```python
import torch

def _softmax(x, axis=-1):
    return torch.softmax(x, dim=axis)
def _gelu(x):
    return torch.nn.functional.gelu(x, approximate="tanh")
def _silu(x):
    return torch.nn.functional.silu(x)
def _sigmoid(x):
    return torch.sigmoid(x)
def _layernorm(x, axis=-1, eps=1e-5):
    m = x.mean(dim=axis, keepdim=True)
    v = x.var(dim=axis, keepdim=True, unbiased=False)
    return (x - m) / torch.sqrt(v + eps)
def _scatter_add(tgt, idx, src, axis=0):
    return tgt.clone().index_add_(axis, idx, src)
def _segment_sum(src, seg, n):
    out = torch.zeros((n,) + src.shape[1:], dtype=src.dtype)
    return out.index_add_(0, seg, src)
def _pad(x, pw):
    flat = tuple(v for pair in reversed(pw) for v in pair)
    return torch.nn.functional.pad(x, flat)

kernel_name = 'parallel_sum__sliding_local_dilated__glu_gated_swiglu__prompt'

def setup_inputs():

    _w = (lambda a: (lambda t: t.to(torch.bfloat16) if t.is_floating_point() else t)(torch.as_tensor(a)))
    def _A_setup():
        B, S, D = 1, 2048, 640
        return {
            "x": _w((lambda *s: torch.randn(*s, dtype=torch.bfloat16) * 0.05)(B, S, D)),
            "wqkv": _w((lambda *s: torch.randn(*s, dtype=torch.bfloat16) * 0.05)(D, 3 * D)),
            "wo": _w((lambda *s: torch.randn(*s, dtype=torch.bfloat16) * 0.05)(D, D)),
        }
    _A_in = _A_setup()

    def _B_setup():
        B, S, D, F = 1, 2048, 640, 1728
        return {
            "x": _w((lambda *s: torch.randn(*s, dtype=torch.bfloat16) * 0.05)(B, S, D)),
            "w1": _w((lambda *s: torch.randn(*s, dtype=torch.bfloat16) * 0.8)(D, F) * (2.0 / D) ** 0.5),
            "w3": _w((lambda *s: torch.randn(*s, dtype=torch.bfloat16) * 0.8)(D, F) * (2.0 / D) ** 0.5),
            "w2": _w((lambda *s: torch.randn(*s, dtype=torch.bfloat16) * 0.8)(F, D) * (2.0 / F) ** 0.5),
        }
    _B_in = _B_setup()

    return {
        "A_x": _A_in["x"],
        "A_wqkv": _A_in["wqkv"],
        "A_wo": _A_in["wo"],
        "B_x": _B_in["x"],
        "B_w1": _B_in["w1"],
        "B_w3": _B_in["w3"],
        "B_w2": _B_in["w2"],
    }

def reference(A_x, A_wqkv, A_wo, B_x, B_w1, B_w3, B_w2):
    def _A_ref(x, wqkv, wo):
        B, S, D = x.shape
        H = 32; Dh = D // H
        W, dil = 8, 2
        qkv = (lambda x, *d: x.permute(*d))((x @ wqkv).reshape(B, S, 3, H, Dh), 2, 0, 3, 1, 4)
        q, k, v = qkv[0], qkv[1], qkv[2]
        scale = Dh ** -0.5
        pos = torch.arange(S)
        off = torch.arange(W) * dil
        idx = pos[:, None] - off[None, :]
        mask = idx >= 0
        idx_c = torch.where(mask, idx, 0).reshape(-1)
        kg = k[:, :, idx_c, :].reshape(B, H, S, W, Dh)
        vg = v[:, :, idx_c, :].reshape(B, H, S, W, Dh)
        logits = torch.einsum("bhsd,bhswd->bhsw", q, kg) * scale
        logits = torch.where(mask[None, None, :, :], logits, -1e9)
        attn = _softmax(logits, axis=-1)
        o = torch.einsum("bhsw,bhswd->bhsd", attn, vg)
        return (lambda x, *d: x.permute(*d))(o, 0, 2, 1, 3).reshape(B, S, D) @ wo

    def _B_ref(x, w1, w3, w2):
        gate = torch.einsum("bsd,df->bsf", x, w1)
        up = torch.einsum("bsd,df->bsf", x, w3)
        h = _silu(gate) * up
        out = torch.einsum("bsf,fd->bsd", h, w2)
        return out

    x = A_x
    xn = _layernorm(x, axis=-1)
    return x + _A_ref(xn, A_wqkv, A_wo) + _B_ref(xn, B_w1, B_w3, B_w2)
```

```asm
; @launch grid=(256,1,1) block=(512,1,1) lds=163840
.amdgcn_target "amdgcn-amd-amdhsa--gfx950"
.text
.globl parallel_sum__sliding_local_dilated__glu_gated_swiglu__prompt_kernel
.p2align 8
.type parallel_sum__sliding_local_dilated__glu_gated_swiglu__prompt_kernel,@function
parallel_sum__sliding_local_dilated__glu_gated_swiglu__prompt_kernel:
    s_cmp_ge_u32 s2, 256
    s_cbranch_scc1 L_parallel_sum__sliding_local_dilated__glu_gated_swiglu__prompt_kernel_end
    s_load_dwordx2 s[24:25], s[0:1], 0
    s_load_dwordx4 s[52:55], s[0:1], 8
    s_load_dwordx2 s[28:29], s[0:1], 32
    s_load_dwordx2 s[32:33], s[0:1], 40
    s_load_dwordx2 s[56:57], s[0:1], 48
    s_load_dwordx2 s[64:65], s[0:1], 56
    s_load_dwordx2 s[20:21], s[0:1], 72
    v_lshrrev_b32 v2, 6, v0
    v_and_b32 v1, 63, v0
    v_readfirstlane_b32 s3, v2
    s_mov_b32 s22, 15106176
    s_mov_b32 s23, 0x20000
    s_mov_b32 s26, 2621440
    s_mov_b32 s27, 0x20000
    s_mov_b32 s66, 2621440
    s_mov_b32 s67, 0x20000
    s_mov_b32 s38, 32768
    s_mov_b32 s39, 0x20000
    s_mov_b32 s30, 2211840
    s_mov_b32 s31, 0x20000
    s_mov_b32 s34, 2211840
    s_mov_b32 s35, 0x20000
    s_and_b32 s11, s2, 3
    s_bfe_u32 s10, s2, 0x10002
    s_lshr_b32 s12, s2, 3
    s_lshl_b32 s16, s3, 10
    s_mov_b32 s75, 0
    s_cmp_lt_u32 s12, 18
    s_cbranch_scc1 L_parallel_sum__sliding_local_dilated__glu_gated_swiglu__prompt_kernel_ffn
    s_and_b32 s4, s2, 7
    s_lshl_b32 s4, s4, 5
    s_lshr_b32 s5, s2, 3
    s_add_u32 s4, s4, s5
    s_lshl_b32 s4, s4, 3
    s_add_u32 s4, s4, s3
    s_mul_i32 s63, s4, 1280
    s_lshl_b32 s61, s4, 4
    s_mov_b32 s62, 15106048
    v_lshlrev_b32 v116, 4, v1
    v_lshlrev_b32 v117, 2, v1
    v_lshlrev_b32 v29, 24, v1
    s_sub_u32 s12, s12, 18
    s_mov_b32 s30, 2457600
    s_cmp_ge_u32 s12, 7
    s_cselect_b32 s13, 1, 0
    s_cselect_b32 s14, 7, 0
    s_sub_u32 s14, s12, s14
    s_mul_i32 s4, s13, 2
    s_add_u32 s4, s4, s14
    s_mul_i32 s5, s4, 52
    s_lshr_b32 s5, s5, 8
    s_mul_i32 s5, s5, 5
    s_sub_u32 s19, s4, s5
    s_lshl_b32 s4, s11, 1
    s_add_u32 s13, s13, s4
    s_mul_i32 s4, s10, 7
    s_add_u32 s14, s14, s4
    s_mul_i32 s40, s19, 245760
    s_lshl_b32 s50, s19, 7
    s_add_u32 s19, s19, 1
    s_cmp_eq_u32 s19, 5
    s_cselect_b32 s19, 0, s19
    s_and_b32 s4, s3, 3
    s_lshr_b32 s5, s3, 2
    s_lshl_b32 s6, s4, 3
    v_lshrrev_b32 v50, 3, v1
    v_and_b32 v51, 7, v1
    v_add_u32 v52, s6, v50
    v_bfe_u32 v53, v52, 1, 3
    v_xor_b32 v53, v51, v53
    v_and_b32 v6, 15, v52
    v_lshrrev_b32 v52, 4, v52
    v_lshl_add_u32 v6, v6, 1, v52
    s_mul_i32 s15, s14, 146
    s_lshl_b32 s9, s5, 5
    s_add_u32 s6, s15, s9
    v_add_u32 v6, s6, v6
    v_mul_u32_u24 v6, 1280, v6
    v_lshl_add_u32 v6, v53, 4, v6
    v_add_u32 v7, 81920, v6
    v_add_u32 v8, 163840, v6
    s_lshl_b32 s6, s3, 1
    v_lshrrev_b32 v50, 5, v1
    v_add_u32 v50, s6, v50
    v_and_b32 v51, 3, v50
    v_lshlrev_b32 v51, 2, v51
    v_and_b32 v52, 31, v1
    v_xor_b32 v51, v51, v52
    v_mul_u32_u24 v52, 26, v51
    v_lshrrev_b32 v52, 8, v52
    v_mul_u32_u24 v53, 1120, v52
    v_lshl_add_u32 v53, v51, 4, v53
    v_add_u32 v51, 2, v51
    v_lshrrev_b32 v51, 5, v51
    v_lshl_add_u32 v53, v51, 30, v53
    v_mul_u32_u24 v5, 3840, v50
    v_add_u32 v5, v5, v53
    s_mul_i32 s6, s13, 160
    v_add_u32 v5, s6, v5
    s_waitcnt lgkmcnt(0)
    s_add_u32 s36, s20, 14680064
    s_addc_u32 s37, s21, 0
    s_mov_b32 s68, s28
    s_mov_b32 s69, s29
    s_mov_b32 s28, s52
    s_mov_b32 s29, s53
    buffer_load_dword v29, v29, s[20:23], s62 offen sc1
    buffer_load_dwordx4 v[24:27], v116, s[24:27], s63 offen
    buffer_load_dword v28, v117, s[24:27], s63 offen offset:1024
    s_mov_b32 s81, s61
    s_mul_i32 s41, s19, 245760
    s_lshl_b32 s51, s19, 7
    s_add_u32 s19, s19, 1
    s_cmp_eq_u32 s19, 5
    s_cselect_b32 s19, 0, s19
    s_mul_i32 s42, s19, 245760
    s_lshl_b32 s52, s19, 7
    s_add_u32 s19, s19, 1
    s_cmp_eq_u32 s19, 5
    s_cselect_b32 s19, 0, s19
    s_mul_i32 s43, s19, 245760
    s_lshl_b32 s53, s19, 7
    s_add_u32 m0, s16, 0
    s_nop 0
    buffer_load_dwordx4 v6, s[24:27], s50 offen lds
    s_add_u32 s19, s19, 1
    s_cmp_eq_u32 s19, 5
    s_cselect_b32 s19, 0, s19
    s_mul_i32 s44, s19, 245760
    s_lshl_b32 s54, s19, 7
    s_add_u32 s19, s19, 1
    s_cmp_eq_u32 s19, 5
    s_cselect_b32 s19, 0, s19
    s_add_u32 s4, s19, 5
    s_mul_i32 s45, s4, 245760
    s_lshl_b32 s55, s4, 7
    s_add_u32 s19, s19, 1
    s_add_u32 m0, s16, 8192
    s_nop 0
    buffer_load_dwordx4 v7, s[24:27], s50 offen lds
    s_cmp_eq_u32 s19, 5
    s_cselect_b32 s19, 0, s19
    s_add_u32 s4, s19, 5
    s_mul_i32 s46, s4, 245760
    s_lshl_b32 s56, s4, 7
    s_add_u32 s19, s19, 1
    s_cmp_eq_u32 s19, 5
    s_cselect_b32 s19, 0, s19
    s_add_u32 s4, s19, 5
    s_mul_i32 s47, s4, 245760
    s_lshl_b32 s57, s4, 7
    s_add_u32 s19, s19, 1
    s_cmp_lt_u32 s3, 4
    s_cbranch_scc0 L_c1
    s_add_u32 m0, s16, 16384
    s_nop 0
    buffer_load_dwordx4 v8, s[24:27], s50 offen lds
L_c1:
    s_cmp_eq_u32 s19, 5
    s_cselect_b32 s19, 0, s19
    s_add_u32 s4, s19, 5
    s_mul_i32 s48, s4, 245760
    s_lshl_b32 s58, s4, 7
    s_add_u32 s19, s19, 1
    s_cmp_eq_u32 s19, 5
    s_cselect_b32 s19, 0, s19
    s_add_u32 s4, s19, 5
    s_mul_i32 s49, s4, 245760
    s_lshl_b32 s59, s4, 7
    v_lshrrev_b32 v50, 5, v1
    v_lshlrev_b32 v50, 12, v50
    v_bfe_u32 v51, v1, 2, 2
    v_lshl_add_u32 v50, v51, 9, v50
    v_xor_b32 v51, s3, v51
    v_lshl_add_u32 v50, v51, 6, v50
    v_bfe_u32 v51, v1, 4, 1
    v_lshl_add_u32 v50, v51, 5, v50
    v_and_b32 v51, 3, v1
    v_lshl_add_u32 v50, v51, 3, v50
    v_add_u32 v9, 20480, v50
    v_add_u32 v10, 73728, v50
    v_add_u32 v11, 126976, v50
    v_and_b32 v50, 31, v1
    v_lshrrev_b32 v51, 5, v1
    v_bfe_u32 v52, v1, 1, 3
    v_xor_b32 v52, v51, v52
    v_lshlrev_b32 v53, 7, v50
    v_xor_b32 v54, 0, v52
    v_lshl_add_u32 v12, v54, 4, v53
    v_add_u32 v16, 53248, v12
    v_add_u32 v20, 106496, v12
    v_xor_b32 v54, 2, v52
    v_lshl_add_u32 v13, v54, 4, v53
    v_add_u32 v17, 53248, v13
    v_add_u32 v21, 106496, v13
    v_xor_b32 v54, 4, v52
    v_lshl_add_u32 v14, v54, 4, v53
    v_add_u32 v18, 53248, v14
    v_add_u32 v22, 106496, v14
    v_xor_b32 v54, 6, v52
    v_lshl_add_u32 v15, v54, 4, v53
    v_add_u32 v19, 53248, v15
    v_add_u32 v23, 106496, v15
    s_mul_i32 s4, s11, 15
    s_add_u32 s4, s4, 1
    s_add_u32 m0, s16, 20480
    s_nop 0
    buffer_load_dwordx4 v5, s[28:31], s40 offen lds
    s_lshr_b32 s4, s4, 1
    s_add_u32 s4, s4, s12
    s_mul_i32 s6, s4, 86
    s_lshr_b32 s6, s6, 8
    s_mul_i32 s7, s6, 3
    s_sub_u32 s4, s4, s7
    s_mul_i32 s8, s4, 10
    s_add_u32 s8, s8, s6
    s_lshl_b32 s9, s8, 7
    s_mul_i32 s4, s11, 9
    s_add_u32 s4, s4, 1
    s_lshr_b32 s4, s4, 1
    s_add_u32 s4, s4, s12
    s_sub_u32 s4, s4, 9
    s_lshr_b32 s5, s4, 1
    s_mul_i32 s5, s5, 3
    s_add_u32 s5, s5, 2
    s_bitcmp1_b32 s4, 0
    s_cselect_b32 s6, 57, 30
    s_cselect_b32 s68, s32, s68
    s_cselect_b32 s69, s33, s69
    s_add_u32 s6, s6, s5
    s_lshl_b32 s5, s5, 7
    s_movk_i32 s76, 3456
    s_cmp_lt_u32 s12, 9
    s_cselect_b32 s8, s8, s6
    s_cselect_b32 s9, s9, s5
    s_cselect_b32 s76, 3840, s76
    s_cselect_b32 s7, 8, 14
    s_cselect_b32 s68, s28, s68
    s_cselect_b32 s69, s29, s69
    s_mul_i32 s70, s76, 640
    s_mov_b32 s71, 0x20000
    s_lshl_b32 s0, s76, 6
    s_and_b32 s4, s11, 1
    s_add_u32 s4, s4, s12
    s_add_u32 m0, s16, 28672
    s_add_u32 s63, s40, 61440
    buffer_load_dwordx4 v5, s[28:31], s63 offen lds
    s_cmp_lt_u32 s4, s7
    s_cselect_b32 s9, s9, 0x7ff00000
    s_cselect_b32 s7, s3, 1
    s_lshl_b32 s5, s8, 10
    s_lshl_b32 s8, s10, 9
    s_add_u32 s5, s5, s8
    s_add_u32 s5, s5, 14942208
    s_mul_i32 s8, s10, 40
    s_add_u32 s8, s8, s3
    s_lshl_b32 s8, s8, 3
    s_mul_i32 s8, s8, s76
    s_add_u32 s78, s8, s9
    s_cmp_eq_u32 s7, 0
    s_cselect_b32 s18, s5, 0x7ff00000
    v_lshrrev_b32 v118, 3, v1
    v_and_b32 v119, 7, v1
    v_mul_u32_u24 v118, s76, v118
    v_lshl_add_u32 v118, v119, 4, v118
    s_bfe_u32 s10, s2, 0x20001
    s_lshl_b32 s10, s10, 3
    s_bfe_u32 s5, s2, 0x30003
    s_add_u32 s10, s10, s5
    s_and_b32 s11, s2, 1
    s_lshl_b32 s11, s11, 2
    s_lshr_b32 s6, s2, 6
    s_add_u32 s11, s11, s6
    s_bfe_u32 s6, s3, 0x10001
    s_lshl_b32 s9, s10, 1
    s_add_u32 s6, s6, s9
    s_mul_i32 s72, s6, 74
    s_lshr_b32 s9, s3, 2
    s_add_u32 s72, s72, s9
    s_lshl_b32 s72, s72, 1
    s_and_b32 s9, s3, 1
    s_add_u32 s72, s72, s9
    s_lshl_b32 s72, s72, 10
    s_mul_i32 s74, s10, 81920
    s_add_u32 m0, s16, 36864
    s_add_u32 s63, s40, 122880
    buffer_load_dwordx4 v5, s[28:31], s63 offen lds
    s_mul_i32 s73, s11, 74
    s_add_u32 s73, s73, s3
    s_mul_i32 s73, s73, 5120
    s_add_u32 s73, s73, 10485760
    s_mul_i32 s6, s11, 160
    s_add_u32 s74, s74, s6
    s_lshr_b32 s6, s10, 1
    s_lshl_b32 s6, s6, 7
    s_sub_u32 s6, s6, 0
    s_mov_b32 exec_lo, 65535
    s_mov_b32 exec_hi, 0
    v_lshl_add_u32 v2, v1, 2, s6
    s_mov_b64 exec, -1
    s_lshl_b32 s6, s10, 6
    s_add_u32 s6, s6, 0
    s_max_u32 s6, s6, 14
    s_sub_u32 s6, s6, 14
    s_mul_i32 s6, s6, 7183
    s_lshr_b32 s6, s6, 20
    s_add_u32 s6, s6, 16
    s_lshl_b32 s6, s6, 7
    s_sub_u32 s6, s6, 64
    s_mov_b32 exec_lo, 16711680
    s_mov_b32 exec_hi, 0
    v_lshl_add_u32 v2, v1, 2, s6
    s_mov_b64 exec, -1
    s_lshl_b32 s6, s10, 6
    s_add_u32 s6, s6, 63
    s_max_u32 s6, s6, 14
    s_sub_u32 s6, s6, 14
    s_mul_i32 s6, s6, 7183
    s_lshr_b32 s6, s6, 20
    s_add_u32 s6, s6, 16
    s_lshl_b32 s6, s6, 7
    s_sub_u32 s6, s6, 96
    s_mov_b32 exec_lo, 4278190080
    s_mov_b32 exec_hi, 0
    v_lshl_add_u32 v2, v1, 2, s6
    s_mov_b64 exec, -1
    s_add_u32 m0, s16, 45056
    s_add_u32 s63, s40, 184320
    buffer_load_dwordx4 v5, s[28:31], s63 offen lds
    s_mul_i32 s6, s11, 5
    s_add_u32 s6, s6, 128
    s_lshr_b32 s6, s6, 2
    s_lshl_b32 s6, s6, 7
    s_sub_u32 s6, s6, 128
    s_mov_b32 exec_lo, 0
    s_mov_b32 exec_hi, 8191
    v_lshl_add_u32 v2, v1, 2, s6
    s_mov_b64 exec, -1
    s_mul_i32 s6, s11, 5
    s_add_u32 s6, s6, 132
    s_lshr_b32 s6, s6, 2
    s_lshl_b32 s6, s6, 7
    s_sub_u32 s6, s6, 180
    s_mov_b32 exec_lo, 0
    s_mov_b32 exec_hi, 4294959104
    v_lshl_add_u32 v2, v1, 2, s6
    s_mov_b64 exec, -1
    s_lshl_b32 s17, s14, 5
    s_add_u32 s17, s17, s13
    s_lshl_b32 s17, s17, 2
    s_add_u32 s17, s17, 15075328
    s_mov_b32 s12, 14942208
    v_lshlrev_b32 v0, 4, v1
    v_or_b32 v4, s16, v1
    v_min_u32 v4, 1, v4
    v_lshlrev_b32 v4, 30, v4
    v_and_b32 v50, 31, v1
    v_lshrrev_b32 v51, 5, v1
    v_and_b32 v52, 15, v1
    v_bfe_u32 v53, v1, 4, 1
    v_lshl_add_u32 v54, v52, 1, v53
    v_add_u32 v54, s15, v54
    v_add_u32 v87, 0, v54
    v_min_u32 v87, 2047, v87
    v_lshlrev_b32 v87, 4, v87
    s_add_u32 m0, s16, 53248
    s_nop 0
    buffer_load_dwordx4 v6, s[24:27], s51 offen lds
    v_add_u32 v88, 32, v54
    v_min_u32 v88, 2047, v88
    v_lshlrev_b32 v88, 4, v88
    v_add_u32 v89, 64, v54
    v_min_u32 v89, 2047, v89
    v_lshlrev_b32 v89, 4, v89
    v_add_u32 v90, 96, v54
    v_min_u32 v90, 2047, v90
    v_lshlrev_b32 v90, 4, v90
    v_add_u32 v91, 128, v54
    v_min_u32 v91, 2047, v91
    v_lshlrev_b32 v91, 4, v91
    s_lshl_b32 s6, s3, 5
    v_add_u32 v50, s6, v50
    v_min_u32 v50, 239, v50
    v_mul_u32_u24 v54, 205, v50
    v_lshrrev_b32 v54, 14, v54
    v_mul_u32_u24 v54, 560, v54
    v_add_u32 v54, v54, v50
    s_mul_i32 s6, s13, 80
    v_add_u32 v54, s6, v54
    v_lshrrev_b32 v58, 6, v54
    v_lshlrev_b32 v58, 10, v58
    v_and_b32 v54, 63, v54
    v_lshl_add_u32 v58, v54, 3, v58
    v_lshl_add_u32 v58, v51, 9, v58
    v_mul_u32_u24 v55, 3200, v53
    v_mul_u32_u24 v56, 40, v52
    v_add_u32 v55, v55, v56
    v_add_u32 v55, 81920, v55
    s_lshl_b32 s6, s3, 3
    v_add_u32 v50, s6, v51
    v_mul_u32_u24 v54, 52, v50
    v_lshrrev_b32 v54, 8, v54
    v_mul_u32_u24 v56, 6360, v54
    v_lshl_add_u32 v56, v50, 3, v56
    s_add_u32 m0, s16, 61440
    s_nop 0
    buffer_load_dwordx4 v7, s[24:27], s51 offen lds
    v_add_u32 v46, v56, v55
    v_add_u32 v50, s6, v51
    v_add_u32 v50, 2, v50
    v_mul_u32_u24 v54, 52, v50
    v_lshrrev_b32 v54, 8, v54
    v_mul_u32_u24 v56, 6360, v54
    v_lshl_add_u32 v56, v50, 3, v56
    v_add_u32 v47, v56, v55
    v_add_u32 v50, s6, v51
    v_add_u32 v50, 4, v50
    v_mul_u32_u24 v54, 52, v50
    v_lshrrev_b32 v54, 8, v54
    v_mul_u32_u24 v56, 6360, v54
    v_lshl_add_u32 v56, v50, 3, v56
    v_add_u32 v48, v56, v55
    v_add_u32 v50, s6, v51
    v_add_u32 v50, 6, v50
    v_mul_u32_u24 v54, 52, v50
    v_lshrrev_b32 v54, 8, v54
    v_mul_u32_u24 v56, 6360, v54
    v_lshl_add_u32 v56, v50, 3, v56
    v_add_u32 v49, v56, v55
    v_and_b32 v85, 15, v1
    v_lshrrev_b32 v86, 4, v1
    v_lshlrev_b32 v50, 2, v86
    v_sub_u32 v50, v85, v50
    v_mov_b32 v54, 0xf149f2ca
    v_mov_b32 v55, 0xffff
    v_mov_b32 v56, 0xffff0000
    v_add_u32 v51, 0, v50
    v_cmp_gt_u32 s[4:5], 8, v51
    s_nop 1
    v_cndmask_b32 v60, v54, 0, s[4:5]
    v_cndmask_b32 v68, 0, v55, s[4:5]
    v_add_u32 v51, 16, v50
    v_cmp_gt_u32 s[4:5], 8, v51
    s_nop 1
    v_cndmask_b32 v64, v54, 0, s[4:5]
    s_cmp_lt_u32 s3, 4
    s_cbranch_scc0 L_c2
    s_add_u32 m0, s16, 69632
    s_nop 0
    buffer_load_dwordx4 v8, s[24:27], s51 offen lds
L_c2:
    v_cndmask_b32 v70, 0, v55, s[4:5]
    v_add_u32 v51, -1, v50
    v_cmp_gt_u32 s[4:5], 8, v51
    s_nop 1
    v_cndmask_b32 v61, v54, 0, s[4:5]
    v_cndmask_b32 v53, 0, v56, s[4:5]
    v_or_b32 v68, v68, v53
    v_add_u32 v51, 15, v50
    v_cmp_gt_u32 s[4:5], 8, v51
    s_nop 1
    v_cndmask_b32 v65, v54, 0, s[4:5]
    v_cndmask_b32 v53, 0, v56, s[4:5]
    v_or_b32 v70, v70, v53
    v_add_u32 v51, -2, v50
    v_cmp_gt_u32 s[4:5], 8, v51
    s_nop 1
    v_cndmask_b32 v62, v54, 0, s[4:5]
    v_cndmask_b32 v69, 0, v55, s[4:5]
    v_add_u32 v51, 14, v50
    v_cmp_gt_u32 s[4:5], 8, v51
    s_nop 1
    v_cndmask_b32 v66, v54, 0, s[4:5]
    v_cndmask_b32 v71, 0, v55, s[4:5]
    v_add_u32 v51, -3, v50
    v_cmp_gt_u32 s[4:5], 8, v51
    s_nop 1
    v_cndmask_b32 v63, v54, 0, s[4:5]
    v_cndmask_b32 v53, 0, v56, s[4:5]
    v_or_b32 v69, v69, v53
    v_add_u32 v51, 13, v50
    v_cmp_gt_u32 s[4:5], 8, v51
    s_nop 1
    v_cndmask_b32 v67, v54, 0, s[4:5]
    v_cndmask_b32 v53, 0, v56, s[4:5]
    v_or_b32 v71, v71, v53
    v_mov_b32 v72, 0x3f803f80
    v_mov_b32 v73, 0x3f803f80
    v_mov_b32 v74, 0x3f803f80
    v_mov_b32 v75, 0x3f803f80
    v_cmp_eq_u32 s[4:5], 0, v86
    s_nop 1
    v_cndmask_b32 v76, 0, -1, s[4:5]
    s_mul_i32 s6, s3, 3200
    s_add_u32 m0, s16, 73728
    s_nop 0
    buffer_load_dwordx4 v5, s[28:31], s41 offen lds
    s_add_u32 s6, s6, 81920
    v_mul_u32_u24 v50, 40, v85
    v_add_u32 v50, s6, v50
    v_lshl_add_u32 v77, v86, 3, v50
    v_add_u32 v78, 32, v50
    v_lshrrev_b32 v50, 2, v1
    v_mul_u32_u24 v50, 40, v50
    v_add_u32 v50, s6, v50
    v_add_u32 v50, 51200, v50
    v_and_b32 v51, 3, v1
    v_lshl_add_u32 v79, v51, 3, v50
    v_add_u32 v80, 32, v50
    s_mul_i32 s7, s14, 73
    s_and_b32 s6, s7, 7
    s_lshl_b32 s6, s6, 4
    s_bitcmp1_b32 s3, 0
    s_cselect_b32 s8, 83328, 0
    s_max_u32 s8, s8, 81920
    s_add_u32 s6, s6, s8
    v_lshl_add_u32 v51, v85, 4, s6
    s_lshr_b32 s6, s3, 1
    s_mul_i32 s6, s6, 5
    v_add_u32 v50, s6, v86
    v_lshrrev_b32 v52, 1, v50
    v_mul_u32_u24 v52, 2816, v52
    v_add_u32 v81, v52, v51
    v_and_b32 v52, 1, v50
    v_lshl_add_u32 v81, v52, 3, v81
    s_add_u32 s6, s6, 4
    v_mov_b32 v50, s6
    v_lshrrev_b32 v52, 1, v50
    v_mul_u32_u24 v52, 2816, v52
    v_add_u32 v82, v52, v51
    v_and_b32 v52, 1, v50
    v_lshl_add_u32 v82, v52, 3, v82
    v_mov_b32 v55, 159744
    s_add_u32 m0, s16, 81920
    s_add_u32 s63, s41, 61440
    buffer_load_dwordx4 v5, s[28:31], s63 offen lds
    v_cndmask_b32 v82, v55, v82, s[4:5]
    v_lshl_add_u32 v83, v1, 4, s16
    v_add_u32 v83, 81920, v83
    s_mul_i32 s7, s14, 73
    s_add_u32 s8, s7, 7
    s_cmp_eq_u32 s14, 0
    s_cselect_b32 s8, 0, s8
    s_add_u32 s35, s7, 80
    s_sub_u32 s34, s35, s8
    s_mov_b32 s33, s8
    s_and_b32 s32, s7, -8
    s_mul_i32 s1, s13, 10
    v_mov_b32 v55, 0x7ff00000
    s_lshl_b32 s6, s3, 6
    s_add_u32 s6, s6, 0
    v_add_u32 v50, s6, v1
    v_mul_u32_u24 v51, 745, v50
    v_lshrrev_b32 v51, 16, v51
    v_mul_u32_u24 v52, 88, v51
    v_sub_u32 v50, v50, v52
    v_add_u32 v50, s32, v50
    v_lshrrev_b32 v52, 4, v50
    v_mul_u32_u24 v92, 151552, v52
    v_and_b32 v52, 15, v50
    v_lshl_add_u32 v92, v52, 4, v92
    v_and_b32 v52, 1, v51
    v_lshl_add_u32 v92, v52, 10, v92
    v_lshrrev_b32 v52, 1, v51
    v_add_u32 v52, s1, v52
    v_lshrrev_b32 v53, 2, v52
    v_lshl_add_u32 v92, v53, 11, v92
    v_and_b32 v52, 3, v52
    v_lshl_add_u32 v92, v52, 8, v92
    v_subrev_u32 v50, s33, v50
    v_cmp_gt_u32 s[4:5], s34, v50
    s_nop 1
    v_cndmask_b32 v92, v55, v92, s[4:5]
    s_add_u32 m0, s16, 90112
    s_add_u32 s63, s41, 122880
    buffer_load_dwordx4 v5, s[28:31], s63 offen lds
    s_lshl_b32 s6, s3, 6
    s_add_u32 s6, s6, 512
    v_add_u32 v50, s6, v1
    v_mul_u32_u24 v51, 745, v50
    v_lshrrev_b32 v51, 16, v51
    v_mul_u32_u24 v52, 88, v51
    v_sub_u32 v50, v50, v52
    v_add_u32 v50, s32, v50
    v_lshrrev_b32 v52, 4, v50
    v_mul_u32_u24 v93, 151552, v52
    v_and_b32 v52, 15, v50
    v_lshl_add_u32 v93, v52, 4, v93
    v_and_b32 v52, 1, v51
    v_lshl_add_u32 v93, v52, 10, v93
    v_lshrrev_b32 v52, 1, v51
    v_add_u32 v52, s1, v52
    v_lshrrev_b32 v53, 2, v52
    v_lshl_add_u32 v93, v53, 11, v93
    v_and_b32 v52, 3, v52
    v_lshl_add_u32 v93, v52, 8, v93
    v_subrev_u32 v50, s33, v50
    v_cmp_gt_u32 s[4:5], s34, v50
    s_nop 1
    v_cndmask_b32 v93, v55, v93, s[4:5]
    s_lshl_b32 s6, s3, 6
    s_add_u32 s6, s6, 1024
    v_add_u32 v50, s6, v1
    v_mul_u32_u24 v51, 745, v50
    v_lshrrev_b32 v51, 16, v51
    v_mul_u32_u24 v52, 88, v51
    v_sub_u32 v50, v50, v52
    v_add_u32 v50, s32, v50
    v_lshrrev_b32 v52, 4, v50
    v_mul_u32_u24 v94, 151552, v52
    v_and_b32 v52, 15, v50
    v_lshl_add_u32 v94, v52, 4, v94
    v_and_b32 v52, 1, v51
    s_add_u32 m0, s16, 98304
    s_add_u32 s63, s41, 184320
    buffer_load_dwordx4 v5, s[28:31], s63 offen lds
    v_lshl_add_u32 v94, v52, 10, v94
    v_lshrrev_b32 v52, 1, v51
    v_add_u32 v52, s1, v52
    v_lshrrev_b32 v53, 2, v52
    v_lshl_add_u32 v94, v53, 11, v94
    v_and_b32 v52, 3, v52
    v_lshl_add_u32 v94, v52, 8, v94
    v_subrev_u32 v50, s33, v50
    v_cmp_gt_u32 s[4:5], s34, v50
    s_nop 1
    v_cndmask_b32 v94, v55, v94, s[4:5]
    s_lshl_b32 s6, s3, 6
    s_add_u32 s6, s6, 1536
    v_add_u32 v50, s6, v1
    v_mul_u32_u24 v51, 745, v50
    v_lshrrev_b32 v51, 16, v51
    v_mul_u32_u24 v52, 88, v51
    v_sub_u32 v50, v50, v52
    v_add_u32 v50, s32, v50
    v_lshrrev_b32 v52, 4, v50
    v_mul_u32_u24 v95, 151552, v52
    v_and_b32 v52, 15, v50
    v_lshl_add_u32 v95, v52, 4, v95
    v_and_b32 v52, 1, v51
    v_lshl_add_u32 v95, v52, 10, v95
    v_lshrrev_b32 v52, 1, v51
    v_add_u32 v52, s1, v52
    v_lshrrev_b32 v53, 2, v52
    v_lshl_add_u32 v95, v53, 11, v95
    v_and_b32 v52, 3, v52
    v_lshl_add_u32 v95, v52, 8, v95
    v_subrev_u32 v50, s33, v50
    v_cmp_gt_u32 s[4:5], s34, v50
    s_nop 1
    v_cndmask_b32 v95, v55, v95, s[4:5]
    v_cmp_gt_u32 s[4:5], 20, v51
    s_nop 1
    v_cndmask_b32 v95, v55, v95, s[4:5]
    s_mov_b32 s61, 0x01000100
    s_mov_b32 s62, 0x03020302
    s_waitcnt vmcnt(14)
    v_readfirstlane_b32 s60, v29
    s_waitcnt vmcnt(12)
    v_lshlrev_b32 v38, 16, v28
    v_and_b32 v39, 0xffff0000, v28
    v_lshlrev_b32 v30, 16, v24
    v_and_b32 v31, 0xffff0000, v24
    v_lshlrev_b32 v32, 16, v25
    v_and_b32 v33, 0xffff0000, v25
    v_lshlrev_b32 v34, 16, v26
    v_and_b32 v35, 0xffff0000, v26
    v_lshlrev_b32 v36, 16, v27
    v_and_b32 v37, 0xffff0000, v27
    s_mul_i32 s60, s60, 0x9e3779b1
    s_add_u32 s60, s60, 0x7f4a7c15
    v_add_f32 v29, v30, v31
    v_add_f32 v28, v32, v33
    v_add_f32 v29, v29, v34
    v_add_f32 v28, v28, v35
    v_add_f32 v29, v29, v36
    v_add_f32 v28, v28, v37
    v_add_f32 v29, v29, v38
    v_add_f32 v28, v28, v39
    v_add_f32 v29, v29, v28
    s_nop 1
    v_add_f32_dpp v29, v29, v29 quad_perm:[1,0,3,2] row_mask:0xf bank_mask:0xf
    s_nop 1
    v_add_f32_dpp v29, v29, v29 quad_perm:[2,3,0,1] row_mask:0xf bank_mask:0xf
    s_nop 1
    v_add_f32_dpp v29, v29, v29 row_half_mirror row_mask:0xf bank_mask:0xf
    s_nop 1
    v_add_f32_dpp v29, v29, v29 row_ror:8 row_mask:0xf bank_mask:0xf
    v_mov_b32 v28, v29
    s_nop 1
    v_permlane16_swap_b32 v29, v28
    v_add_f32 v29, v29, v28
    v_mov_b32 v28, v29
    s_nop 1
    v_permlane32_swap_b32 v29, v28
    v_add_f32 v29, v29, v28
    v_mul_f32 v29, 0xbacccccd, v29
    v_add_f32 v30, v30, v29
    v_add_f32 v31, v31, v29
    v_add_f32 v32, v32, v29
    v_add_f32 v33, v33, v29
    v_add_f32 v34, v34, v29
    v_add_f32 v35, v35, v29
    v_add_f32 v36, v36, v29
    v_add_f32 v37, v37, v29
    v_add_f32 v38, v38, v29
    v_add_f32 v39, v39, v29
    v_mul_f32 v25, v30, v30
    v_mul_f32 v28, v31, v31
    v_fmac_f32 v25, v32, v32
    v_fmac_f32 v28, v33, v33
    v_fmac_f32 v25, v34, v34
    v_fmac_f32 v28, v35, v35
    v_fmac_f32 v25, v36, v36
    v_fmac_f32 v28, v37, v37
    v_fmac_f32 v25, v38, v38
    v_fmac_f32 v28, v39, v39
    v_add_f32 v25, v25, v28
    s_nop 1
    v_add_f32_dpp v25, v25, v25 quad_perm:[1,0,3,2] row_mask:0xf bank_mask:0xf
    s_nop 1
    v_add_f32_dpp v25, v25, v25 quad_perm:[2,3,0,1] row_mask:0xf bank_mask:0xf
    s_nop 1
    v_add_f32_dpp v25, v25, v25 row_half_mirror row_mask:0xf bank_mask:0xf
    s_nop 1
    v_add_f32_dpp v25, v25, v25 row_ror:8 row_mask:0xf bank_mask:0xf
    v_mov_b32 v28, v25
    s_nop 1
    v_permlane16_swap_b32 v25, v28
    v_add_f32 v25, v25, v28
    v_mov_b32 v28, v25
    s_nop 1
    v_permlane32_swap_b32 v25, v28
    v_add_f32 v25, v25, v28
    v_mov_b32 v27, 0x3727c5ac
    v_fmac_f32 v27, 0x3acccccd, v25
    v_rsq_f32 v26, v27
    v_cvt_pk_bf16_f32 v28, v29, v29
    v_lshlrev_b32 v28, 16, v28
    v_sub_f32 v28, v29, v28
    v_cvt_pk_bf16_f32 v24, v29, v28
    v_mov_b32 v25, s60
    v_mov_b32 v28, s16
    v_lshrrev_b32 v28, 6, v28
    v_add_u32 v28, 162816, v28
    ds_write_b128 v28, v[24:27]
    s_waitcnt vmcnt(6) lgkmcnt(0)
    s_barrier
    ds_read_b64_tr_b16 v[128:129], v9
    ds_read_b64_tr_b16 v[130:131], v9 offset:2048
    ds_read_b128 v[132:135], v12
    ds_read_b128 v[136:139], v12 offset:4096
    ds_read_b128 v[140:143], v12 offset:8192
    ds_read_b128 v[144:147], v12 offset:12288
    ds_read_b128 v[148:151], v12 offset:16384
    s_waitcnt lgkmcnt(4)
    v_mfma_f32_32x32x16_bf16 v[176:191], v[128:131], v[132:135], 0
    ds_read_b64_tr_b16 v[152:153], v9 offset:8192
    ds_read_b64_tr_b16 v[154:155], v9 offset:10240
    s_cmp_eq_u32 s3, 1
    s_cbranch_scc0 L_b3
    v_and_b32 v28, 0x70, v116
    v_add_u32 v28, 162816, v28
    ds_read_b128 v[24:27], v28
    v_lshrrev_b32 v29, 7, v116
    v_lshl_add_u32 v29, v29, 24, v116
    s_sub_u32 s81, s81, 16
    s_waitcnt lgkmcnt(0)
    buffer_store_dwordx4 v[24:27], v29, s[36:39], s81 offen sc1
    s_nop 1
L_b3:
    s_waitcnt lgkmcnt(5)
    v_mfma_f32_32x32x16_bf16 v[192:207], v[128:131], v[136:139], 0
    ds_read_b128 v[156:159], v13
    ds_read_b128 v[160:163], v13 offset:4096
    s_add_u32 m0, s16, 106496
    s_nop 0
    buffer_load_dwordx4 v6, s[24:27], s52 offen lds
    s_waitcnt lgkmcnt(6)
    v_mfma_f32_32x32x16_bf16 v[208:223], v[128:131], v[140:143], 0
    ds_read_b128 v[164:167], v13 offset:8192
    ds_read_b128 v[168:171], v13 offset:12288
    s_add_u32 m0, s16, 114688
    s_nop 0
    buffer_load_dwordx4 v7, s[24:27], s52 offen lds
    s_waitcnt lgkmcnt(7)
    v_mfma_f32_32x32x16_bf16 v[224:239], v[128:131], v[144:147], 0
    ds_read_b128 v[172:175], v13 offset:16384
    s_cmp_lt_u32 s3, 4
    s_cbranch_scc0 L_c4
    s_add_u32 m0, s16, 122880
    s_nop 0
    buffer_load_dwordx4 v8, s[24:27], s52 offen lds
L_c4:
    s_waitcnt lgkmcnt(7)
    v_mfma_f32_32x32x16_bf16 v[240:255], v[128:131], v[148:151], 0
    s_add_u32 m0, s16, 126976
    s_nop 0
    buffer_load_dwordx4 v5, s[28:31], s42 offen lds
    s_waitcnt lgkmcnt(4)
    v_mfma_f32_32x32x16_bf16 v[176:191], v[152:155], v[156:159], v[176:191]
    ds_read_b64_tr_b16 v[128:129], v9 offset:16384
    ds_read_b64_tr_b16 v[130:131], v9 offset:18432
    s_waitcnt lgkmcnt(5)
    v_mfma_f32_32x32x16_bf16 v[192:207], v[152:155], v[160:163], v[192:207]
    ds_read_b128 v[132:135], v14
    ds_read_b128 v[136:139], v14 offset:4096
    s_waitcnt lgkmcnt(6)
    v_mfma_f32_32x32x16_bf16 v[208:223], v[152:155], v[164:167], v[208:223]
    ds_read_b128 v[140:143], v14 offset:8192
    ds_read_b128 v[144:147], v14 offset:12288
    s_waitcnt lgkmcnt(7)
    v_mfma_f32_32x32x16_bf16 v[224:239], v[152:155], v[168:171], v[224:239]
    ds_read_b128 v[148:151], v14 offset:16384
    s_add_u32 m0, s16, 135168
    s_add_u32 s63, s42, 61440
    buffer_load_dwordx4 v5, s[28:31], s63 offen lds
    s_waitcnt lgkmcnt(7)
    v_mfma_f32_32x32x16_bf16 v[240:255], v[152:155], v[172:175], v[240:255]
    s_add_u32 m0, s16, 143360
    s_add_u32 s63, s42, 122880
    buffer_load_dwordx4 v5, s[28:31], s63 offen lds
    s_waitcnt lgkmcnt(4)
    v_mfma_f32_32x32x16_bf16 v[176:191], v[128:131], v[132:135], v[176:191]
    ds_read_b64_tr_b16 v[152:153], v9 offset:24576
    ds_read_b64_tr_b16 v[154:155], v9 offset:26624
    s_waitcnt lgkmcnt(5)
    v_mfma_f32_32x32x16_bf16 v[192:207], v[128:131], v[136:139], v[192:207]
    ds_read_b128 v[156:159], v15
    ds_read_b128 v[160:163], v15 offset:4096
    s_waitcnt lgkmcnt(6)
    v_mfma_f32_32x32x16_bf16 v[208:223], v[128:131], v[140:143], v[208:223]
    ds_read_b128 v[164:167], v15 offset:8192
    ds_read_b128 v[168:171], v15 offset:12288
    s_waitcnt lgkmcnt(7)
    v_mfma_f32_32x32x16_bf16 v[224:239], v[128:131], v[144:147], v[224:239]
    ds_read_b128 v[172:175], v15 offset:16384
    s_add_u32 m0, s16, 151552
    s_add_u32 s63, s42, 184320
    buffer_load_dwordx4 v5, s[28:31], s63 offen lds
    s_waitcnt lgkmcnt(7)
    v_mfma_f32_32x32x16_bf16 v[240:255], v[128:131], v[148:151], v[240:255]
    s_waitcnt vmcnt(6) lgkmcnt(0)
    s_barrier
    v_mfma_f32_32x32x16_bf16 v[176:191], v[152:155], v[156:159], v[176:191]
    ds_read_b64_tr_b16 v[128:129], v10
    ds_read_b64_tr_b16 v[130:131], v10 offset:2048
    v_mfma_f32_32x32x16_bf16 v[192:207], v[152:155], v[160:163], v[192:207]
    ds_read_b128 v[132:135], v16
    ds_read_b128 v[136:139], v16 offset:4096
    s_add_u32 m0, s16, 0
    s_nop 0
    buffer_load_dwordx4 v6, s[24:27], s53 offen lds
    v_mfma_f32_32x32x16_bf16 v[208:223], v[152:155], v[164:167], v[208:223]
    ds_read_b128 v[140:143], v16 offset:8192
    ds_read_b128 v[144:147], v16 offset:12288
    s_add_u32 m0, s16, 8192
    s_nop 0
    buffer_load_dwordx4 v7, s[24:27], s53 offen lds
    v_mfma_f32_32x32x16_bf16 v[224:239], v[152:155], v[168:171], v[224:239]
    ds_read_b128 v[148:151], v16 offset:16384
    s_cmp_lt_u32 s3, 4
    s_cbranch_scc0 L_c5
    s_add_u32 m0, s16, 16384
    s_nop 0
    buffer_load_dwordx4 v8, s[24:27], s53 offen lds
L_c5:
    v_mfma_f32_32x32x16_bf16 v[240:255], v[152:155], v[172:175], v[240:255]
    s_add_u32 m0, s16, 20480
    s_nop 0
    buffer_load_dwordx4 v5, s[28:31], s43 offen lds
    s_waitcnt lgkmcnt(4)
    v_mfma_f32_32x32x16_bf16 v[176:191], v[128:131], v[132:135], v[176:191]
    ds_read_b64_tr_b16 v[152:153], v10 offset:8192
    ds_read_b64_tr_b16 v[154:155], v10 offset:10240
    s_waitcnt lgkmcnt(5)
    v_mfma_f32_32x32x16_bf16 v[192:207], v[128:131], v[136:139], v[192:207]
    ds_read_b128 v[156:159], v17
    ds_read_b128 v[160:163], v17 offset:4096
    s_add_u32 m0, s16, 28672
    s_add_u32 s63, s43, 61440
    buffer_load_dwordx4 v5, s[28:31], s63 offen lds
    s_waitcnt lgkmcnt(6)
    v_mfma_f32_32x32x16_bf16 v[208:223], v[128:131], v[140:143], v[208:223]
    ds_read_b128 v[164:167], v17 offset:8192
    ds_read_b128 v[168:171], v17 offset:12288
    s_add_u32 m0, s16, 36864
    s_add_u32 s63, s43, 122880
    buffer_load_dwordx4 v5, s[28:31], s63 offen lds
    s_waitcnt lgkmcnt(7)
    v_mfma_f32_32x32x16_bf16 v[224:239], v[128:131], v[144:147], v[224:239]
    ds_read_b128 v[172:175], v17 offset:16384
    s_add_u32 m0, s16, 45056
    s_add_u32 s63, s43, 184320
    buffer_load_dwordx4 v5, s[28:31], s63 offen lds
    s_waitcnt lgkmcnt(7)
    v_mfma_f32_32x32x16_bf16 v[240:255], v[128:131], v[148:151], v[240:255]
    s_cmp_lt_u32 s78, 0x7ff00000
    s_cbranch_scc0 L_c6
    buffer_load_dwordx4 v[96:99], v118, s[68:71], s78 offen
    s_add_u32 s78, s78, s0
L_c6:
    s_waitcnt lgkmcnt(4)
    v_mfma_f32_32x32x16_bf16 v[176:191], v[152:155], v[156:159], v[176:191]
    ds_read_b64_tr_b16 v[128:129], v10 offset:16384
    ds_read_b64_tr_b16 v[130:131], v10 offset:18432
    s_waitcnt lgkmcnt(5)
    v_mfma_f32_32x32x16_bf16 v[192:207], v[152:155], v[160:163], v[192:207]
    ds_read_b128 v[132:135], v18
    ds_read_b128 v[136:139], v18 offset:4096
    s_waitcnt lgkmcnt(6)
    v_mfma_f32_32x32x16_bf16 v[208:223], v[152:155], v[164:167], v[208:223]
    ds_read_b128 v[140:143], v18 offset:8192
    ds_read_b128 v[144:147], v18 offset:12288
    s_waitcnt lgkmcnt(7)
    v_mfma_f32_32x32x16_bf16 v[224:239], v[152:155], v[168:171], v[224:239]
    ds_read_b128 v[148:151], v18 offset:16384
    s_cmp_lt_u32 s78, 0x7ff00000
    s_cbranch_scc0 L_c7
    buffer_load_dwordx4 v[100:103], v118, s[68:71], s78 offen
    s_add_u32 s78, s78, s0
L_c7:
    s_waitcnt lgkmcnt(7)
    v_mfma_f32_32x32x16_bf16 v[240:255], v[152:155], v[172:175], v[240:255]
    s_cmp_lt_u32 s78, 0x7ff00000
    s_cbranch_scc0 L_c8
    buffer_load_dwordx4 v[104:107], v118, s[68:71], s78 offen
    s_add_u32 s78, s78, s0
L_c8:
    s_waitcnt lgkmcnt(4)
    v_mfma_f32_32x32x16_bf16 v[176:191], v[128:131], v[132:135], v[176:191]
    ds_read_b64_tr_b16 v[152:153], v10 offset:24576
    ds_read_b64_tr_b16 v[154:155], v10 offset:26624
    s_waitcnt lgkmcnt(5)
    v_mfma_f32_32x32x16_bf16 v[192:207], v[128:131], v[136:139], v[192:207]
    ds_read_b128 v[156:159], v19
    ds_read_b128 v[160:163], v19 offset:4096
    s_waitcnt lgkmcnt(6)
    v_mfma_f32_32x32x16_bf16 v[208:223], v[128:131], v[140:143], v[208:223]
    ds_read_b128 v[164:167], v19 offset:8192
    ds_read_b128 v[168:171], v19 offset:12288
    s_waitcnt lgkmcnt(7)
    v_mfma_f32_32x32x16_bf16 v[224:239], v[128:131], v[144:147], v[224:239]
    ds_read_b128 v[172:175], v19 offset:16384
    s_waitcnt lgkmcnt(7)
    v_mfma_f32_32x32x16_bf16 v[240:255], v[128:131], v[148:151], v[240:255]
    s_waitcnt vmcnt(6) lgkmcnt(0)
    s_barrier
    v_mfma_f32_32x32x16_bf16 v[176:191], v[152:155], v[156:159], v[176:191]
    ds_read_b64_tr_b16 v[128:129], v11
    ds_read_b64_tr_b16 v[130:131], v11 offset:2048
    v_mfma_f32_32x32x16_bf16 v[192:207], v[152:155], v[160:163], v[192:207]
    ds_read_b128 v[132:135], v20
    ds_read_b128 v[136:139], v20 offset:4096
    s_add_u32 m0, s16, 53248
    s_nop 0
    buffer_load_dwordx4 v6, s[24:27], s54 offen lds
    v_mfma_f32_32x32x16_bf16 v[208:223], v[152:155], v[164:167], v[208:223]
    ds_read_b128 v[140:143], v20 offset:8192
    ds_read_b128 v[144:147], v20 offset:12288
    s_add_u32 m0, s16, 61440
    s_nop 0
    buffer_load_dwordx4 v7, s[24:27], s54 offen lds
    v_mfma_f32_32x32x16_bf16 v[224:239], v[152:155], v[168:171], v[224:239]
    ds_read_b128 v[148:151], v20 offset:16384
    s_cmp_lt_u32 s3, 4
    s_cbranch_scc0 L_c9
    s_add_u32 m0, s16, 69632
    s_nop 0
    buffer_load_dwordx4 v8, s[24:27], s54 offen lds
L_c9:
    v_mfma_f32_32x32x16_bf16 v[240:255], v[152:155], v[172:175], v[240:255]
    s_add_u32 m0, s16, 73728
    s_nop 0
    buffer_load_dwordx4 v5, s[28:31], s44 offen lds
    s_waitcnt lgkmcnt(4)
    v_mfma_f32_32x32x16_bf16 v[176:191], v[128:131], v[132:135], v[176:191]
    ds_read_b64_tr_b16 v[152:153], v11 offset:8192
    ds_read_b64_tr_b16 v[154:155], v11 offset:10240
    s_waitcnt lgkmcnt(5)
    v_mfma_f32_32x32x16_bf16 v[192:207], v[128:131], v[136:139], v[192:207]
    ds_read_b128 v[156:159], v21
    ds_read_b128 v[160:163], v21 offset:4096
    s_add_u32 m0, s16, 81920
    s_add_u32 s63, s44, 61440
    buffer_load_dwordx4 v5, s[28:31], s63 offen lds
    s_waitcnt lgkmcnt(6)
    v_mfma_f32_32x32x16_bf16 v[208:223], v[128:131], v[140:143], v[208:223]
    ds_read_b128 v[164:167], v21 offset:8192
    ds_read_b128 v[168:171], v21 offset:12288
    s_waitcnt lgkmcnt(7)
    v_mfma_f32_32x32x16_bf16 v[224:239], v[128:131], v[144:147], v[224:239]
    ds_read_b128 v[172:175], v21 offset:16384
    s_add_u32 m0, s16, 90112
    s_add_u32 s63, s44, 122880
    buffer_load_dwordx4 v5, s[28:31], s63 offen lds
    s_waitcnt lgkmcnt(7)
    v_mfma_f32_32x32x16_bf16 v[240:255], v[128:131], v[148:151], v[240:255]
    s_add_u32 m0, s16, 98304
    s_add_u32 s63, s44, 184320
    buffer_load_dwordx4 v5, s[28:31], s63 offen lds
    s_waitcnt lgkmcnt(4)
    v_mfma_f32_32x32x16_bf16 v[176:191], v[152:155], v[156:159], v[176:191]
    ds_read_b64_tr_b16 v[128:129], v11 offset:16384
    ds_read_b64_tr_b16 v[130:131], v11 offset:18432
    s_waitcnt lgkmcnt(5)
    v_mfma_f32_32x32x16_bf16 v[192:207], v[152:155], v[160:163], v[192:207]
    ds_read_b128 v[132:135], v22
    ds_read_b128 v[136:139], v22 offset:4096
    s_waitcnt lgkmcnt(6)
    v_mfma_f32_32x32x16_bf16 v[208:223], v[152:155], v[164:167], v[208:223]
    ds_read_b128 v[140:143], v22 offset:8192
    ds_read_b128 v[144:147], v22 offset:12288
    s_waitcnt lgkmcnt(7)
    v_mfma_f32_32x32x16_bf16 v[224:239], v[152:155], v[168:171], v[224:239]
    ds_read_b128 v[148:151], v22 offset:16384
    s_cmp_lt_u32 s78, 0x7ff00000
    s_cbranch_scc0 L_c10
    buffer_load_dwordx4 v[108:111], v118, s[68:71], s78 offen
    s_add_u32 s78, s78, s0
L_c10:
    s_waitcnt lgkmcnt(7)
    v_mfma_f32_32x32x16_bf16 v[240:255], v[152:155], v[172:175], v[240:255]
    s_cmp_lt_u32 s78, 0x7ff00000
    s_cbranch_scc0 L_c11
    buffer_load_dwordx4 v[112:115], v118, s[68:71], s78 offen
L_c11:
    s_waitcnt lgkmcnt(4)
    v_mfma_f32_32x32x16_bf16 v[176:191], v[128:131], v[132:135], v[176:191]
    ds_read_b64_tr_b16 v[152:153], v11 offset:24576
    ds_read_b64_tr_b16 v[154:155], v11 offset:26624
    s_waitcnt lgkmcnt(5)
    v_mfma_f32_32x32x16_bf16 v[192:207], v[128:131], v[136:139], v[192:207]
    ds_read_b128 v[156:159], v23
    ds_read_b128 v[160:163], v23 offset:4096
    s_waitcnt lgkmcnt(6)
    v_mfma_f32_32x32x16_bf16 v[208:223], v[128:131], v[140:143], v[208:223]
    ds_read_b128 v[164:167], v23 offset:8192
    ds_read_b128 v[168:171], v23 offset:12288
    s_waitcnt lgkmcnt(7)
    v_mfma_f32_32x32x16_bf16 v[224:239], v[128:131], v[144:147], v[224:239]
    ds_read_b128 v[172:175], v23 offset:16384
    s_waitcnt lgkmcnt(7)
    v_mfma_f32_32x32x16_bf16 v[240:255], v[128:131], v[148:151], v[240:255]
    s_waitcnt vmcnt(6) lgkmcnt(0)
    s_barrier
    v_mfma_f32_32x32x16_bf16 v[176:191], v[152:155], v[156:159], v[176:191]
    ds_read_b64_tr_b16 v[128:129], v9
    ds_read_b64_tr_b16 v[130:131], v9 offset:2048
    v_mfma_f32_32x32x16_bf16 v[192:207], v[152:155], v[160:163], v[192:207]
    ds_read_b128 v[132:135], v12
    ds_read_b128 v[136:139], v12 offset:4096
    s_add_u32 m0, s16, 106496
    s_nop 0
    buffer_load_dwordx4 v6, s[24:27], s55 offen lds
    v_mfma_f32_32x32x16_bf16 v[208:223], v[152:155], v[164:167], v[208:223]
    ds_read_b128 v[140:143], v12 offset:8192
    ds_read_b128 v[144:147], v12 offset:12288
    s_add_u32 m0, s16, 114688
    s_nop 0
    buffer_load_dwordx4 v7, s[24:27], s55 offen lds
    v_mfma_f32_32x32x16_bf16 v[224:239], v[152:155], v[168:171], v[224:239]
    ds_read_b128 v[148:151], v12 offset:16384
    s_cmp_lt_u32 s3, 4
    s_cbranch_scc0 L_c12
    s_add_u32 m0, s16, 122880
    s_nop 0
    buffer_load_dwordx4 v8, s[24:27], s55 offen lds
L_c12:
    v_mfma_f32_32x32x16_bf16 v[240:255], v[152:155], v[172:175], v[240:255]
    s_add_u32 m0, s16, 126976
    s_nop 0
    buffer_load_dwordx4 v5, s[28:31], s45 offen lds
    s_waitcnt lgkmcnt(4)
    v_mfma_f32_32x32x16_bf16 v[176:191], v[128:131], v[132:135], v[176:191]
    ds_read_b64_tr_b16 v[152:153], v9 offset:8192
    ds_read_b64_tr_b16 v[154:155], v9 offset:10240
    s_waitcnt lgkmcnt(5)
    v_mfma_f32_32x32x16_bf16 v[192:207], v[128:131], v[136:139], v[192:207]
    ds_read_b128 v[156:159], v13
    ds_read_b128 v[160:163], v13 offset:4096
    s_waitcnt vmcnt(9)
    v_lshlrev_b32 v120, 16, v96
    v_and_b32 v121, 0xffff0000, v96
    v_lshlrev_b32 v122, 16, v97
    v_and_b32 v123, 0xffff0000, v97
    s_waitcnt lgkmcnt(6)
    v_mfma_f32_32x32x16_bf16 v[208:223], v[128:131], v[140:143], v[208:223]
    ds_read_b128 v[164:167], v13 offset:8192
    ds_read_b128 v[168:171], v13 offset:12288
    v_lshlrev_b32 v124, 16, v98
    v_and_b32 v125, 0xffff0000, v98
    v_lshlrev_b32 v126, 16, v99
    v_and_b32 v127, 0xffff0000, v99
    s_waitcnt lgkmcnt(7)
    v_mfma_f32_32x32x16_bf16 v[224:239], v[128:131], v[144:147], v[224:239]
    ds_read_b128 v[172:175], v13 offset:16384
    s_add_u32 m0, s16, 135168
    s_add_u32 s63, s45, 61440
    buffer_load_dwordx4 v5, s[28:31], s63 offen lds
    s_waitcnt vmcnt(10)
    v_lshlrev_b32 v96, 16, v100
    v_and_b32 v100, 0xffff0000, v100
    v_add_f32 v120, v120, v96
    s_waitcnt lgkmcnt(7)
    v_mfma_f32_32x32x16_bf16 v[240:255], v[128:131], v[148:151], v[240:255]
    s_add_u32 m0, s16, 143360
    s_add_u32 s63, s45, 122880
    buffer_load_dwordx4 v5, s[28:31], s63 offen lds
    v_add_f32 v121, v121, v100
    v_lshlrev_b32 v96, 16, v101
    v_and_b32 v101, 0xffff0000, v101
    s_waitcnt lgkmcnt(4)
    v_mfma_f32_32x32x16_bf16 v[176:191], v[152:155], v[156:159], v[176:191]
    ds_read_b64_tr_b16 v[128:129], v9 offset:16384
    ds_read_b64_tr_b16 v[130:131], v9 offset:18432
    v_add_f32 v122, v122, v96
    v_add_f32 v123, v123, v101
    v_lshlrev_b32 v96, 16, v102
    v_and_b32 v102, 0xffff0000, v102
    s_waitcnt lgkmcnt(5)
    v_mfma_f32_32x32x16_bf16 v[192:207], v[152:155], v[160:163], v[192:207]
    ds_read_b128 v[132:135], v14
    ds_read_b128 v[136:139], v14 offset:4096
    v_add_f32 v124, v124, v96
    v_add_f32 v125, v125, v102
    v_lshlrev_b32 v96, 16, v103
    v_and_b32 v103, 0xffff0000, v103
    s_waitcnt lgkmcnt(6)
    v_mfma_f32_32x32x16_bf16 v[208:223], v[152:155], v[164:167], v[208:223]
    ds_read_b128 v[140:143], v14 offset:8192
    ds_read_b128 v[144:147], v14 offset:12288
    v_add_f32 v126, v126, v96
    v_add_f32 v127, v127, v103
    s_waitcnt vmcnt(11)
    v_lshlrev_b32 v96, 16, v104
    v_and_b32 v104, 0xffff0000, v104
    s_waitcnt lgkmcnt(7)
    v_mfma_f32_32x32x16_bf16 v[224:239], v[152:155], v[168:171], v[224:239]
    ds_read_b128 v[148:151], v14 offset:16384
    s_add_u32 m0, s16, 151552
    s_add_u32 s63, s45, 184320
    buffer_load_dwordx4 v5, s[28:31], s63 offen lds
    v_add_f32 v120, v120, v96
    v_add_f32 v121, v121, v104
    v_lshlrev_b32 v96, 16, v105
    s_waitcnt lgkmcnt(7)
    v_mfma_f32_32x32x16_bf16 v[240:255], v[152:155], v[172:175], v[240:255]
    v_and_b32 v105, 0xffff0000, v105
    v_add_f32 v122, v122, v96
    v_add_f32 v123, v123, v105
    v_lshlrev_b32 v96, 16, v106
    s_waitcnt lgkmcnt(4)
    v_mfma_f32_32x32x16_bf16 v[176:191], v[128:131], v[132:135], v[176:191]
    ds_read_b64_tr_b16 v[152:153], v9 offset:24576
    ds_read_b64_tr_b16 v[154:155], v9 offset:26624
    v_and_b32 v106, 0xffff0000, v106
    v_add_f32 v124, v124, v96
    v_add_f32 v125, v125, v106
    v_lshlrev_b32 v96, 16, v107
    s_waitcnt lgkmcnt(5)
    v_mfma_f32_32x32x16_bf16 v[192:207], v[128:131], v[136:139], v[192:207]
    ds_read_b128 v[156:159], v15
    ds_read_b128 v[160:163], v15 offset:4096
    v_and_b32 v107, 0xffff0000, v107
    v_add_f32 v126, v126, v96
    v_add_f32 v127, v127, v107
    s_waitcnt vmcnt(6)
    v_lshlrev_b32 v96, 16, v108
    s_waitcnt lgkmcnt(6)
    v_mfma_f32_32x32x16_bf16 v[208:223], v[128:131], v[140:143], v[208:223]
    ds_read_b128 v[164:167], v15 offset:8192
    ds_read_b128 v[168:171], v15 offset:12288
    v_and_b32 v108, 0xffff0000, v108
    v_add_f32 v120, v120, v96
    v_add_f32 v121, v121, v108
    v_lshlrev_b32 v96, 16, v109
    s_waitcnt lgkmcnt(7)
    v_mfma_f32_32x32x16_bf16 v[224:239], v[128:131], v[144:147], v[224:239]
    ds_read_b128 v[172:175], v15 offset:16384
    v_and_b32 v109, 0xffff0000, v109
    v_add_f32 v122, v122, v96
    v_add_f32 v123, v123, v109
    v_lshlrev_b32 v96, 16, v110
    s_waitcnt lgkmcnt(7)
    v_mfma_f32_32x32x16_bf16 v[240:255], v[128:131], v[148:151], v[240:255]
    v_and_b32 v110, 0xffff0000, v110
    v_add_f32 v124, v124, v96
    v_add_f32 v125, v125, v110
    v_lshlrev_b32 v96, 16, v111
    s_waitcnt lgkmcnt(0)
    s_barrier
    v_mfma_f32_32x32x16_bf16 v[176:191], v[152:155], v[156:159], v[176:191]
    ds_read_b64_tr_b16 v[128:129], v10
    ds_read_b64_tr_b16 v[130:131], v10 offset:2048
    v_and_b32 v111, 0xffff0000, v111
    v_add_f32 v126, v126, v96
    v_add_f32 v127, v127, v111
    s_waitcnt vmcnt(6)
    v_lshlrev_b32 v96, 16, v112
    v_mfma_f32_32x32x16_bf16 v[192:207], v[152:155], v[160:163], v[192:207]
    ds_read_b128 v[132:135], v16
    ds_read_b128 v[136:139], v16 offset:4096
    s_add_u32 m0, s16, 0
    s_nop 0
    buffer_load_dwordx4 v6, s[24:27], s56 offen lds
    v_and_b32 v112, 0xffff0000, v112
    v_add_f32 v120, v120, v96
    v_add_f32 v121, v121, v112
    v_mfma_f32_32x32x16_bf16 v[208:223], v[152:155], v[164:167], v[208:223]
    ds_read_b128 v[140:143], v16 offset:8192
    ds_read_b128 v[144:147], v16 offset:12288
    s_add_u32 m0, s16, 8192
    s_nop 0
    buffer_load_dwordx4 v7, s[24:27], s56 offen lds
    v_lshlrev_b32 v96, 16, v113
    v_and_b32 v113, 0xffff0000, v113
    v_add_f32 v122, v122, v96
    v_mfma_f32_32x32x16_bf16 v[224:239], v[152:155], v[168:171], v[224:239]
    ds_read_b128 v[148:151], v16 offset:16384
    s_cmp_lt_u32 s3, 4
    s_cbranch_scc0 L_c13
    s_add_u32 m0, s16, 16384
    s_nop 0
    buffer_load_dwordx4 v8, s[24:27], s56 offen lds
L_c13:
    v_add_f32 v123, v123, v113
    v_lshlrev_b32 v96, 16, v114
    v_and_b32 v114, 0xffff0000, v114
    v_mfma_f32_32x32x16_bf16 v[240:255], v[152:155], v[172:175], v[240:255]
    s_add_u32 m0, s16, 20480
    s_nop 0
    buffer_load_dwordx4 v5, s[28:31], s46 offen lds
    v_add_f32 v124, v124, v96
    v_add_f32 v125, v125, v114
    v_lshlrev_b32 v96, 16, v115
    s_waitcnt lgkmcnt(4)
    v_mfma_f32_32x32x16_bf16 v[176:191], v[128:131], v[132:135], v[176:191]
    ds_read_b64_tr_b16 v[152:153], v10 offset:8192
    ds_read_b64_tr_b16 v[154:155], v10 offset:10240
    v_and_b32 v115, 0xffff0000, v115
    v_add_f32 v126, v126, v96
    v_add_f32 v127, v127, v115
    v_lshrrev_b32 v96, 4, v1
    s_waitcnt lgkmcnt(5)
    v_mfma_f32_32x32x16_bf16 v[192:207], v[128:131], v[136:139], v[192:207]
    ds_read_b128 v[156:159], v17
    ds_read_b128 v[160:163], v17 offset:4096
    v_lshlrev_b32 v96, 3, v96
    v_lshl_add_u32 v96, v119, 5, v96
    v_permlane32_swap_b32 v120, v124
    s_waitcnt lgkmcnt(6)
    v_mfma_f32_32x32x16_bf16 v[208:223], v[128:131], v[140:143], v[208:223]
    ds_read_b128 v[164:167], v17 offset:8192
    ds_read_b128 v[168:171], v17 offset:12288
    v_permlane32_swap_b32 v121, v125
    v_permlane32_swap_b32 v122, v126
    s_waitcnt lgkmcnt(7)
    v_mfma_f32_32x32x16_bf16 v[224:239], v[128:131], v[144:147], v[224:239]
    ds_read_b128 v[172:175], v17 offset:16384
    s_add_u32 m0, s16, 28672
    s_add_u32 s63, s46, 61440
    buffer_load_dwordx4 v5, s[28:31], s63 offen lds
    v_permlane32_swap_b32 v123, v127
    v_add_f32 v120, v120, v124
    s_waitcnt lgkmcnt(7)
    v_mfma_f32_32x32x16_bf16 v[240:255], v[128:131], v[148:151], v[240:255]
    s_add_u32 m0, s16, 36864
    s_add_u32 s63, s46, 122880
    buffer_load_dwordx4 v5, s[28:31], s63 offen lds
    v_add_f32 v121, v121, v125
    v_add_f32 v122, v122, v126
    v_add_f32 v123, v123, v127
    s_waitcnt lgkmcnt(4)
    v_mfma_f32_32x32x16_bf16 v[176:191], v[152:155], v[156:159], v[176:191]
    ds_read_b64_tr_b16 v[128:129], v10 offset:16384
    ds_read_b64_tr_b16 v[130:131], v10 offset:18432
    v_mov_b32 v97, s16
    v_lshrrev_b32 v97, 2, v97
    v_permlane16_swap_b32 v120, v122
    s_waitcnt lgkmcnt(5)
    v_mfma_f32_32x32x16_bf16 v[192:207], v[152:155], v[160:163], v[192:207]
    ds_read_b128 v[132:135], v18
    ds_read_b128 v[136:139], v18 offset:4096
    v_permlane16_swap_b32 v121, v123
    v_add_f32 v120, v120, v122
    v_add_f32 v121, v121, v123
    s_waitcnt lgkmcnt(6)
    v_mfma_f32_32x32x16_bf16 v[208:223], v[152:155], v[164:167], v[208:223]
    ds_read_b128 v[140:143], v18 offset:8192
    ds_read_b128 v[144:147], v18 offset:12288
    v_add_u32 v96, v96, v97
    v_add_u32 v96, 160768, v96
    v_add_f32_dpp v120, v120, v120 row_ror:8 row_mask:0xf bank_mask:0xf
    v_add_f32_dpp v121, v121, v121 row_ror:8 row_mask:0xf bank_mask:0xf
    s_waitcnt lgkmcnt(7)
    v_mfma_f32_32x32x16_bf16 v[224:239], v[152:155], v[168:171], v[224:239]
    ds_read_b128 v[148:151], v18 offset:16384
    s_add_u32 m0, s16, 45056
    s_add_u32 s63, s46, 184320
    buffer_load_dwordx4 v5, s[28:31], s63 offen lds
    ds_write_b64 v96, v[120:121]
    s_waitcnt lgkmcnt(8)
    v_mfma_f32_32x32x16_bf16 v[240:255], v[152:155], v[172:175], v[240:255]
    s_waitcnt lgkmcnt(5)
    v_mfma_f32_32x32x16_bf16 v[176:191], v[128:131], v[132:135], v[176:191]
    ds_read_b64_tr_b16 v[152:153], v10 offset:24576
    ds_read_b64_tr_b16 v[154:155], v10 offset:26624
    s_waitcnt lgkmcnt(6)
    v_mfma_f32_32x32x16_bf16 v[192:207], v[128:131], v[136:139], v[192:207]
    ds_read_b128 v[156:159], v19
    ds_read_b128 v[160:163], v19 offset:4096
    s_waitcnt lgkmcnt(7)
    v_mfma_f32_32x32x16_bf16 v[208:223], v[128:131], v[140:143], v[208:223]
    ds_read_b128 v[164:167], v19 offset:8192
    ds_read_b128 v[168:171], v19 offset:12288
    s_waitcnt lgkmcnt(8)
    v_mfma_f32_32x32x16_bf16 v[224:239], v[128:131], v[144:147], v[224:239]
    ds_read_b128 v[172:175], v19 offset:16384
    s_waitcnt lgkmcnt(8)
    v_mfma_f32_32x32x16_bf16 v[240:255], v[128:131], v[148:151], v[240:255]
    s_waitcnt vmcnt(6) lgkmcnt(0)
    s_barrier
    v_mfma_f32_32x32x16_bf16 v[176:191], v[152:155], v[156:159], v[176:191]
    ds_read_b64_tr_b16 v[128:129], v11
    ds_read_b64_tr_b16 v[130:131], v11 offset:2048
    s_cmp_lt_u32 s18, 0x7ff00000
    s_cbranch_scc0 L_b14
    v_lshlrev_b32 v57, 2, v1
    v_add_u32 v57, 160768, v57
    ds_read_b32 v96, v57
    ds_read_b32 v97, v57 offset:256
    ds_read_b32 v98, v57 offset:512
    ds_read_b32 v99, v57 offset:768
    ds_read_b32 v100, v57 offset:1024
    ds_read_b32 v101, v57 offset:1280
    ds_read_b32 v102, v57 offset:1536
    ds_read_b32 v103, v57 offset:1792
    s_waitcnt lgkmcnt(3)
    v_add_f32 v96, v96, v100
    s_waitcnt lgkmcnt(2)
    v_add_f32 v97, v97, v101
    s_waitcnt lgkmcnt(1)
    v_add_f32 v98, v98, v102
    s_waitcnt lgkmcnt(0)
    v_add_f32 v99, v99, v103
    v_add_f32 v96, v96, v97
    v_add_f32 v98, v98, v99
    v_add_f32 v96, v96, v98
    v_cvt_pk_bf16_f32 v100, v96, v96
    v_lshlrev_b32 v102, 16, v100
    v_sub_f32 v102, v96, v102
    v_cvt_pk_bf16_f32 v100, v96, v102
    v_mov_b32 v101, s60
    v_lshlrev_b32 v57, 3, v1
    buffer_store_dwordx2 v[100:101], v57, s[20:23], s18 offen sc1
    s_nop 1
L_b14:
    v_mfma_f32_32x32x16_bf16 v[192:207], v[152:155], v[160:163], v[192:207]
    ds_read_b128 v[132:135], v20
    ds_read_b128 v[136:139], v20 offset:4096
    s_add_u32 m0, s16, 53248
    s_nop 0
    buffer_load_dwordx4 v6, s[24:27], s57 offen lds
    v_mfma_f32_32x32x16_bf16 v[208:223], v[152:155], v[164:167], v[208:223]
    ds_read_b128 v[140:143], v20 offset:8192
    ds_read_b128 v[144:147], v20 offset:12288
    s_add_u32 m0, s16, 61440
    s_nop 0
    buffer_load_dwordx4 v7, s[24:27], s57 offen lds
    v_mfma_f32_32x32x16_bf16 v[224:239], v[152:155], v[168:171], v[224:239]
    ds_read_b128 v[148:151], v20 offset:16384
    s_cmp_lt_u32 s3, 4
    s_cbranch_scc0 L_c15
    s_add_u32 m0, s16, 69632
    s_nop 0
    buffer_load_dwordx4 v8, s[24:27], s57 offen lds
L_c15:
    v_mfma_f32_32x32x16_bf16 v[240:255], v[152:155], v[172:175], v[240:255]
    s_add_u32 m0, s16, 73728
    s_nop 0
    buffer_load_dwordx4 v5, s[28:31], s47 offen lds
    s_waitcnt lgkmcnt(4)
    v_mfma_f32_32x32x16_bf16 v[176:191], v[128:131], v[132:135], v[176:191]
    ds_read_b64_tr_b16 v[152:153], v11 offset:8192
    ds_read_b64_tr_b16 v[154:155], v11 offset:10240
    s_waitcnt lgkmcnt(5)
    v_mfma_f32_32x32x16_bf16 v[192:207], v[128:131], v[136:139], v[192:207]
    ds_read_b128 v[156:159], v21
    ds_read_b128 v[160:163], v21 offset:4096
    s_waitcnt lgkmcnt(6)
    v_mfma_f32_32x32x16_bf16 v[208:223], v[128:131], v[140:143], v[208:223]
    ds_read_b128 v[164:167], v21 offset:8192
    ds_read_b128 v[168:171], v21 offset:12288
    s_waitcnt lgkmcnt(7)
    v_mfma_f32_32x32x16_bf16 v[224:239], v[128:131], v[144:147], v[224:239]
    ds_read_b128 v[172:175], v21 offset:16384
    s_add_u32 m0, s16, 81920
    s_add_u32 s63, s47, 61440
    buffer_load_dwordx4 v5, s[28:31], s63 offen lds
    s_waitcnt lgkmcnt(7)
    v_mfma_f32_32x32x16_bf16 v[240:255], v[128:131], v[148:151], v[240:255]
    s_add_u32 m0, s16, 90112
    s_add_u32 s63, s47, 122880
    buffer_load_dwordx4 v5, s[28:31], s63 offen lds
    s_waitcnt lgkmcnt(4)
    v_mfma_f32_32x32x16_bf16 v[176:191], v[152:155], v[156:159], v[176:191]
    ds_read_b64_tr_b16 v[128:129], v11 offset:16384
    ds_read_b64_tr_b16 v[130:131], v11 offset:18432
    s_waitcnt lgkmcnt(5)
    v_mfma_f32_32x32x16_bf16 v[192:207], v[152:155], v[160:163], v[192:207]
    ds_read_b128 v[132:135], v22
    ds_read_b128 v[136:139], v22 offset:4096
    s_waitcnt lgkmcnt(6)
    v_mfma_f32_32x32x16_bf16 v[208:223], v[152:155], v[164:167], v[208:223]
    ds_read_b128 v[140:143], v22 offset:8192
    ds_read_b128 v[144:147], v22 offset:12288
    s_waitcnt lgkmcnt(7)
    v_mfma_f32_32x32x16_bf16 v[224:239], v[152:155], v[168:171], v[224:239]
    ds_read_b128 v[148:151], v22 offset:16384
    s_add_u32 m0, s16, 98304
    s_add_u32 s63, s47, 184320
    buffer_load_dwordx4 v5, s[28:31], s63 offen lds
    s_waitcnt lgkmcnt(7)
    v_mfma_f32_32x32x16_bf16 v[240:255], v[152:155], v[172:175], v[240:255]
    s_waitcnt lgkmcnt(4)
    v_mfma_f32_32x32x16_bf16 v[176:191], v[128:131], v[132:135], v[176:191]
    ds_read_b64_tr_b16 v[152:153], v11 offset:24576
    ds_read_b64_tr_b16 v[154:155], v11 offset:26624
    s_waitcnt lgkmcnt(5)
    v_mfma_f32_32x32x16_bf16 v[192:207], v[128:131], v[136:139], v[192:207]
    ds_read_b128 v[156:159], v23
    ds_read_b128 v[160:163], v23 offset:4096
    s_waitcnt lgkmcnt(6)
    v_mfma_f32_32x32x16_bf16 v[208:223], v[128:131], v[140:143], v[208:223]
    ds_read_b128 v[164:167], v23 offset:8192
    ds_read_b128 v[168:171], v23 offset:12288
    s_waitcnt lgkmcnt(7)
    v_mfma_f32_32x32x16_bf16 v[224:239], v[128:131], v[144:147], v[224:239]
    ds_read_b128 v[172:175], v23 offset:16384
    s_waitcnt lgkmcnt(7)
    v_mfma_f32_32x32x16_bf16 v[240:255], v[128:131], v[148:151], v[240:255]
    s_waitcnt vmcnt(6) lgkmcnt(0)
    s_barrier
    v_mfma_f32_32x32x16_bf16 v[176:191], v[152:155], v[156:159], v[176:191]
    ds_read_b64_tr_b16 v[128:129], v9
    ds_read_b64_tr_b16 v[130:131], v9 offset:2048
    v_mfma_f32_32x32x16_bf16 v[192:207], v[152:155], v[160:163], v[192:207]
    ds_read_b128 v[132:135], v12
    ds_read_b128 v[136:139], v12 offset:4096
    s_add_u32 m0, s16, 106496
    s_nop 0
    buffer_load_dwordx4 v6, s[24:27], s58 offen lds
    v_mfma_f32_32x32x16_bf16 v[208:223], v[152:155], v[164:167], v[208:223]
    ds_read_b128 v[140:143], v12 offset:8192
    ds_read_b128 v[144:147], v12 offset:12288
    s_add_u32 m0, s16, 114688
    s_nop 0
    buffer_load_dwordx4 v7, s[24:27], s58 offen lds
    v_mfma_f32_32x32x16_bf16 v[224:239], v[152:155], v[168:171], v[224:239]
    ds_read_b128 v[148:151], v12 offset:16384
    s_cmp_lt_u32 s3, 4
    s_cbranch_scc0 L_c16
    s_add_u32 m0, s16, 122880
    s_nop 0
    buffer_load_dwordx4 v8, s[24:27], s58 offen lds
L_c16:
    v_mfma_f32_32x32x16_bf16 v[240:255], v[152:155], v[172:175], v[240:255]
    s_add_u32 m0, s16, 126976
    s_nop 0
    buffer_load_dwordx4 v5, s[28:31], s48 offen lds
    s_waitcnt lgkmcnt(4)
    v_mfma_f32_32x32x16_bf16 v[176:191], v[128:131], v[132:135], v[176:191]
    ds_read_b64_tr_b16 v[152:153], v9 offset:8192
    ds_read_b64_tr_b16 v[154:155], v9 offset:10240
    s_waitcnt lgkmcnt(5)
    v_mfma_f32_32x32x16_bf16 v[192:207], v[128:131], v[136:139], v[192:207]
    ds_read_b128 v[156:159], v13
    ds_read_b128 v[160:163], v13 offset:4096
    s_waitcnt lgkmcnt(6)
    v_mfma_f32_32x32x16_bf16 v[208:223], v[128:131], v[140:143], v[208:223]
    ds_read_b128 v[164:167], v13 offset:8192
    ds_read_b128 v[168:171], v13 offset:12288
    s_waitcnt lgkmcnt(7)
    v_mfma_f32_32x32x16_bf16 v[224:239], v[128:131], v[144:147], v[224:239]
    ds_read_b128 v[172:175], v13 offset:16384
    s_add_u32 m0, s16, 135168
    s_add_u32 s63, s48, 61440
    buffer_load_dwordx4 v5, s[28:31], s63 offen lds
    s_waitcnt lgkmcnt(7)
    v_mfma_f32_32x32x16_bf16 v[240:255], v[128:131], v[148:151], v[240:255]
    s_add_u32 m0, s16, 143360
    s_add_u32 s63, s48, 122880
    buffer_load_dwordx4 v5, s[28:31], s63 offen lds
    s_waitcnt lgkmcnt(4)
    v_mfma_f32_32x32x16_bf16 v[176:191], v[152:155], v[156:159], v[176:191]
    ds_read_b64_tr_b16 v[128:129], v9 offset:16384
    ds_read_b64_tr_b16 v[130:131], v9 offset:18432
    s_waitcnt lgkmcnt(5)
    v_mfma_f32_32x32x16_bf16 v[192:207], v[152:155], v[160:163], v[192:207]
    ds_read_b128 v[132:135], v14
    ds_read_b128 v[136:139], v14 offset:4096
    s_waitcnt lgkmcnt(6)
    v_mfma_f32_32x32x16_bf16 v[208:223], v[152:155], v[164:167], v[208:223]
    ds_read_b128 v[140:143], v14 offset:8192
    ds_read_b128 v[144:147], v14 offset:12288
    s_waitcnt lgkmcnt(7)
    v_mfma_f32_32x32x16_bf16 v[224:239], v[152:155], v[168:171], v[224:239]
    ds_read_b128 v[148:151], v14 offset:16384
    s_add_u32 m0, s16, 151552
    s_add_u32 s63, s48, 184320
    buffer_load_dwordx4 v5, s[28:31], s63 offen lds
    s_waitcnt lgkmcnt(7)
    v_mfma_f32_32x32x16_bf16 v[240:255], v[152:155], v[172:175], v[240:255]
    s_waitcnt lgkmcnt(4)
    v_mfma_f32_32x32x16_bf16 v[176:191], v[128:131], v[132:135], v[176:191]
    ds_read_b64_tr_b16 v[152:153], v9 offset:24576
    ds_read_b64_tr_b16 v[154:155], v9 offset:26624
    s_waitcnt lgkmcnt(5)
    v_mfma_f32_32x32x16_bf16 v[192:207], v[128:131], v[136:139], v[192:207]
    ds_read_b128 v[156:159], v15
    ds_read_b128 v[160:163], v15 offset:4096
    s_waitcnt lgkmcnt(6)
    v_mfma_f32_32x32x16_bf16 v[208:223], v[128:131], v[140:143], v[208:223]
    ds_read_b128 v[164:167], v15 offset:8192
    ds_read_b128 v[168:171], v15 offset:12288
    s_waitcnt lgkmcnt(7)
    v_mfma_f32_32x32x16_bf16 v[224:239], v[128:131], v[144:147], v[224:239]
    ds_read_b128 v[172:175], v15 offset:16384
    s_waitcnt lgkmcnt(7)
    v_mfma_f32_32x32x16_bf16 v[240:255], v[128:131], v[148:151], v[240:255]
    s_waitcnt vmcnt(6) lgkmcnt(0)
    s_barrier
    v_mfma_f32_32x32x16_bf16 v[176:191], v[152:155], v[156:159], v[176:191]
    ds_read_b64_tr_b16 v[128:129], v10
    ds_read_b64_tr_b16 v[130:131], v10 offset:2048
    v_mfma_f32_32x32x16_bf16 v[192:207], v[152:155], v[160:163], v[192:207]
    ds_read_b128 v[132:135], v16
    ds_read_b128 v[136:139], v16 offset:4096
    s_add_u32 m0, s16, 0
    s_nop 0
    buffer_load_dwordx4 v6, s[24:27], s59 offen lds
    v_mfma_f32_32x32x16_bf16 v[208:223], v[152:155], v[164:167], v[208:223]
    ds_read_b128 v[140:143], v16 offset:8192
    ds_read_b128 v[144:147], v16 offset:12288
    s_add_u32 m0, s16, 8192
    s_nop 0
    buffer_load_dwordx4 v7, s[24:27], s59 offen lds
    v_mfma_f32_32x32x16_bf16 v[224:239], v[152:155], v[168:171], v[224:239]
    ds_read_b128 v[148:151], v16 offset:16384
    s_cmp_lt_u32 s3, 4
    s_cbranch_scc0 L_c17
    s_add_u32 m0, s16, 16384
    s_nop 0
    buffer_load_dwordx4 v8, s[24:27], s59 offen lds
L_c17:
    v_mfma_f32_32x32x16_bf16 v[240:255], v[152:155], v[172:175], v[240:255]
    s_add_u32 m0, s16, 20480
    s_nop 0
    buffer_load_dwordx4 v5, s[28:31], s49 offen lds
    s_waitcnt lgkmcnt(4)
    v_mfma_f32_32x32x16_bf16 v[176:191], v[128:131], v[132:135], v[176:191]
    ds_read_b64_tr_b16 v[152:153], v10 offset:8192
    ds_read_b64_tr_b16 v[154:155], v10 offset:10240
    s_waitcnt lgkmcnt(5)
    v_mfma_f32_32x32x16_bf16 v[192:207], v[128:131], v[136:139], v[192:207]
    ds_read_b128 v[156:159], v17
    ds_read_b128 v[160:163], v17 offset:4096
    s_waitcnt lgkmcnt(6)
    v_mfma_f32_32x32x16_bf16 v[208:223], v[128:131], v[140:143], v[208:223]
    ds_read_b128 v[164:167], v17 offset:8192
    ds_read_b128 v[168:171], v17 offset:12288
    s_waitcnt lgkmcnt(7)
    v_mfma_f32_32x32x16_bf16 v[224:239], v[128:131], v[144:147], v[224:239]
    ds_read_b128 v[172:175], v17 offset:16384
    s_add_u32 m0, s16, 28672
    s_add_u32 s63, s49, 61440
    buffer_load_dwordx4 v5, s[28:31], s63 offen lds
    s_waitcnt lgkmcnt(7)
    v_mfma_f32_32x32x16_bf16 v[240:255], v[128:131], v[148:151], v[240:255]
    s_add_u32 m0, s16, 36864
    s_add_u32 s63, s49, 122880
    buffer_load_dwordx4 v5, s[28:31], s63 offen lds
    s_waitcnt lgkmcnt(4)
    v_mfma_f32_32x32x16_bf16 v[176:191], v[152:155], v[156:159], v[176:191]
    ds_read_b64_tr_b16 v[128:129], v10 offset:16384
    ds_read_b64_tr_b16 v[130:131], v10 offset:18432
    s_waitcnt lgkmcnt(5)
    v_mfma_f32_32x32x16_bf16 v[192:207], v[152:155], v[160:163], v[192:207]
    ds_read_b128 v[132:135], v18
    ds_read_b128 v[136:139], v18 offset:4096
    s_waitcnt lgkmcnt(6)
    v_mfma_f32_32x32x16_bf16 v[208:223], v[152:155], v[164:167], v[208:223]
    ds_read_b128 v[140:143], v18 offset:8192
    ds_read_b128 v[144:147], v18 offset:12288
    s_waitcnt lgkmcnt(7)
    v_mfma_f32_32x32x16_bf16 v[224:239], v[152:155], v[168:171], v[224:239]
    ds_read_b128 v[148:151], v18 offset:16384
    s_add_u32 m0, s16, 45056
    s_add_u32 s63, s49, 184320
    buffer_load_dwordx4 v5, s[28:31], s63 offen lds
    s_waitcnt lgkmcnt(7)
    v_mfma_f32_32x32x16_bf16 v[240:255], v[152:155], v[172:175], v[240:255]
    s_waitcnt lgkmcnt(4)
    v_mfma_f32_32x32x16_bf16 v[176:191], v[128:131], v[132:135], v[176:191]
    ds_read_b64_tr_b16 v[152:153], v10 offset:24576
    ds_read_b64_tr_b16 v[154:155], v10 offset:26624
    s_waitcnt lgkmcnt(5)
    v_mfma_f32_32x32x16_bf16 v[192:207], v[128:131], v[136:139], v[192:207]
    ds_read_b128 v[156:159], v19
    ds_read_b128 v[160:163], v19 offset:4096
    s_waitcnt lgkmcnt(6)
    v_mfma_f32_32x32x16_bf16 v[208:223], v[128:131], v[140:143], v[208:223]
    ds_read_b128 v[164:167], v19 offset:8192
    ds_read_b128 v[168:171], v19 offset:12288
    s_waitcnt lgkmcnt(7)
    v_mfma_f32_32x32x16_bf16 v[224:239], v[128:131], v[144:147], v[224:239]
    ds_read_b128 v[172:175], v19 offset:16384
    s_waitcnt lgkmcnt(7)
    v_mfma_f32_32x32x16_bf16 v[240:255], v[128:131], v[148:151], v[240:255]
    s_waitcnt vmcnt(6) lgkmcnt(0)
    s_barrier
    v_mfma_f32_32x32x16_bf16 v[176:191], v[152:155], v[156:159], v[176:191]
    ds_read_b64_tr_b16 v[128:129], v11
    ds_read_b64_tr_b16 v[130:131], v11 offset:2048
    v_mfma_f32_32x32x16_bf16 v[192:207], v[152:155], v[160:163], v[192:207]
    ds_read_b128 v[132:135], v20
    ds_read_b128 v[136:139], v20 offset:4096
    v_mfma_f32_32x32x16_bf16 v[208:223], v[152:155], v[164:167], v[208:223]
    ds_read_b128 v[140:143], v20 offset:8192
    ds_read_b128 v[144:147], v20 offset:12288
    v_mfma_f32_32x32x16_bf16 v[224:239], v[152:155], v[168:171], v[224:239]
    ds_read_b128 v[148:151], v20 offset:16384
    v_mfma_f32_32x32x16_bf16 v[240:255], v[152:155], v[172:175], v[240:255]
    s_waitcnt lgkmcnt(4)
    v_mfma_f32_32x32x16_bf16 v[176:191], v[128:131], v[132:135], v[176:191]
    ds_read_b64_tr_b16 v[152:153], v11 offset:8192
    ds_read_b64_tr_b16 v[154:155], v11 offset:10240
    s_waitcnt lgkmcnt(5)
    v_mfma_f32_32x32x16_bf16 v[192:207], v[128:131], v[136:139], v[192:207]
    ds_read_b128 v[156:159], v21
    ds_read_b128 v[160:163], v21 offset:4096
    s_waitcnt lgkmcnt(6)
    v_mfma_f32_32x32x16_bf16 v[208:223], v[128:131], v[140:143], v[208:223]
    ds_read_b128 v[164:167], v21 offset:8192
    ds_read_b128 v[168:171], v21 offset:12288
    s_waitcnt lgkmcnt(7)
    v_mfma_f32_32x32x16_bf16 v[224:239], v[128:131], v[144:147], v[224:239]
    ds_read_b128 v[172:175], v21 offset:16384
    s_waitcnt lgkmcnt(7)
    v_mfma_f32_32x32x16_bf16 v[240:255], v[128:131], v[148:151], v[240:255]
    s_waitcnt lgkmcnt(4)
    v_mfma_f32_32x32x16_bf16 v[176:191], v[152:155], v[156:159], v[176:191]
    ds_read_b64_tr_b16 v[128:129], v11 offset:16384
    ds_read_b64_tr_b16 v[130:131], v11 offset:18432
    s_waitcnt lgkmcnt(5)
    v_mfma_f32_32x32x16_bf16 v[192:207], v[152:155], v[160:163], v[192:207]
    ds_read_b128 v[132:135], v22
    ds_read_b128 v[136:139], v22 offset:4096
    s_waitcnt lgkmcnt(6)
    v_mfma_f32_32x32x16_bf16 v[208:223], v[152:155], v[164:167], v[208:223]
    ds_read_b128 v[140:143], v22 offset:8192
    ds_read_b128 v[144:147], v22 offset:12288
    s_waitcnt lgkmcnt(7)
    v_mfma_f32_32x32x16_bf16 v[224:239], v[152:155], v[168:171], v[224:239]
    ds_read_b128 v[148:151], v22 offset:16384
    s_waitcnt lgkmcnt(7)
    v_mfma_f32_32x32x16_bf16 v[240:255], v[152:155], v[172:175], v[240:255]
    s_waitcnt lgkmcnt(4)
    v_mfma_f32_32x32x16_bf16 v[176:191], v[128:131], v[132:135], v[176:191]
    ds_read_b64_tr_b16 v[152:153], v11 offset:24576
    ds_read_b64_tr_b16 v[154:155], v11 offset:26624
    s_waitcnt lgkmcnt(5)
    v_mfma_f32_32x32x16_bf16 v[192:207], v[128:131], v[136:139], v[192:207]
    ds_read_b128 v[156:159], v23
    ds_read_b128 v[160:163], v23 offset:4096
    s_waitcnt lgkmcnt(6)
    v_mfma_f32_32x32x16_bf16 v[208:223], v[128:131], v[140:143], v[208:223]
    ds_read_b128 v[164:167], v23 offset:8192
    ds_read_b128 v[168:171], v23 offset:12288
    s_waitcnt lgkmcnt(7)
    v_mfma_f32_32x32x16_bf16 v[224:239], v[128:131], v[144:147], v[224:239]
    ds_read_b128 v[172:175], v23 offset:16384
    s_waitcnt lgkmcnt(7)
    v_mfma_f32_32x32x16_bf16 v[240:255], v[128:131], v[148:151], v[240:255]
    s_waitcnt vmcnt(0) lgkmcnt(0)
    s_barrier
    v_mfma_f32_32x32x16_bf16 v[176:191], v[152:155], v[156:159], v[176:191]
    ds_read_b64_tr_b16 v[128:129], v9
    ds_read_b64_tr_b16 v[130:131], v9 offset:2048
    v_mfma_f32_32x32x16_bf16 v[192:207], v[152:155], v[160:163], v[192:207]
    ds_read_b128 v[132:135], v12
    ds_read_b128 v[136:139], v12 offset:4096
    buffer_load_dwordx4 v[24:27], v87, s[36:39], 0 offen sc1
    v_mfma_f32_32x32x16_bf16 v[208:223], v[152:155], v[164:167], v[208:223]
    ds_read_b128 v[140:143], v12 offset:8192
    ds_read_b128 v[144:147], v12 offset:12288
    buffer_load_dwordx4 v[28:31], v88, s[36:39], 0 offen sc1
    v_mfma_f32_32x32x16_bf16 v[224:239], v[152:155], v[168:171], v[224:239]
    ds_read_b128 v[148:151], v12 offset:16384
    buffer_load_dwordx4 v[32:35], v89, s[36:39], 0 offen sc1
    v_mfma_f32_32x32x16_bf16 v[240:255], v[152:155], v[172:175], v[240:255]
    buffer_load_dwordx4 v[36:39], v90, s[36:39], 0 offen sc1
    s_waitcnt lgkmcnt(4)
    v_mfma_f32_32x32x16_bf16 v[176:191], v[128:131], v[132:135], v[176:191]
    ds_read_b64_tr_b16 v[152:153], v9 offset:8192
    ds_read_b64_tr_b16 v[154:155], v9 offset:10240
    s_waitcnt lgkmcnt(5)
    v_mfma_f32_32x32x16_bf16 v[192:207], v[128:131], v[136:139], v[192:207]
    ds_read_b128 v[156:159], v13
    ds_read_b128 v[160:163], v13 offset:4096
    s_waitcnt lgkmcnt(6)
    v_mfma_f32_32x32x16_bf16 v[208:223], v[128:131], v[140:143], v[208:223]
    ds_read_b128 v[164:167], v13 offset:8192
    ds_read_b128 v[168:171], v13 offset:12288
    s_waitcnt lgkmcnt(7)
    v_mfma_f32_32x32x16_bf16 v[224:239], v[128:131], v[144:147], v[224:239]
    ds_read_b128 v[172:175], v13 offset:16384
    buffer_load_dwordx4 v[40:43], v91, s[36:39], 0 offen sc1
    s_waitcnt lgkmcnt(7)
    v_mfma_f32_32x32x16_bf16 v[240:255], v[128:131], v[148:151], v[240:255]
    buffer_load_dwordx2 v[44:45], v58, s[20:23], s12 offen sc1
    s_waitcnt lgkmcnt(4)
    v_mfma_f32_32x32x16_bf16 v[176:191], v[152:155], v[156:159], v[176:191]
    ds_read_b64_tr_b16 v[128:129], v9 offset:16384
    ds_read_b64_tr_b16 v[130:131], v9 offset:18432
    s_waitcnt lgkmcnt(5)
    v_mfma_f32_32x32x16_bf16 v[192:207], v[152:155], v[160:163], v[192:207]
    ds_read_b128 v[132:135], v14
    ds_read_b128 v[136:139], v14 offset:4096
    s_waitcnt lgkmcnt(6)
    v_mfma_f32_32x32x16_bf16 v[208:223], v[152:155], v[164:167], v[208:223]
    ds_read_b128 v[140:143], v14 offset:8192
    ds_read_b128 v[144:147], v14 offset:12288
    s_waitcnt lgkmcnt(7)
    v_mfma_f32_32x32x16_bf16 v[224:239], v[152:155], v[168:171], v[224:239]
    ds_read_b128 v[148:151], v14 offset:16384
    s_mov_b32 s9, 15073280
    s_mov_b32 exec_lo, 0
    s_mov_b32 exec_hi, 67108863
    buffer_load_dword v3, v2, s[20:23], s9 offen sc1
    s_mov_b64 exec, -1
    s_waitcnt lgkmcnt(7)
    v_mfma_f32_32x32x16_bf16 v[240:255], v[152:155], v[172:175], v[240:255]
    s_waitcnt lgkmcnt(4)
    v_mfma_f32_32x32x16_bf16 v[176:191], v[128:131], v[132:135], v[176:191]
    ds_read_b64_tr_b16 v[152:153], v9 offset:24576
    ds_read_b64_tr_b16 v[154:155], v9 offset:26624
    s_waitcnt lgkmcnt(5)
    v_mfma_f32_32x32x16_bf16 v[192:207], v[128:131], v[136:139], v[192:207]
    ds_read_b128 v[156:159], v15
    ds_read_b128 v[160:163], v15 offset:4096
    s_waitcnt lgkmcnt(6)
    v_mfma_f32_32x32x16_bf16 v[208:223], v[128:131], v[140:143], v[208:223]
    ds_read_b128 v[164:167], v15 offset:8192
    ds_read_b128 v[168:171], v15 offset:12288
    s_waitcnt lgkmcnt(7)
    v_mfma_f32_32x32x16_bf16 v[224:239], v[128:131], v[144:147], v[224:239]
    ds_read_b128 v[172:175], v15 offset:16384
    s_waitcnt lgkmcnt(7)
    v_mfma_f32_32x32x16_bf16 v[240:255], v[128:131], v[148:151], v[240:255]
    s_waitcnt vmcnt(6)
    v_xor_b32 v57, s60, v25
    s_waitcnt vmcnt(5)
    v_bitop3_b32 v57, v57, v29, s60 bitop3:0xf6
    s_waitcnt vmcnt(4)
    v_bitop3_b32 v57, v57, v33, s60 bitop3:0xf6
    s_waitcnt vmcnt(3)
    v_bitop3_b32 v57, v57, v37, s60 bitop3:0xf6
    s_waitcnt vmcnt(2)
    v_bitop3_b32 v57, v57, v41, s60 bitop3:0xf6
    s_waitcnt vmcnt(1)
    v_bitop3_b32 v57, v57, v45, s60 bitop3:0xf6
    v_cmp_ne_u32 vcc, 0, v57
    s_nop 1
    s_cmp_lg_u64 vcc, 0
    s_cbranch_scc0 L_ck1_ok
L_ck1_sp:
    s_sleep 2
    buffer_load_dwordx4 v[24:27], v87, s[36:39], 0 offen sc1
    buffer_load_dwordx4 v[28:31], v88, s[36:39], 0 offen sc1
    buffer_load_dwordx4 v[32:35], v89, s[36:39], 0 offen sc1
    buffer_load_dwordx4 v[36:39], v90, s[36:39], 0 offen sc1
    buffer_load_dwordx4 v[40:43], v91, s[36:39], 0 offen sc1
    buffer_load_dwordx2 v[44:45], v58, s[20:23], s12 offen sc1
    s_waitcnt vmcnt(0)
    s_add_u32 s75, s75, 1
    s_cmp_gt_u32 s75, 30000
    s_cbranch_scc1 L_ck1_ok
    v_xor_b32 v57, s60, v25
    s_nop 3
    v_bitop3_b32 v57, v57, v29, s60 bitop3:0xf6
    s_nop 3
    v_bitop3_b32 v57, v57, v33, s60 bitop3:0xf6
    s_nop 3
    v_bitop3_b32 v57, v57, v37, s60 bitop3:0xf6
    s_nop 3
    v_bitop3_b32 v57, v57, v41, s60 bitop3:0xf6
    s_nop 3
    v_bitop3_b32 v57, v57, v45, s60 bitop3:0xf6
    s_nop 3
    v_cmp_ne_u32 vcc, 0, v57
    s_nop 3
    s_cmp_lg_u64 vcc, 0
    s_nop 3
    s_cbranch_scc1 L_ck1_sp
L_ck1_ok:
    s_waitcnt lgkmcnt(4)
    v_mfma_f32_32x32x16_bf16 v[176:191], v[152:155], v[156:159], v[176:191]
    v_perm_b32 v45, v44, v44, s62
    v_perm_b32 v44, v44, v44, s61
    v_mov_b32 v25, v24
    v_mov_b32 v29, v28
    s_waitcnt lgkmcnt(3)
    v_mfma_f32_32x32x16_bf16 v[192:207], v[152:155], v[160:163], v[192:207]
    v_mov_b32 v33, v32
    v_mov_b32 v37, v36
    v_mov_b32 v41, v40
    s_waitcnt lgkmcnt(2)
    v_mfma_f32_32x32x16_bf16 v[208:223], v[152:155], v[164:167], v[208:223]
    s_waitcnt lgkmcnt(1)
    v_mfma_f32_32x32x16_bf16 v[224:239], v[152:155], v[168:171], v[224:239]
    s_waitcnt lgkmcnt(0)
    v_mfma_f32_32x32x16_bf16 v[240:255], v[152:155], v[172:175], v[240:255]
    v_mfma_f32_32x32x8_bf16 v[176:191], v[44:45], v[24:25], v[176:191]
    v_mfma_f32_32x32x8_bf16 v[192:207], v[44:45], v[28:29], v[192:207]
    s_nop 3
    v_mfma_f32_32x32x8_bf16 v[208:223], v[44:45], v[32:33], v[208:223]
    s_nop 0
    v_mfma_f32_32x32x8_bf16 v[224:239], v[44:45], v[36:37], v[224:239]
    s_nop 0
    v_mfma_f32_32x32x8_bf16 v[240:255], v[44:45], v[40:41], v[240:255]
    s_waitcnt vmcnt(0)
    v_cmp_ne_u32 vcc, s60, v3
    s_nop 1
    s_and_b32 vcc_hi, vcc_hi, 67108863
    s_cbranch_scc0 L_ck2_ok
L_ck2_sp:
    s_sleep 2
    s_mov_b32 s9, 15073280
    s_mov_b32 exec_lo, 0
    s_mov_b32 exec_hi, 67108863
    buffer_load_dword v3, v2, s[20:23], s9 offen sc1
    s_mov_b64 exec, -1
    s_waitcnt vmcnt(0)
    s_add_u32 s75, s75, 1
    s_cmp_gt_u32 s75, 30000
    s_cbranch_scc1 L_ck2_ok
    v_cmp_ne_u32 vcc, s60, v3
    s_nop 3
    s_and_b32 vcc_hi, vcc_hi, 67108863
    s_nop 3
    s_cbranch_scc1 L_ck2_sp
L_ck2_ok:
    s_add_u32 s9, s73, 43008
    s_add_u32 m0, s16, 57344
    s_nop 0
    buffer_load_dwordx4 v0, s[20:23], s9 offen sc1 lds
    v_mul_f32 v176, v176, v26
    v_mul_f32 v177, v177, v26
    v_mul_f32 v178, v178, v26
    v_mul_f32 v179, v179, v26
    v_cvt_pk_bf16_f32 v176, v176, v177
    v_cvt_pk_bf16_f32 v177, v178, v179
    ds_write_b64 v46, v[176:177]
    s_add_u32 s9, s73, 44032
    s_add_u32 m0, s16, 65536
    s_nop 0
    buffer_load_dwordx4 v0, s[20:23], s9 offen sc1 lds
    v_mul_f32 v180, v180, v26
    v_mul_f32 v181, v181, v26
    v_mul_f32 v182, v182, v26
    v_mul_f32 v183, v183, v26
    v_cvt_pk_bf16_f32 v180, v180, v181
    v_cvt_pk_bf16_f32 v181, v182, v183
    ds_write_b64 v47, v[180:181]
    s_add_u32 s9, s73, 45056
    s_add_u32 m0, s16, 73728
    s_nop 0
    buffer_load_dwordx4 v0, s[20:23], s9 offen sc1 lds
    v_mul_f32 v184, v184, v26
    v_mul_f32 v185, v185, v26
    v_mul_f32 v186, v186, v26
    v_mul_f32 v187, v187, v26
    v_cvt_pk_bf16_f32 v184, v184, v185
    v_cvt_pk_bf16_f32 v185, v186, v187
    ds_write_b64 v48, v[184:185]
    v_mul_f32 v188, v188, v26
    v_mul_f32 v189, v189, v26
    v_mul_f32 v190, v190, v26
    v_mul_f32 v191, v191, v26
    v_cvt_pk_bf16_f32 v188, v188, v189
    v_cvt_pk_bf16_f32 v189, v190, v191
    ds_write_b64 v49, v[188:189]
    s_add_u32 s9, s73, 81920
    buffer_load_dwordx4 v[132:135], v0, s[20:23], s9 offen sc1
    v_mul_f32 v192, v192, v30
    v_mul_f32 v193, v193, v30
    v_mul_f32 v194, v194, v30
    v_mul_f32 v195, v195, v30
    v_cvt_pk_bf16_f32 v192, v192, v193
    v_cvt_pk_bf16_f32 v193, v194, v195
    ds_write_b64 v46, v[192:193] offset:640
    s_add_u32 s9, s73, 82944
    buffer_load_dwordx4 v[136:139], v0, s[20:23], s9 offen sc1
    v_mul_f32 v196, v196, v30
    v_mul_f32 v197, v197, v30
    v_mul_f32 v198, v198, v30
    v_mul_f32 v199, v199, v30
    v_cvt_pk_bf16_f32 v196, v196, v197
    v_cvt_pk_bf16_f32 v197, v198, v199
    ds_write_b64 v47, v[196:197] offset:640
    s_add_u32 s9, s73, 83968
    buffer_load_dwordx4 v[140:143], v0, s[20:23], s9 offen sc1
    v_mul_f32 v200, v200, v30
    v_mul_f32 v201, v201, v30
    v_mul_f32 v202, v202, v30
    v_mul_f32 v203, v203, v30
    v_cvt_pk_bf16_f32 v200, v200, v201
    v_cvt_pk_bf16_f32 v201, v202, v203
    ds_write_b64 v48, v[200:201] offset:640
    v_mul_f32 v204, v204, v30
    v_mul_f32 v205, v205, v30
    v_mul_f32 v206, v206, v30
    v_mul_f32 v207, v207, v30
    v_cvt_pk_bf16_f32 v204, v204, v205
    v_cvt_pk_bf16_f32 v205, v206, v207
    ds_write_b64 v49, v[204:205] offset:640
    s_add_u32 s9, s73, 84992
    buffer_load_dwordx4 v[144:147], v0, s[20:23], s9 offen sc1
    v_mul_f32 v208, v208, v34
    v_mul_f32 v209, v209, v34
    v_mul_f32 v210, v210, v34
    v_mul_f32 v211, v211, v34
    v_cvt_pk_bf16_f32 v208, v208, v209
    v_cvt_pk_bf16_f32 v209, v210, v211
    ds_write_b64 v46, v[208:209] offset:1280
    s_add_u32 s9, s73, 86016
    buffer_load_dwordx4 v[148:151], v0, s[20:23], s9 offen sc1
    v_mul_f32 v212, v212, v34
    v_mul_f32 v213, v213, v34
    v_mul_f32 v214, v214, v34
    v_mul_f32 v215, v215, v34
    v_cvt_pk_bf16_f32 v212, v212, v213
    v_cvt_pk_bf16_f32 v213, v214, v215
    ds_write_b64 v47, v[212:213] offset:1280
    s_add_u32 s9, s73, 122880
    buffer_load_dwordx4 v[152:155], v0, s[20:23], s9 offen sc1
    v_mul_f32 v216, v216, v34
    v_mul_f32 v217, v217, v34
    v_mul_f32 v218, v218, v34
    v_mul_f32 v219, v219, v34
    v_cvt_pk_bf16_f32 v216, v216, v217
    v_cvt_pk_bf16_f32 v217, v218, v219
    ds_write_b64 v48, v[216:217] offset:1280
    v_mul_f32 v220, v220, v34
    v_mul_f32 v221, v221, v34
    v_mul_f32 v222, v222, v34
    v_mul_f32 v223, v223, v34
    v_cvt_pk_bf16_f32 v220, v220, v221
    v_cvt_pk_bf16_f32 v221, v222, v223
    ds_write_b64 v49, v[220:221] offset:1280
    s_add_u32 s9, s73, 123904
    buffer_load_dwordx4 v[156:159], v0, s[20:23], s9 offen sc1
    v_mul_f32 v224, v224, v38
    v_mul_f32 v225, v225, v38
    v_mul_f32 v226, v226, v38
    v_mul_f32 v227, v227, v38
    v_cvt_pk_bf16_f32 v224, v224, v225
    v_cvt_pk_bf16_f32 v225, v226, v227
    ds_write_b64 v46, v[224:225] offset:1920
    s_add_u32 s9, s73, 124928
    buffer_load_dwordx4 v[160:163], v0, s[20:23], s9 offen sc1
    v_mul_f32 v228, v228, v38
    v_mul_f32 v229, v229, v38
    v_mul_f32 v230, v230, v38
    v_mul_f32 v231, v231, v38
    v_cvt_pk_bf16_f32 v228, v228, v229
    v_cvt_pk_bf16_f32 v229, v230, v231
    ds_write_b64 v47, v[228:229] offset:1920
    s_add_u32 s9, s73, 125952
    buffer_load_dwordx4 v[164:167], v0, s[20:23], s9 offen sc1
    v_mul_f32 v232, v232, v38
    v_mul_f32 v233, v233, v38
    v_mul_f32 v234, v234, v38
    v_mul_f32 v235, v235, v38
    v_cvt_pk_bf16_f32 v232, v232, v233
    v_cvt_pk_bf16_f32 v233, v234, v235
    ds_write_b64 v48, v[232:233] offset:1920
    v_mul_f32 v236, v236, v38
    v_mul_f32 v237, v237, v38
    v_mul_f32 v238, v238, v38
    v_mul_f32 v239, v239, v38
    v_cvt_pk_bf16_f32 v236, v236, v237
    v_cvt_pk_bf16_f32 v237, v238, v239
    ds_write_b64 v49, v[236:237] offset:1920
    s_add_u32 s9, s73, 126976
    buffer_load_dwordx4 v[168:171], v0, s[20:23], s9 offen sc1
    v_mul_f32 v240, v240, v42
    v_mul_f32 v241, v241, v42
    v_mul_f32 v242, v242, v42
    v_mul_f32 v243, v243, v42
    v_cvt_pk_bf16_f32 v240, v240, v241
    v_cvt_pk_bf16_f32 v241, v242, v243
    ds_write_b64 v46, v[240:241] offset:2560
    v_mul_f32 v244, v244, v42
    v_mul_f32 v245, v245, v42
    v_mul_f32 v246, v246, v42
    v_mul_f32 v247, v247, v42
    v_cvt_pk_bf16_f32 v244, v244, v245
    v_cvt_pk_bf16_f32 v245, v246, v247
    ds_write_b64 v47, v[244:245] offset:2560
    v_mul_f32 v248, v248, v42
    v_mul_f32 v249, v249, v42
    v_mul_f32 v250, v250, v42
    v_mul_f32 v251, v251, v42
    v_cvt_pk_bf16_f32 v248, v248, v249
    v_cvt_pk_bf16_f32 v249, v250, v251
    ds_write_b64 v48, v[248:249] offset:2560
    v_mul_f32 v252, v252, v42
    v_mul_f32 v253, v253, v42
    v_mul_f32 v254, v254, v42
    v_mul_f32 v255, v255, v42
    v_cvt_pk_bf16_f32 v252, v252, v253
    v_cvt_pk_bf16_f32 v253, v254, v255
    ds_write_b64 v49, v[252:253] offset:2560
    s_mov_b32 s9, 15079424
    s_mov_b32 exec_lo, 511
    s_mov_b32 exec_hi, 0
    buffer_load_dword v57, v2, s[20:23], s9 offen sc1
    s_mov_b64 exec, -1
    s_waitcnt lgkmcnt(0)
    s_barrier
    ds_read_b64 v[176:177], v77
    ds_read_b64 v[178:179], v78
    ds_read_b64 v[196:197], v77 offset:25600
    ds_read_b64 v[198:199], v78 offset:25600
    ds_read_b64 v[180:181], v77 offset:640
    ds_read_b64 v[182:183], v78 offset:640
    ds_read_b64 v[200:201], v77 offset:26240
    ds_read_b64 v[202:203], v78 offset:26240
    ds_read_b64 v[184:185], v77 offset:1280
    ds_read_b64 v[186:187], v78 offset:1280
    ds_read_b64 v[204:205], v77 offset:26880
    ds_read_b64 v[206:207], v78 offset:26880
    ds_read_b64 v[188:189], v77 offset:1920
    ds_read_b64 v[190:191], v78 offset:1920
    ds_read_b64 v[208:209], v77 offset:27520
    ds_read_b64 v[210:211], v78 offset:27520
    ds_read_b64 v[192:193], v77 offset:2560
    ds_read_b64 v[194:195], v78 offset:2560
    ds_read_b64 v[212:213], v77 offset:28160
    ds_read_b64 v[214:215], v78 offset:28160
    ds_read_b64_tr_b16 v[26:27], v79
    ds_read_b64_tr_b16 v[38:39], v80
    ds_read_b64_tr_b16 v[28:29], v79 offset:640
    ds_read_b64_tr_b16 v[40:41], v80 offset:640
    ds_read_b64_tr_b16 v[30:31], v79 offset:1280
    ds_read_b64_tr_b16 v[42:43], v80 offset:1280
    ds_read_b64_tr_b16 v[32:33], v79 offset:1920
    ds_read_b64_tr_b16 v[44:45], v80 offset:1920
    ds_read_b64_tr_b16 v[34:35], v79 offset:2560
    ds_read_b64_tr_b16 v[46:47], v80 offset:2560
    v_mov_b32 v24, 0
    v_mov_b32 v25, 0
    v_mov_b32 v36, 0
    v_mov_b32 v37, 0
    s_waitcnt lgkmcnt(15)
    v_and_b32 v178, v178, v76
    v_and_b32 v179, v179, v76
    v_and_b32 v182, v182, v76
    v_and_b32 v183, v183, v76
    v_and_b32 v186, v186, v76
    v_and_b32 v187, v187, v76
    v_and_b32 v190, v190, v76
    v_and_b32 v191, v191, v76
    s_waitcnt lgkmcnt(12)
    v_and_b32 v194, v194, v76
    v_and_b32 v195, v195, v76
    v_mfma_f32_16x16x32_bf16 v[216:219], v[196:199], v[176:179], v[60:63]
    v_mfma_f32_16x16x32_bf16 v[220:223], v[200:203], v[180:183], v[60:63]
    v_mfma_f32_16x16x32_bf16 v[240:243], v[196:199], v[180:183], v[64:67]
    v_mfma_f32_16x16x32_bf16 v[224:227], v[204:207], v[184:187], v[60:63]
    v_mfma_f32_16x16x32_bf16 v[244:247], v[200:203], v[184:187], v[64:67]
    v_mfma_f32_16x16x32_bf16 v[228:231], v[208:211], v[188:191], v[60:63]
    v_mfma_f32_16x16x32_bf16 v[248:251], v[204:207], v[188:191], v[64:67]
    s_waitcnt lgkmcnt(10)
    v_mfma_f32_16x16x32_bf16 v[232:235], v[212:215], v[192:195], v[60:63]
    v_mfma_f32_16x16x32_bf16 v[252:255], v[208:211], v[192:195], v[64:67]
    s_barrier
    s_waitcnt vmcnt(0)
    v_cmp_ne_u32 vcc, s60, v57
    s_nop 1
    s_and_b32 vcc_lo, vcc_lo, 511
    s_cbranch_scc0 L_ck3_ok
L_ck3_sp:
    s_sleep 2
    s_mov_b32 s9, 15079424
    s_mov_b32 exec_lo, 511
    s_mov_b32 exec_hi, 0
    buffer_load_dword v57, v2, s[20:23], s9 offen sc1
    s_mov_b64 exec, -1
    s_waitcnt vmcnt(0)
    s_add_u32 s75, s75, 1
    s_cmp_gt_u32 s75, 30000
    s_cbranch_scc1 L_ck3_ok
    v_cmp_ne_u32 vcc, s60, v57
    s_nop 3
    s_and_b32 vcc_lo, vcc_lo, 511
    s_nop 3
    s_cbranch_scc1 L_ck3_sp
L_ck3_ok:
    v_max3_f32 v5, v216, v217, v218
    v_max_f32 v5, v5, v219
    v_max_f32 v220, v220, v240
    v_max_f32 v221, v221, v241
    v_max_f32 v222, v222, v242
    v_max_f32 v223, v223, v243
    v_max3_f32 v6, v220, v221, v222
    v_max_f32 v6, v6, v223
    s_add_u32 s9, s73, 0
    s_add_u32 m0, s16, 0
    s_nop 0
    buffer_load_dwordx4 v0, s[20:23], s9 offen sc1 lds
    v_max_f32 v224, v224, v244
    v_max_f32 v225, v225, v245
    v_max_f32 v226, v226, v246
    v_max_f32 v227, v227, v247
    v_max3_f32 v7, v224, v225, v226
    v_max_f32 v7, v7, v227
    v_max_f32 v228, v228, v248
    v_max_f32 v229, v229, v249
    v_max_f32 v230, v230, v250
    v_max_f32 v231, v231, v251
    v_max3_f32 v8, v228, v229, v230
    v_max_f32 v8, v8, v231
    s_add_u32 s9, s72, 0
    buffer_load_dwordx4 v[96:99], v0, s[20:23], s9 offen sc1
    v_max_f32 v232, v232, v252
    v_max_f32 v233, v233, v253
    v_max_f32 v234, v234, v254
    v_max_f32 v235, v235, v255
    v_max3_f32 v9, v232, v233, v234
    v_max_f32 v9, v9, v235
    v_mov_b32 v10, v5
    v_mov_b32 v11, v6
    v_mov_b32 v12, v7
    v_mov_b32 v13, v8
    v_mov_b32 v14, v9
    v_permlane16_swap_b32 v5, v10
    v_permlane16_swap_b32 v6, v11
    v_permlane16_swap_b32 v7, v12
    v_permlane16_swap_b32 v8, v13
    v_permlane16_swap_b32 v9, v14
    v_max_f32 v5, v5, v10
    v_max_f32 v6, v6, v11
    v_max_f32 v7, v7, v12
    v_max_f32 v8, v8, v13
    v_max_f32 v9, v9, v14
    s_add_u32 s9, s72, 4096
    buffer_load_dwordx4 v[100:103], v0, s[20:23], s9 offen sc1
    v_mov_b32 v10, v5
    v_mov_b32 v11, v6
    v_mov_b32 v12, v7
    v_mov_b32 v13, v8
    v_mov_b32 v14, v9
    v_permlane32_swap_b32 v5, v10
    v_permlane32_swap_b32 v6, v11
    v_permlane32_swap_b32 v7, v12
    v_permlane32_swap_b32 v8, v13
    v_permlane32_swap_b32 v9, v14
    v_max_f32 v5, v5, v10
    v_max_f32 v6, v6, v11
    v_max_f32 v7, v7, v12
    v_max_f32 v8, v8, v13
    v_max_f32 v9, v9, v14
    s_add_u32 s9, s73, 1024
    s_add_u32 m0, s16, 8192
    s_nop 0
    buffer_load_dwordx4 v0, s[20:23], s9 offen sc1 lds
    s_mov_b32 s7, 0x3ea52b5c
    v_mul_f32 v5, 0xbea52b5c, v5
    v_mul_f32 v6, 0xbea52b5c, v6
    v_mul_f32 v7, 0xbea52b5c, v7
    v_mul_f32 v8, 0xbea52b5c, v8
    v_mul_f32 v9, 0xbea52b5c, v9
    v_fma_f32 v216, v216, s7, v5
    v_fma_f32 v217, v217, s7, v5
    v_fma_f32 v218, v218, s7, v5
    v_fma_f32 v219, v219, s7, v5
    v_exp_f32 v216, v216
    v_exp_f32 v217, v217
    v_exp_f32 v218, v218
    v_exp_f32 v219, v219
    s_add_u32 s9, s72, 8192
    buffer_load_dwordx4 v[104:107], v0, s[20:23], s9 offen sc1
    v_fma_f32 v220, v220, s7, v6
    v_fma_f32 v221, v221, s7, v6
    v_fma_f32 v222, v222, s7, v6
    v_fma_f32 v223, v223, s7, v6
    v_exp_f32 v220, v220
    v_exp_f32 v221, v221
    v_exp_f32 v222, v222
    v_exp_f32 v223, v223
    s_add_u32 s9, s73, 2048
    s_add_u32 m0, s16, 16384
    s_nop 0
    buffer_load_dwordx4 v0, s[20:23], s9 offen sc1 lds
    v_fma_f32 v224, v224, s7, v7
    v_fma_f32 v225, v225, s7, v7
    v_fma_f32 v226, v226, s7, v7
    v_fma_f32 v227, v227, s7, v7
    v_exp_f32 v224, v224
    v_exp_f32 v225, v225
    v_exp_f32 v226, v226
    v_exp_f32 v227, v227
    s_add_u32 s9, s72, 12288
    buffer_load_dwordx4 v[108:111], v0, s[20:23], s9 offen sc1
    v_fma_f32 v228, v228, s7, v8
    v_fma_f32 v229, v229, s7, v8
    v_fma_f32 v230, v230, s7, v8
    v_fma_f32 v231, v231, s7, v8
    v_exp_f32 v228, v228
    v_exp_f32 v229, v229
    v_exp_f32 v230, v230
    v_exp_f32 v231, v231
    s_add_u32 s9, s73, 3072
    s_add_u32 m0, s16, 24576
    s_nop 0
    buffer_load_dwordx4 v0, s[20:23], s9 offen sc1 lds
    v_fma_f32 v232, v232, s7, v9
    v_fma_f32 v233, v233, s7, v9
    v_fma_f32 v234, v234, s7, v9
    v_fma_f32 v235, v235, s7, v9
    v_exp_f32 v232, v232
    v_exp_f32 v233, v233
    v_exp_f32 v234, v234
    v_exp_f32 v235, v235
    s_add_u32 s9, s72, 16384
    buffer_load_dwordx4 v[112:115], v0, s[20:23], s9 offen sc1
    v_cvt_pk_bf16_f32 v216, v216, v217
    v_cvt_pk_bf16_f32 v217, v218, v219
    v_and_b32 v236, v216, v70
    v_and_b32 v238, v216, v68
    v_and_b32 v237, v217, v71
    v_and_b32 v239, v217, v69
    v_cvt_pk_bf16_f32 v220, v220, v221
    v_cvt_pk_bf16_f32 v221, v222, v223
    v_and_b32 v240, v220, v70
    v_and_b32 v242, v220, v68
    v_and_b32 v241, v221, v71
    v_and_b32 v243, v221, v69
    s_add_u32 s9, s72, 20480
    buffer_load_dwordx4 v[116:119], v0, s[20:23], s9 offen sc1
    v_cvt_pk_bf16_f32 v224, v224, v225
    v_cvt_pk_bf16_f32 v225, v226, v227
    v_and_b32 v244, v224, v70
    v_and_b32 v246, v224, v68
    v_and_b32 v245, v225, v71
    v_and_b32 v247, v225, v69
    v_cvt_pk_bf16_f32 v228, v228, v229
    v_cvt_pk_bf16_f32 v229, v230, v231
    v_and_b32 v248, v228, v70
    v_and_b32 v250, v228, v68
    v_and_b32 v249, v229, v71
    v_and_b32 v251, v229, v69
    s_add_u32 s9, s73, 4096
    s_add_u32 m0, s16, 32768
    s_nop 0
    buffer_load_dwordx4 v0, s[20:23], s9 offen sc1 lds
    v_cvt_pk_bf16_f32 v232, v232, v233
    v_cvt_pk_bf16_f32 v233, v234, v235
    v_and_b32 v252, v232, v70
    v_and_b32 v254, v232, v68
    v_and_b32 v253, v233, v71
    v_and_b32 v255, v233, v69
    v_mfma_f32_16x16x32_bf16 v[216:219], v[72:75], v[236:239], 0
    s_waitcnt lgkmcnt(9)
    v_mfma_f32_16x16x32_bf16 v[176:179], v[24:27], v[236:239], 0
    s_waitcnt lgkmcnt(8)
    v_mfma_f32_16x16x32_bf16 v[196:199], v[36:39], v[236:239], 0
    v_mfma_f32_16x16x32_bf16 v[220:223], v[72:75], v[240:243], 0
    s_waitcnt lgkmcnt(7)
    v_mfma_f32_16x16x32_bf16 v[180:183], v[26:29], v[240:243], 0
    s_waitcnt lgkmcnt(6)
    v_mfma_f32_16x16x32_bf16 v[200:203], v[38:41], v[240:243], 0
    v_mfma_f32_16x16x32_bf16 v[224:227], v[72:75], v[244:247], 0
    s_waitcnt lgkmcnt(5)
    v_mfma_f32_16x16x32_bf16 v[184:187], v[28:31], v[244:247], 0
    s_waitcnt lgkmcnt(4)
    v_mfma_f32_16x16x32_bf16 v[204:207], v[40:43], v[244:247], 0
    v_mfma_f32_16x16x32_bf16 v[228:231], v[72:75], v[248:251], 0
    s_waitcnt lgkmcnt(3)
    v_mfma_f32_16x16x32_bf16 v[188:191], v[30:33], v[248:251], 0
    s_waitcnt lgkmcnt(2)
    v_mfma_f32_16x16x32_bf16 v[208:211], v[42:45], v[248:251], 0
    v_mfma_f32_16x16x32_bf16 v[232:235], v[72:75], v[252:255], 0
    s_waitcnt lgkmcnt(1)
    v_mfma_f32_16x16x32_bf16 v[192:195], v[32:35], v[252:255], 0
    s_waitcnt lgkmcnt(0)
    v_mfma_f32_16x16x32_bf16 v[212:215], v[44:47], v[252:255], 0
    s_mov_b32 s28, s20
    s_mov_b32 s29, s21
    s_mov_b32 s30, 9699328
    s_mov_b32 s31, 0x20000
    v_rcp_f32 v216, v216
    v_rcp_f32 v220, v220
    v_rcp_f32 v224, v224
    v_rcp_f32 v228, v228
    v_rcp_f32 v232, v232
    v_mul_f32 v176, v176, v216
    v_mul_f32 v177, v177, v216
    v_mul_f32 v178, v178, v216
    v_mul_f32 v179, v179, v216
    v_cvt_pk_bf16_f32 v176, v176, v177
    v_cvt_pk_bf16_f32 v177, v178, v179
    v_mul_f32 v196, v196, v216
    v_mul_f32 v197, v197, v216
    v_mul_f32 v198, v198, v216
    v_mul_f32 v199, v199, v216
    v_cvt_pk_bf16_f32 v196, v196, v197
    v_cvt_pk_bf16_f32 v197, v198, v199
    ds_write_b64 v81, v[176:177]
    ds_write_b64 v82, v[196:197]
    s_add_u32 s9, s72, 24576
    buffer_load_dwordx4 v[120:123], v0, s[20:23], s9 offen sc1
    v_mul_f32 v180, v180, v220
    v_mul_f32 v181, v181, v220
    v_mul_f32 v182, v182, v220
    v_mul_f32 v183, v183, v220
    v_cvt_pk_bf16_f32 v180, v180, v181
    v_cvt_pk_bf16_f32 v181, v182, v183
    v_mul_f32 v200, v200, v220
    v_mul_f32 v201, v201, v220
    v_mul_f32 v202, v202, v220
    v_mul_f32 v203, v203, v220
    v_cvt_pk_bf16_f32 v200, v200, v201
    v_cvt_pk_bf16_f32 v201, v202, v203
    ds_write_b64 v81, v[180:181] offset:256
    ds_write_b64 v82, v[200:201] offset:256
    s_add_u32 s9, s73, 40960
    s_add_u32 m0, s16, 40960
    s_nop 0
    buffer_load_dwordx4 v0, s[20:23], s9 offen sc1 lds
    v_mul_f32 v184, v184, v224
    v_mul_f32 v185, v185, v224
    v_mul_f32 v186, v186, v224
    v_mul_f32 v187, v187, v224
    v_cvt_pk_bf16_f32 v184, v184, v185
    v_cvt_pk_bf16_f32 v185, v186, v187
    v_mul_f32 v204, v204, v224
    v_mul_f32 v205, v205, v224
    v_mul_f32 v206, v206, v224
    v_mul_f32 v207, v207, v224
    v_cvt_pk_bf16_f32 v204, v204, v205
    v_cvt_pk_bf16_f32 v205, v206, v207
    ds_write_b64 v81, v[184:185] offset:512
    ds_write_b64 v82, v[204:205] offset:512
    s_add_u32 s9, s72, 28672
    buffer_load_dwordx4 v[124:127], v0, s[20:23], s9 offen sc1
    v_mul_f32 v188, v188, v228
    v_mul_f32 v189, v189, v228
    v_mul_f32 v190, v190, v228
    v_mul_f32 v191, v191, v228
    v_cvt_pk_bf16_f32 v188, v188, v189
    v_cvt_pk_bf16_f32 v189, v190, v191
    v_mul_f32 v208, v208, v228
    v_mul_f32 v209, v209, v228
    v_mul_f32 v210, v210, v228
    v_mul_f32 v211, v211, v228
    v_cvt_pk_bf16_f32 v208, v208, v209
    v_cvt_pk_bf16_f32 v209, v210, v211
    ds_write_b64 v81, v[188:189] offset:768
    ds_write_b64 v82, v[208:209] offset:768
    s_add_u32 s9, s73, 41984
    s_add_u32 m0, s16, 49152
    s_nop 0
    buffer_load_dwordx4 v0, s[20:23], s9 offen sc1 lds
    v_mul_f32 v192, v192, v232
    v_mul_f32 v193, v193, v232
    v_mul_f32 v194, v194, v232
    v_mul_f32 v195, v195, v232
    v_cvt_pk_bf16_f32 v192, v192, v193
    v_cvt_pk_bf16_f32 v193, v194, v195
    v_mul_f32 v212, v212, v232
    v_mul_f32 v213, v213, v232
    v_mul_f32 v214, v214, v232
    v_mul_f32 v215, v215, v232
    v_cvt_pk_bf16_f32 v212, v212, v213
    v_cvt_pk_bf16_f32 v213, v214, v215
    ds_write_b64 v81, v[192:193] offset:1024
    ds_write_b64 v82, v[212:213] offset:1024
    s_add_u32 s9, s72, 32768
    buffer_load_dwordx4 v[128:131], v0, s[20:23], s9 offen sc1
    s_waitcnt lgkmcnt(0)
    s_barrier
    ds_read_b128 v[216:219], v83
    ds_read_b128 v[220:223], v83 offset:8192
    ds_read_b128 v[224:227], v83 offset:16384
    ds_read_b128 v[228:231], v83 offset:24576
    s_mov_b32 s6, 110592
    s_waitcnt lgkmcnt(3)
    buffer_store_dwordx4 v[216:219], v92, s[28:31], s6 offen sc1
    s_waitcnt lgkmcnt(2)
    buffer_store_dwordx4 v[220:223], v93, s[28:31], s6 offen sc1
    s_waitcnt lgkmcnt(1)
    buffer_store_dwordx4 v[224:227], v94, s[28:31], s6 offen sc1
    s_waitcnt lgkmcnt(0)
    buffer_store_dwordx4 v[228:231], v95, s[28:31], s6 offen sc1
    s_mov_b32 s9, 15081472
    s_mov_b32 exec_lo, 511
    s_mov_b32 exec_hi, 0
    buffer_load_dword v3, v2, s[20:23], s9 offen sc1
    s_mov_b64 exec, -1
    s_lshr_b32 s4, s3, 2
    s_lshl_b32 s5, s4, 10
    v_add_u32 v68, s5, v0
    v_add_u32 v69, 65536, v68
    v_add_u32 v70, 131072, v68
    s_waitcnt vmcnt(10)
    s_barrier
    ds_read_b128 v[8:11], v68
    ds_read_b128 v[12:15], v68 offset:8192
    ds_read_b128 v[16:19], v68 offset:16384
    ds_read_b128 v[20:23], v68 offset:24576
    ds_read_b128 v[24:27], v68 offset:32768
    v_add_u32 v6, s16, v0
    v_add_u32 v7, 0x20000, v6
    v_add_u32 v6, 0x10000, v6
    ds_write_b128 v6, v[132:135] offset:16384
    ds_write_b128 v6, v[136:139] offset:24576
    ds_write_b128 v6, v[140:143] offset:32768
    ds_write_b128 v6, v[144:147] offset:40960
    ds_write_b128 v6, v[148:151] offset:49152
    ds_write_b128 v6, v[152:155] offset:57344
    ds_write_b128 v7, v[156:159]
    ds_write_b128 v7, v[160:163] offset:8192
    ds_write_b128 v7, v[164:167] offset:16384
    ds_write_b128 v7, v[168:171] offset:24576
    s_waitcnt lgkmcnt(14)
    v_mfma_f32_16x16x32_bf16 v[48:51], v[8:11], v[96:99], 0
    ds_read_b128 v[28:31], v68 offset:2048
    s_lshl_b32 s4, s3, 6
    s_add_u32 s4, s4, 0
    v_add_u32 v76, s4, v1
    v_mul_u32_u24 v77, 6554, v76
    v_lshrrev_b32 v77, 16, v77
    s_waitcnt lgkmcnt(14)
    v_mfma_f32_16x16x32_bf16 v[52:55], v[12:15], v[96:99], 0
    ds_read_b128 v[32:35], v68 offset:10240
    v_mul_u32_u24 v78, 10, v77
    v_sub_u32 v76, v76, v78
    v_mul_u32_u24 v73, 336, v77
    v_lshl_add_u32 v73, v76, 5, v73
    v_add_u32 v73, 81920, v73
    s_waitcnt lgkmcnt(14)
    v_mfma_f32_16x16x32_bf16 v[56:59], v[16:19], v[96:99], 0
    ds_read_b128 v[36:39], v68 offset:18432
    v_and_b32 v78, 15, v77
    v_and_b32 v71, 32, v77
    v_lshl_add_u32 v71, v78, 1, v71
    v_bfe_u32 v78, v77, 4, 1
    v_add_u32 v71, v71, v78
    s_waitcnt lgkmcnt(14)
    v_mfma_f32_16x16x32_bf16 v[60:63], v[20:23], v[96:99], 0
    ds_read_b128 v[40:43], v68 offset:26624
    v_mul_u32_u24 v71, 1280, v71
    v_lshl_add_u32 v71, v76, 4, v71
    buffer_load_dwordx4 v[244:247], v71, s[24:27], s74 offen
    s_waitcnt lgkmcnt(14)
    v_mfma_f32_16x16x32_bf16 v[64:67], v[24:27], v[96:99], 0
    ds_read_b128 v[44:47], v68 offset:34816
    s_lshl_b32 s4, s3, 6
    s_add_u32 s4, s4, 512
    v_add_u32 v76, s4, v1
    v_mul_u32_u24 v77, 6554, v76
    v_lshrrev_b32 v77, 16, v77
    s_waitcnt vmcnt(1)
    v_cmp_ne_u32 vcc, s60, v3
    s_nop 1
    s_and_b32 vcc_lo, vcc_lo, 511
    s_cbranch_scc0 L_ck4_ok
L_ck4_sp:
    s_sleep 2
    s_mov_b32 s9, 15081472
    s_mov_b32 exec_lo, 511
    s_mov_b32 exec_hi, 0
    buffer_load_dword v3, v2, s[20:23], s9 offen sc1
    s_mov_b64 exec, -1
    s_waitcnt vmcnt(0)
    s_add_u32 s75, s75, 1
    s_cmp_gt_u32 s75, 30000
    s_cbranch_scc1 L_ck4_ok
    v_cmp_ne_u32 vcc, s60, v3
    s_nop 3
    s_and_b32 vcc_lo, vcc_lo, 511
    s_nop 3
    s_cbranch_scc1 L_ck4_sp
L_ck4_ok:
    s_waitcnt lgkmcnt(4)
    v_mfma_f32_16x16x32_bf16 v[48:51], v[28:31], v[100:103], v[48:51]
    ds_read_b128 v[8:11], v68 offset:4096
    s_add_u32 s9, s72, 36864
    buffer_load_dwordx4 v[132:135], v0, s[20:23], s9 offen sc1
    s_waitcnt lgkmcnt(4)
    v_mfma_f32_16x16x32_bf16 v[52:55], v[32:35], v[100:103], v[52:55]
    ds_read_b128 v[12:15], v68 offset:12288
    s_add_u32 s9, s72, 40960
    buffer_load_dwordx4 v[136:139], v0, s[20:23], s9 offen sc1
    s_waitcnt lgkmcnt(4)
    v_mfma_f32_16x16x32_bf16 v[56:59], v[36:39], v[100:103], v[56:59]
    ds_read_b128 v[16:19], v68 offset:20480
    s_add_u32 s9, s72, 45056
    buffer_load_dwordx4 v[140:143], v0, s[20:23], s9 offen sc1
    s_waitcnt lgkmcnt(4)
    v_mfma_f32_16x16x32_bf16 v[60:63], v[40:43], v[100:103], v[60:63]
    ds_read_b128 v[20:23], v68 offset:28672
    s_waitcnt lgkmcnt(4)
    v_mfma_f32_16x16x32_bf16 v[64:67], v[44:47], v[100:103], v[64:67]
    ds_read_b128 v[24:27], v68 offset:36864
    s_waitcnt lgkmcnt(4)
    v_mfma_f32_16x16x32_bf16 v[48:51], v[8:11], v[104:107], v[48:51]
    ds_read_b128 v[28:31], v68 offset:6144
    s_add_u32 s9, s72, 49152
    buffer_load_dwordx4 v[144:147], v0, s[20:23], s9 offen sc1
    s_waitcnt lgkmcnt(4)
    v_mfma_f32_16x16x32_bf16 v[52:55], v[12:15], v[104:107], v[52:55]
    ds_read_b128 v[32:35], v68 offset:14336
    s_add_u32 s9, s72, 53248
    buffer_load_dwordx4 v[148:151], v0, s[20:23], s9 offen sc1
    s_waitcnt lgkmcnt(4)
    v_mfma_f32_16x16x32_bf16 v[56:59], v[16:19], v[104:107], v[56:59]
    ds_read_b128 v[36:39], v68 offset:22528
    s_waitcnt lgkmcnt(4)
    v_mfma_f32_16x16x32_bf16 v[60:63], v[20:23], v[104:107], v[60:63]
    ds_read_b128 v[40:43], v68 offset:30720
    s_waitcnt lgkmcnt(4)
    v_mfma_f32_16x16x32_bf16 v[64:67], v[24:27], v[104:107], v[64:67]
    ds_read_b128 v[44:47], v68 offset:38912
    s_waitcnt lgkmcnt(0)
    s_barrier
    v_mfma_f32_16x16x32_bf16 v[48:51], v[28:31], v[108:111], v[48:51]
    ds_read_b128 v[8:11], v68 offset:40960
    s_add_u32 s9, s72, 57344
    buffer_load_dwordx4 v[152:155], v0, s[20:23], s9 offen sc1
    v_mfma_f32_16x16x32_bf16 v[52:55], v[32:35], v[108:111], v[52:55]
    ds_read_b128 v[12:15], v68 offset:49152
    s_add_u32 s9, s73, 163840
    s_add_u32 m0, s16, 0
    s_nop 0
    buffer_load_dwordx4 v0, s[20:23], s9 offen sc1 lds
    v_mfma_f32_16x16x32_bf16 v[56:59], v[36:39], v[108:111], v[56:59]
    ds_read_b128 v[16:19], v68 offset:57344
    v_mfma_f32_16x16x32_bf16 v[60:63], v[40:43], v[108:111], v[60:63]
    ds_read_b128 v[20:23], v69
    v_mfma_f32_16x16x32_bf16 v[64:67], v[44:47], v[108:111], v[64:67]
    ds_read_b128 v[24:27], v69 offset:8192
    s_barrier
    s_cmp_eq_u32 s3, 0
    s_cbranch_scc0 L_c18
    s_add_u32 s9, s17, 0
    v_mov_b32 v5, s60
    buffer_store_dword v5, v4, s[20:23], s9 offen sc1
L_c18:
    s_waitcnt lgkmcnt(4)
    v_mfma_f32_16x16x32_bf16 v[48:51], v[8:11], v[112:115], v[48:51]
    ds_read_b128 v[28:31], v68 offset:43008
    s_add_u32 s9, s73, 164864
    s_add_u32 m0, s16, 8192
    s_nop 0
    buffer_load_dwordx4 v0, s[20:23], s9 offen sc1 lds
    s_waitcnt lgkmcnt(4)
    v_mfma_f32_16x16x32_bf16 v[52:55], v[12:15], v[112:115], v[52:55]
    ds_read_b128 v[32:35], v68 offset:51200
    s_add_u32 s9, s73, 165888
    s_add_u32 m0, s16, 16384
    s_nop 0
    buffer_load_dwordx4 v0, s[20:23], s9 offen sc1 lds
    s_waitcnt lgkmcnt(4)
    v_mfma_f32_16x16x32_bf16 v[56:59], v[16:19], v[112:115], v[56:59]
    ds_read_b128 v[36:39], v68 offset:59392
    s_waitcnt lgkmcnt(4)
    v_mfma_f32_16x16x32_bf16 v[60:63], v[20:23], v[112:115], v[60:63]
    ds_read_b128 v[40:43], v69 offset:2048
    s_waitcnt lgkmcnt(4)
    v_mfma_f32_16x16x32_bf16 v[64:67], v[24:27], v[112:115], v[64:67]
    ds_read_b128 v[44:47], v69 offset:10240
    s_waitcnt lgkmcnt(4)
    v_mfma_f32_16x16x32_bf16 v[48:51], v[28:31], v[116:119], v[48:51]
    ds_read_b128 v[8:11], v68 offset:45056
    s_add_u32 s9, s73, 166912
    s_add_u32 m0, s16, 24576
    s_nop 0
    buffer_load_dwordx4 v0, s[20:23], s9 offen sc1 lds
    s_waitcnt lgkmcnt(4)
    v_mfma_f32_16x16x32_bf16 v[52:55], v[32:35], v[116:119], v[52:55]
    ds_read_b128 v[12:15], v68 offset:53248
    s_add_u32 s9, s73, 167936
    s_add_u32 m0, s16, 32768
    s_nop 0
    buffer_load_dwordx4 v0, s[20:23], s9 offen sc1 lds
    s_waitcnt lgkmcnt(4)
    v_mfma_f32_16x16x32_bf16 v[56:59], v[36:39], v[116:119], v[56:59]
    ds_read_b128 v[16:19], v68 offset:61440
    s_waitcnt lgkmcnt(4)
    v_mfma_f32_16x16x32_bf16 v[60:63], v[40:43], v[116:119], v[60:63]
    ds_read_b128 v[20:23], v69 offset:4096
    s_waitcnt lgkmcnt(4)
    v_mfma_f32_16x16x32_bf16 v[64:67], v[44:47], v[116:119], v[64:67]
    ds_read_b128 v[24:27], v69 offset:12288
    s_waitcnt lgkmcnt(4)
    v_mfma_f32_16x16x32_bf16 v[48:51], v[8:11], v[120:123], v[48:51]
    ds_read_b128 v[28:31], v68 offset:47104
    s_add_u32 s9, s72, 61440
    buffer_load_dwordx4 v[156:159], v0, s[20:23], s9 offen sc1
    s_waitcnt lgkmcnt(4)
    v_mfma_f32_16x16x32_bf16 v[52:55], v[12:15], v[120:123], v[52:55]
    ds_read_b128 v[32:35], v68 offset:55296
    s_add_u32 s9, s72, 65536
    buffer_load_dwordx4 v[160:163], v0, s[20:23], s9 offen sc1
    s_waitcnt lgkmcnt(4)
    v_mfma_f32_16x16x32_bf16 v[56:59], v[16:19], v[120:123], v[56:59]
    ds_read_b128 v[36:39], v68 offset:63488
    s_waitcnt lgkmcnt(4)
    v_mfma_f32_16x16x32_bf16 v[60:63], v[20:23], v[120:123], v[60:63]
    ds_read_b128 v[40:43], v69 offset:6144
    s_waitcnt lgkmcnt(4)
    v_mfma_f32_16x16x32_bf16 v[64:67], v[24:27], v[120:123], v[64:67]
    ds_read_b128 v[44:47], v69 offset:14336
    s_waitcnt lgkmcnt(0)
    s_barrier
    v_mfma_f32_16x16x32_bf16 v[48:51], v[28:31], v[124:127], v[48:51]
    ds_read_b128 v[8:11], v69 offset:16384
    s_add_u32 s9, s72, 69632
    buffer_load_dwordx4 v[164:167], v0, s[20:23], s9 offen sc1
    v_mfma_f32_16x16x32_bf16 v[52:55], v[32:35], v[124:127], v[52:55]
    ds_read_b128 v[12:15], v69 offset:24576
    s_add_u32 s9, s73, 204800
    s_add_u32 m0, s16, 40960
    s_nop 0
    buffer_load_dwordx4 v0, s[20:23], s9 offen sc1 lds
    v_mfma_f32_16x16x32_bf16 v[56:59], v[36:39], v[124:127], v[56:59]
    ds_read_b128 v[16:19], v69 offset:32768
    v_mfma_f32_16x16x32_bf16 v[60:63], v[40:43], v[124:127], v[60:63]
    ds_read_b128 v[20:23], v69 offset:40960
    v_mfma_f32_16x16x32_bf16 v[64:67], v[44:47], v[124:127], v[64:67]
    ds_read_b128 v[24:27], v69 offset:49152
    s_waitcnt lgkmcnt(4)
    v_mfma_f32_16x16x32_bf16 v[48:51], v[8:11], v[128:131], v[48:51]
    ds_read_b128 v[28:31], v69 offset:18432
    s_add_u32 s9, s73, 205824
    s_add_u32 m0, s16, 49152
    s_nop 0
    buffer_load_dwordx4 v0, s[20:23], s9 offen sc1 lds
    s_waitcnt lgkmcnt(4)
    v_mfma_f32_16x16x32_bf16 v[52:55], v[12:15], v[128:131], v[52:55]
    ds_read_b128 v[32:35], v69 offset:26624
    s_add_u32 s9, s73, 206848
    s_add_u32 m0, s16, 57344
    s_nop 0
    buffer_load_dwordx4 v0, s[20:23], s9 offen sc1 lds
    s_waitcnt lgkmcnt(4)
    v_mfma_f32_16x16x32_bf16 v[56:59], v[16:19], v[128:131], v[56:59]
    ds_read_b128 v[36:39], v69 offset:34816
    s_waitcnt lgkmcnt(4)
    v_mfma_f32_16x16x32_bf16 v[60:63], v[20:23], v[128:131], v[60:63]
    ds_read_b128 v[40:43], v69 offset:43008
    s_waitcnt lgkmcnt(4)
    v_mfma_f32_16x16x32_bf16 v[64:67], v[24:27], v[128:131], v[64:67]
    ds_read_b128 v[44:47], v69 offset:51200
    s_waitcnt vmcnt(16) lgkmcnt(4)
    v_mfma_f32_16x16x32_bf16 v[48:51], v[28:31], v[132:135], v[48:51]
    ds_read_b128 v[8:11], v69 offset:20480
    s_add_u32 s9, s73, 207872
    s_add_u32 m0, s16, 65536
    s_nop 0
    buffer_load_dwordx4 v0, s[20:23], s9 offen sc1 lds
    s_waitcnt lgkmcnt(4)
    v_mfma_f32_16x16x32_bf16 v[52:55], v[32:35], v[132:135], v[52:55]
    ds_read_b128 v[12:15], v69 offset:28672
    s_add_u32 s9, s73, 208896
    s_add_u32 m0, s16, 73728
    s_nop 0
    buffer_load_dwordx4 v0, s[20:23], s9 offen sc1 lds
    s_waitcnt lgkmcnt(4)
    v_mfma_f32_16x16x32_bf16 v[56:59], v[36:39], v[132:135], v[56:59]
    ds_read_b128 v[16:19], v69 offset:36864
    v_mul_u32_u24 v78, 10, v77
    v_sub_u32 v76, v76, v78
    v_mul_u32_u24 v74, 336, v77
    v_lshl_add_u32 v74, v76, 5, v74
    v_add_u32 v74, 81920, v74
    s_waitcnt lgkmcnt(4)
    v_mfma_f32_16x16x32_bf16 v[60:63], v[40:43], v[132:135], v[60:63]
    ds_read_b128 v[20:23], v69 offset:45056
    v_and_b32 v78, 15, v77
    v_and_b32 v72, 32, v77
    v_lshl_add_u32 v72, v78, 1, v72
    v_bfe_u32 v78, v77, 4, 1
    v_add_u32 v72, v72, v78
    s_waitcnt lgkmcnt(4)
    v_mfma_f32_16x16x32_bf16 v[64:67], v[44:47], v[132:135], v[64:67]
    ds_read_b128 v[24:27], v69 offset:53248
    v_mul_u32_u24 v72, 1280, v72
    v_lshl_add_u32 v72, v76, 4, v72
    s_cmp_lt_u32 s3, 2
    s_cbranch_scc0 L_c19
    buffer_load_dwordx4 v[248:251], v72, s[24:27], s74 offen
L_c19:
    s_waitcnt vmcnt(17) lgkmcnt(4)
    v_mfma_f32_16x16x32_bf16 v[48:51], v[8:11], v[136:139], v[48:51]
    ds_read_b128 v[28:31], v69 offset:22528
    s_lshr_b32 s4, s3, 2
    s_mul_i32 s4, s4, 21504
    s_and_b32 s5, s3, 3
    s_mul_i32 s5, s5, 5376
    s_add_u32 s4, s4, s5
    s_add_u32 s4, s4, 81920
    v_and_b32 v76, 15, v1
    v_mul_u32_u24 v76, 336, v76
    v_and_b32 v77, 48, v1
    v_add3_u32 v75, v76, v77, s4
    s_waitcnt lgkmcnt(4)
    v_mfma_f32_16x16x32_bf16 v[52:55], v[12:15], v[136:139], v[52:55]
    ds_read_b128 v[32:35], v69 offset:30720
    s_waitcnt lgkmcnt(4)
    v_mfma_f32_16x16x32_bf16 v[56:59], v[16:19], v[136:139], v[56:59]
    ds_read_b128 v[36:39], v69 offset:38912
    s_waitcnt lgkmcnt(4)
    v_mfma_f32_16x16x32_bf16 v[60:63], v[20:23], v[136:139], v[60:63]
    ds_read_b128 v[40:43], v69 offset:47104
    s_waitcnt lgkmcnt(4)
    v_mfma_f32_16x16x32_bf16 v[64:67], v[24:27], v[136:139], v[64:67]
    ds_read_b128 v[44:47], v69 offset:55296
    s_waitcnt lgkmcnt(0)
    s_barrier
    s_mov_b32 s9, 15073280
    s_mov_b32 exec_lo, 511
    s_mov_b32 exec_hi, 0
    buffer_load_dword v3, v2, s[20:23], s9 offen sc1
    s_mov_b64 exec, -1
    s_waitcnt vmcnt(17)
    v_mfma_f32_16x16x32_bf16 v[48:51], v[28:31], v[140:143], v[48:51]
    ds_read_b128 v[8:11], v69 offset:57344
    s_add_u32 s9, s73, 245760
    s_add_u32 m0, s16, 81920
    s_nop 0
    buffer_load_dwordx4 v0, s[20:23], s9 offen sc1 lds
    v_mfma_f32_16x16x32_bf16 v[52:55], v[32:35], v[140:143], v[52:55]
    ds_read_b128 v[12:15], v70
    s_add_u32 s9, s73, 246784
    s_add_u32 m0, s16, 90112
    s_nop 0
    buffer_load_dwordx4 v0, s[20:23], s9 offen sc1 lds
    v_mfma_f32_16x16x32_bf16 v[56:59], v[36:39], v[140:143], v[56:59]
    ds_read_b128 v[16:19], v70 offset:8192
    s_add_u32 s9, s73, 247808
    s_add_u32 m0, s16, 98304
    s_nop 0
    buffer_load_dwordx4 v0, s[20:23], s9 offen sc1 lds
    v_mfma_f32_16x16x32_bf16 v[60:63], v[40:43], v[140:143], v[60:63]
    ds_read_b128 v[20:23], v70 offset:16384
    s_add_u32 s9, s73, 248832
    s_add_u32 m0, s16, 106496
    s_nop 0
    buffer_load_dwordx4 v0, s[20:23], s9 offen sc1 lds
    v_mfma_f32_16x16x32_bf16 v[64:67], v[44:47], v[140:143], v[64:67]
    ds_read_b128 v[24:27], v70 offset:24576
    s_waitcnt vmcnt(20) lgkmcnt(4)
    v_mfma_f32_16x16x32_bf16 v[48:51], v[8:11], v[144:147], v[48:51]
    ds_read_b128 v[28:31], v69 offset:59392
    s_add_u32 s9, s73, 249856
    s_add_u32 m0, s16, 114688
    s_nop 0
    buffer_load_dwordx4 v0, s[20:23], s9 offen sc1 lds
    s_waitcnt lgkmcnt(4)
    v_mfma_f32_16x16x32_bf16 v[52:55], v[12:15], v[144:147], v[52:55]
    ds_read_b128 v[32:35], v70 offset:2048
    s_waitcnt lgkmcnt(4)
    v_mfma_f32_16x16x32_bf16 v[56:59], v[16:19], v[144:147], v[56:59]
    ds_read_b128 v[36:39], v70 offset:10240
    s_waitcnt lgkmcnt(4)
    v_mfma_f32_16x16x32_bf16 v[60:63], v[20:23], v[144:147], v[60:63]
    ds_read_b128 v[40:43], v70 offset:18432
    s_waitcnt lgkmcnt(4)
    v_mfma_f32_16x16x32_bf16 v[64:67], v[24:27], v[144:147], v[64:67]
    ds_read_b128 v[44:47], v70 offset:26624
    s_waitcnt vmcnt(20) lgkmcnt(4)
    v_mfma_f32_16x16x32_bf16 v[48:51], v[28:31], v[148:151], v[48:51]
    ds_read_b128 v[8:11], v69 offset:61440
    s_waitcnt lgkmcnt(4)
    v_mfma_f32_16x16x32_bf16 v[52:55], v[32:35], v[148:151], v[52:55]
    ds_read_b128 v[12:15], v70 offset:4096
    s_waitcnt lgkmcnt(4)
    v_mfma_f32_16x16x32_bf16 v[56:59], v[36:39], v[148:151], v[56:59]
    ds_read_b128 v[16:19], v70 offset:12288
    s_waitcnt lgkmcnt(4)
    v_mfma_f32_16x16x32_bf16 v[60:63], v[40:43], v[148:151], v[60:63]
    ds_read_b128 v[20:23], v70 offset:20480
    s_waitcnt lgkmcnt(4)
    v_mfma_f32_16x16x32_bf16 v[64:67], v[44:47], v[148:151], v[64:67]
    ds_read_b128 v[24:27], v70 offset:28672
    s_waitcnt vmcnt(5)
    v_cmp_ne_u32 vcc, s60, v3
    s_nop 1
    s_and_b32 vcc_lo, vcc_lo, 511
    s_cbranch_scc0 L_ck5_ok
L_ck5_sp:
    s_sleep 1
    s_mov_b32 s9, 15073280
    s_mov_b32 exec_lo, 511
    s_mov_b32 exec_hi, 0
    buffer_load_dword v3, v2, s[20:23], s9 offen sc1
    s_mov_b64 exec, -1
    s_waitcnt vmcnt(0)
    s_add_u32 s75, s75, 1
    s_cmp_gt_u32 s75, 30000
    s_cbranch_scc1 L_ck5_ok
    v_cmp_ne_u32 vcc, s60, v3
    s_nop 3
    s_and_b32 vcc_lo, vcc_lo, 511
    s_nop 3
    s_cbranch_scc1 L_ck5_sp
L_ck5_ok:
    s_add_u32 s9, s72, 73728
    buffer_load_dwordx4 v[168:171], v0, s[20:23], s9 offen sc1
    s_add_u32 s9, s72, 77824
    buffer_load_dwordx4 v[172:175], v0, s[20:23], s9 offen sc1
    s_add_u32 s9, s72, 81920
    buffer_load_dwordx4 v[176:179], v0, s[20:23], s9 offen sc1
    s_waitcnt lgkmcnt(4)
    v_mfma_f32_16x16x32_bf16 v[48:51], v[8:11], v[152:155], v[48:51]
    ds_read_b128 v[28:31], v69 offset:63488
    s_add_u32 s9, s72, 86016
    buffer_load_dwordx4 v[180:183], v0, s[20:23], s9 offen sc1
    s_waitcnt lgkmcnt(4)
    v_mfma_f32_16x16x32_bf16 v[52:55], v[12:15], v[152:155], v[52:55]
    ds_read_b128 v[32:35], v70 offset:6144
    s_add_u32 s9, s72, 90112
    buffer_load_dwordx4 v[184:187], v0, s[20:23], s9 offen sc1
    s_waitcnt lgkmcnt(4)
    v_mfma_f32_16x16x32_bf16 v[56:59], v[16:19], v[152:155], v[56:59]
    ds_read_b128 v[36:39], v70 offset:14336
    s_add_u32 s9, s72, 94208
    buffer_load_dwordx4 v[188:191], v0, s[20:23], s9 offen sc1
    s_waitcnt lgkmcnt(4)
    v_mfma_f32_16x16x32_bf16 v[60:63], v[20:23], v[152:155], v[60:63]
    ds_read_b128 v[40:43], v70 offset:22528
    s_add_u32 s9, s72, 98304
    buffer_load_dwordx4 v[192:195], v0, s[20:23], s9 offen sc1
    s_waitcnt lgkmcnt(4)
    v_mfma_f32_16x16x32_bf16 v[64:67], v[24:27], v[152:155], v[64:67]
    ds_read_b128 v[44:47], v70 offset:30720
    s_waitcnt lgkmcnt(0)
    s_barrier
    v_mfma_f32_16x16x32_bf16 v[48:51], v[28:31], v[156:159], v[48:51]
    ds_read_b128 v[8:11], v68
    s_add_u32 s9, s72, 102400
    buffer_load_dwordx4 v[196:199], v0, s[20:23], s9 offen sc1
    v_mfma_f32_16x16x32_bf16 v[52:55], v[32:35], v[156:159], v[52:55]
    ds_read_b128 v[12:15], v68 offset:8192
    v_mfma_f32_16x16x32_bf16 v[56:59], v[36:39], v[156:159], v[56:59]
    ds_read_b128 v[16:19], v68 offset:16384
    v_mfma_f32_16x16x32_bf16 v[60:63], v[40:43], v[156:159], v[60:63]
    ds_read_b128 v[20:23], v68 offset:24576
    v_mfma_f32_16x16x32_bf16 v[64:67], v[44:47], v[156:159], v[64:67]
    ds_read_b128 v[24:27], v68 offset:32768
    s_waitcnt lgkmcnt(4)
    v_mfma_f32_16x16x32_bf16 v[48:51], v[8:11], v[160:163], v[48:51]
    ds_read_b128 v[28:31], v68 offset:2048
    s_add_u32 s9, s72, 106496
    buffer_load_dwordx4 v[200:203], v0, s[20:23], s9 offen sc1
    s_waitcnt lgkmcnt(4)
    v_mfma_f32_16x16x32_bf16 v[52:55], v[12:15], v[160:163], v[52:55]
    ds_read_b128 v[32:35], v68 offset:10240
    s_waitcnt lgkmcnt(4)
    v_mfma_f32_16x16x32_bf16 v[56:59], v[16:19], v[160:163], v[56:59]
    ds_read_b128 v[36:39], v68 offset:18432
    s_waitcnt lgkmcnt(4)
    v_mfma_f32_16x16x32_bf16 v[60:63], v[20:23], v[160:163], v[60:63]
    ds_read_b128 v[40:43], v68 offset:26624
    s_waitcnt lgkmcnt(4)
    v_mfma_f32_16x16x32_bf16 v[64:67], v[24:27], v[160:163], v[64:67]
    ds_read_b128 v[44:47], v68 offset:34816
    s_mov_b32 s9, 15073280
    s_mov_b32 exec_lo, 4294901760
    s_mov_b32 exec_hi, 0
    buffer_load_dword v3, v2, s[20:23], s9 offen sc1
    s_mov_b64 exec, -1
    s_waitcnt lgkmcnt(4)
    v_mfma_f32_16x16x32_bf16 v[48:51], v[28:31], v[164:167], v[48:51]
    ds_read_b128 v[8:11], v68 offset:4096
    s_add_u32 s9, s73, 286720
    s_add_u32 m0, s16, 122880
    s_nop 0
    buffer_load_dwordx4 v0, s[20:23], s9 offen sc1 lds
    s_waitcnt lgkmcnt(4)
    v_mfma_f32_16x16x32_bf16 v[52:55], v[32:35], v[164:167], v[52:55]
    ds_read_b128 v[12:15], v68 offset:12288
    s_add_u32 s9, s73, 287744
    s_add_u32 m0, s16, 131072
    s_nop 0
    buffer_load_dwordx4 v0, s[20:23], s9 offen sc1 lds
    s_waitcnt lgkmcnt(4)
    v_mfma_f32_16x16x32_bf16 v[56:59], v[36:39], v[164:167], v[56:59]
    ds_read_b128 v[16:19], v68 offset:20480
    s_waitcnt lgkmcnt(4)
    v_mfma_f32_16x16x32_bf16 v[60:63], v[40:43], v[164:167], v[60:63]
    ds_read_b128 v[20:23], v68 offset:28672
    s_waitcnt lgkmcnt(4)
    v_mfma_f32_16x16x32_bf16 v[64:67], v[44:47], v[164:167], v[64:67]
    ds_read_b128 v[24:27], v68 offset:36864
    s_waitcnt vmcnt(11) lgkmcnt(4)
    v_mfma_f32_16x16x32_bf16 v[48:51], v[8:11], v[168:171], v[48:51]
    ds_read_b128 v[28:31], v68 offset:6144
    s_add_u32 s9, s73, 288768
    s_add_u32 m0, s16, 139264
    s_nop 0
    buffer_load_dwordx4 v0, s[20:23], s9 offen sc1 lds
    s_waitcnt lgkmcnt(4)
    v_mfma_f32_16x16x32_bf16 v[52:55], v[12:15], v[168:171], v[52:55]
    ds_read_b128 v[32:35], v68 offset:14336
    s_waitcnt lgkmcnt(4)
    v_mfma_f32_16x16x32_bf16 v[56:59], v[16:19], v[168:171], v[56:59]
    ds_read_b128 v[36:39], v68 offset:22528
    s_waitcnt lgkmcnt(4)
    v_mfma_f32_16x16x32_bf16 v[60:63], v[20:23], v[168:171], v[60:63]
    ds_read_b128 v[40:43], v68 offset:30720
    s_waitcnt lgkmcnt(4)
    v_mfma_f32_16x16x32_bf16 v[64:67], v[24:27], v[168:171], v[64:67]
    ds_read_b128 v[44:47], v68 offset:38912
    s_waitcnt lgkmcnt(0)
    s_barrier
    s_waitcnt vmcnt(11)
    v_mfma_f32_16x16x32_bf16 v[48:51], v[28:31], v[172:175], v[48:51]
    ds_read_b128 v[8:11], v68 offset:40960
    s_add_u32 s9, s73, 289792
    s_add_u32 m0, s16, 147456
    s_nop 0
    buffer_load_dwordx4 v0, s[20:23], s9 offen sc1 lds
    v_mfma_f32_16x16x32_bf16 v[52:55], v[32:35], v[172:175], v[52:55]
    ds_read_b128 v[12:15], v68 offset:49152
    v_mfma_f32_16x16x32_bf16 v[56:59], v[36:39], v[172:175], v[56:59]
    ds_read_b128 v[16:19], v68 offset:57344
    v_mfma_f32_16x16x32_bf16 v[60:63], v[40:43], v[172:175], v[60:63]
    ds_read_b128 v[20:23], v69
    v_mfma_f32_16x16x32_bf16 v[64:67], v[44:47], v[172:175], v[64:67]
    ds_read_b128 v[24:27], v69 offset:8192
    s_waitcnt vmcnt(4)
    v_cmp_ne_u32 vcc, s60, v3
    s_nop 1
    s_and_b32 vcc_lo, vcc_lo, 4294901760
    s_cbranch_scc0 L_ck6_ok
L_ck6_sp:
    s_sleep 1
    s_mov_b32 s9, 15073280
    s_mov_b32 exec_lo, 4294901760
    s_mov_b32 exec_hi, 0
    buffer_load_dword v3, v2, s[20:23], s9 offen sc1
    s_mov_b64 exec, -1
    s_waitcnt vmcnt(0)
    s_add_u32 s75, s75, 1
    s_cmp_gt_u32 s75, 30000
    s_cbranch_scc1 L_ck6_ok
    v_cmp_ne_u32 vcc, s60, v3
    s_nop 3
    s_and_b32 vcc_lo, vcc_lo, 4294901760
    s_nop 3
    s_cbranch_scc1 L_ck6_sp
L_ck6_ok:
    s_waitcnt lgkmcnt(4)
    v_mfma_f32_16x16x32_bf16 v[48:51], v[8:11], v[176:179], v[48:51]
    ds_read_b128 v[28:31], v68 offset:43008
    s_add_u32 s9, s73, 290816
    s_add_u32 m0, s16, 155648
    s_nop 0
    buffer_load_dwordx4 v0, s[20:23], s9 offen sc1 lds
    s_waitcnt lgkmcnt(4)
    v_mfma_f32_16x16x32_bf16 v[52:55], v[12:15], v[176:179], v[52:55]
    ds_read_b128 v[32:35], v68 offset:51200
    s_add_u32 s9, s72, 110592
    buffer_load_dwordx4 v[204:207], v0, s[20:23], s9 offen sc1
    s_waitcnt lgkmcnt(4)
    v_mfma_f32_16x16x32_bf16 v[56:59], v[16:19], v[176:179], v[56:59]
    ds_read_b128 v[36:39], v68 offset:59392
    s_waitcnt lgkmcnt(4)
    v_mfma_f32_16x16x32_bf16 v[60:63], v[20:23], v[176:179], v[60:63]
    ds_read_b128 v[40:43], v69 offset:2048
    s_waitcnt lgkmcnt(4)
    v_mfma_f32_16x16x32_bf16 v[64:67], v[24:27], v[176:179], v[64:67]
    ds_read_b128 v[44:47], v69 offset:10240
    s_waitcnt lgkmcnt(4)
    v_mfma_f32_16x16x32_bf16 v[48:51], v[28:31], v[180:183], v[48:51]
    ds_read_b128 v[8:11], v68 offset:45056
    s_add_u32 s9, s72, 114688
    buffer_load_dwordx4 v[208:211], v0, s[20:23], s9 offen sc1
    s_waitcnt lgkmcnt(4)
    v_mfma_f32_16x16x32_bf16 v[52:55], v[32:35], v[180:183], v[52:55]
    ds_read_b128 v[12:15], v68 offset:53248
    s_waitcnt lgkmcnt(4)
    v_mfma_f32_16x16x32_bf16 v[56:59], v[36:39], v[180:183], v[56:59]
    ds_read_b128 v[16:19], v68 offset:61440
    s_waitcnt lgkmcnt(4)
    v_mfma_f32_16x16x32_bf16 v[60:63], v[40:43], v[180:183], v[60:63]
    ds_read_b128 v[20:23], v69 offset:4096
    s_waitcnt lgkmcnt(4)
    v_mfma_f32_16x16x32_bf16 v[64:67], v[44:47], v[180:183], v[64:67]
    ds_read_b128 v[24:27], v69 offset:12288
    s_waitcnt lgkmcnt(4)
    v_mfma_f32_16x16x32_bf16 v[48:51], v[8:11], v[184:187], v[48:51]
    ds_read_b128 v[28:31], v68 offset:47104
    s_add_u32 s9, s72, 118784
    buffer_load_dwordx4 v[212:215], v0, s[20:23], s9 offen sc1
    s_waitcnt lgkmcnt(4)
    v_mfma_f32_16x16x32_bf16 v[52:55], v[12:15], v[184:187], v[52:55]
    ds_read_b128 v[32:35], v68 offset:55296
    s_add_u32 s9, s72, 122880
    buffer_load_dwordx4 v[216:219], v0, s[20:23], s9 offen sc1
    s_waitcnt lgkmcnt(4)
    v_mfma_f32_16x16x32_bf16 v[56:59], v[16:19], v[184:187], v[56:59]
    ds_read_b128 v[36:39], v68 offset:63488
    s_waitcnt lgkmcnt(4)
    v_mfma_f32_16x16x32_bf16 v[60:63], v[20:23], v[184:187], v[60:63]
    ds_read_b128 v[40:43], v69 offset:6144
    s_waitcnt lgkmcnt(4)
    v_mfma_f32_16x16x32_bf16 v[64:67], v[24:27], v[184:187], v[64:67]
    ds_read_b128 v[44:47], v69 offset:14336
    s_waitcnt lgkmcnt(0)
    s_barrier
    v_mfma_f32_16x16x32_bf16 v[48:51], v[28:31], v[188:191], v[48:51]
    ds_read_b128 v[8:11], v69 offset:16384
    s_add_u32 s9, s73, 327680
    s_add_u32 m0, s16, 0
    s_nop 0
    buffer_load_dwordx4 v0, s[20:23], s9 offen sc1 lds
    v_mfma_f32_16x16x32_bf16 v[52:55], v[32:35], v[188:191], v[52:55]
    ds_read_b128 v[12:15], v69 offset:24576
    v_mfma_f32_16x16x32_bf16 v[56:59], v[36:39], v[188:191], v[56:59]
    ds_read_b128 v[16:19], v69 offset:32768
    v_mfma_f32_16x16x32_bf16 v[60:63], v[40:43], v[188:191], v[60:63]
    ds_read_b128 v[20:23], v69 offset:40960
    v_mfma_f32_16x16x32_bf16 v[64:67], v[44:47], v[188:191], v[64:67]
    ds_read_b128 v[24:27], v69 offset:49152
    s_waitcnt lgkmcnt(4)
    v_mfma_f32_16x16x32_bf16 v[48:51], v[8:11], v[192:195], v[48:51]
    ds_read_b128 v[28:31], v69 offset:18432
    s_add_u32 s9, s73, 328704
    s_add_u32 m0, s16, 8192
    s_nop 0
    buffer_load_dwordx4 v0, s[20:23], s9 offen sc1 lds
    s_waitcnt lgkmcnt(4)
    v_mfma_f32_16x16x32_bf16 v[52:55], v[12:15], v[192:195], v[52:55]
    ds_read_b128 v[32:35], v69 offset:26624
    s_waitcnt lgkmcnt(4)
    v_mfma_f32_16x16x32_bf16 v[56:59], v[16:19], v[192:195], v[56:59]
    ds_read_b128 v[36:39], v69 offset:34816
    s_waitcnt lgkmcnt(4)
    v_mfma_f32_16x16x32_bf16 v[60:63], v[20:23], v[192:195], v[60:63]
    ds_read_b128 v[40:43], v69 offset:43008
    s_waitcnt lgkmcnt(4)
    v_mfma_f32_16x16x32_bf16 v[64:67], v[24:27], v[192:195], v[64:67]
    ds_read_b128 v[44:47], v69 offset:51200
    s_waitcnt lgkmcnt(4)
    v_mfma_f32_16x16x32_bf16 v[48:51], v[28:31], v[196:199], v[48:51]
    ds_read_b128 v[8:11], v69 offset:20480
    s_add_u32 s9, s73, 329728
    s_add_u32 m0, s16, 16384
    s_nop 0
    buffer_load_dwordx4 v0, s[20:23], s9 offen sc1 lds
    s_waitcnt lgkmcnt(4)
    v_mfma_f32_16x16x32_bf16 v[52:55], v[32:35], v[196:199], v[52:55]
    ds_read_b128 v[12:15], v69 offset:28672
    s_add_u32 s9, s73, 330752
    s_add_u32 m0, s16, 24576
    s_nop 0
    buffer_load_dwordx4 v0, s[20:23], s9 offen sc1 lds
    s_waitcnt lgkmcnt(4)
    v_mfma_f32_16x16x32_bf16 v[56:59], v[36:39], v[196:199], v[56:59]
    ds_read_b128 v[16:19], v69 offset:36864
    s_waitcnt lgkmcnt(4)
    v_mfma_f32_16x16x32_bf16 v[60:63], v[40:43], v[196:199], v[60:63]
    ds_read_b128 v[20:23], v69 offset:45056
    s_waitcnt lgkmcnt(4)
    v_mfma_f32_16x16x32_bf16 v[64:67], v[44:47], v[196:199], v[64:67]
    ds_read_b128 v[24:27], v69 offset:53248
    s_waitcnt lgkmcnt(4)
    v_mfma_f32_16x16x32_bf16 v[48:51], v[8:11], v[200:203], v[48:51]
    ds_read_b128 v[28:31], v69 offset:22528
    s_add_u32 s9, s73, 331776
    s_add_u32 m0, s16, 32768
    s_nop 0
    buffer_load_dwordx4 v0, s[20:23], s9 offen sc1 lds
    s_waitcnt lgkmcnt(4)
    v_mfma_f32_16x16x32_bf16 v[52:55], v[12:15], v[200:203], v[52:55]
    ds_read_b128 v[32:35], v69 offset:30720
    s_add_u32 s9, s72, 126976
    buffer_load_dwordx4 v[220:223], v0, s[20:23], s9 offen sc1
    s_waitcnt lgkmcnt(4)
    v_mfma_f32_16x16x32_bf16 v[56:59], v[16:19], v[200:203], v[56:59]
    ds_read_b128 v[36:39], v69 offset:38912
    s_waitcnt lgkmcnt(4)
    v_mfma_f32_16x16x32_bf16 v[60:63], v[20:23], v[200:203], v[60:63]
    ds_read_b128 v[40:43], v69 offset:47104
    s_waitcnt lgkmcnt(4)
    v_mfma_f32_16x16x32_bf16 v[64:67], v[24:27], v[200:203], v[64:67]
    ds_read_b128 v[44:47], v69 offset:55296
    s_waitcnt vmcnt(10) lgkmcnt(0)
    s_barrier
    s_waitcnt vmcnt(9)
    v_mfma_f32_16x16x32_bf16 v[48:51], v[28:31], v[204:207], v[48:51]
    ds_read_b128 v[8:11], v69 offset:57344
    s_add_u32 s9, s72, 131072
    buffer_load_dwordx4 v[224:227], v0, s[20:23], s9 offen sc1
    v_mfma_f32_16x16x32_bf16 v[52:55], v[32:35], v[204:207], v[52:55]
    ds_read_b128 v[12:15], v70
    v_mfma_f32_16x16x32_bf16 v[56:59], v[36:39], v[204:207], v[56:59]
    ds_read_b128 v[16:19], v70 offset:8192
    v_mfma_f32_16x16x32_bf16 v[60:63], v[40:43], v[204:207], v[60:63]
    ds_read_b128 v[20:23], v70 offset:16384
    v_mfma_f32_16x16x32_bf16 v[64:67], v[44:47], v[204:207], v[64:67]
    ds_read_b128 v[24:27], v70 offset:24576
    s_waitcnt vmcnt(9) lgkmcnt(4)
    v_mfma_f32_16x16x32_bf16 v[48:51], v[8:11], v[208:211], v[48:51]
    ds_read_b128 v[28:31], v69 offset:59392
    s_add_u32 s9, s72, 135168
    buffer_load_dwordx4 v[228:231], v0, s[20:23], s9 offen sc1
    s_waitcnt lgkmcnt(4)
    v_mfma_f32_16x16x32_bf16 v[52:55], v[12:15], v[208:211], v[52:55]
    ds_read_b128 v[32:35], v70 offset:2048
    s_waitcnt lgkmcnt(4)
    v_mfma_f32_16x16x32_bf16 v[56:59], v[16:19], v[208:211], v[56:59]
    ds_read_b128 v[36:39], v70 offset:10240
    s_waitcnt lgkmcnt(4)
    v_mfma_f32_16x16x32_bf16 v[60:63], v[20:23], v[208:211], v[60:63]
    ds_read_b128 v[40:43], v70 offset:18432
    s_waitcnt lgkmcnt(4)
    v_mfma_f32_16x16x32_bf16 v[64:67], v[24:27], v[208:211], v[64:67]
    ds_read_b128 v[44:47], v70 offset:26624
    s_waitcnt vmcnt(9) lgkmcnt(4)
    v_mfma_f32_16x16x32_bf16 v[48:51], v[28:31], v[212:215], v[48:51]
    ds_read_b128 v[8:11], v69 offset:61440
    s_add_u32 s9, s72, 139264
    buffer_load_dwordx4 v[232:235], v0, s[20:23], s9 offen sc1
    s_waitcnt lgkmcnt(4)
    v_mfma_f32_16x16x32_bf16 v[52:55], v[32:35], v[212:215], v[52:55]
    ds_read_b128 v[12:15], v70 offset:4096
    s_waitcnt lgkmcnt(4)
    v_mfma_f32_16x16x32_bf16 v[56:59], v[36:39], v[212:215], v[56:59]
    ds_read_b128 v[16:19], v70 offset:12288
    s_waitcnt lgkmcnt(4)
    v_mfma_f32_16x16x32_bf16 v[60:63], v[40:43], v[212:215], v[60:63]
    ds_read_b128 v[20:23], v70 offset:20480
    s_waitcnt lgkmcnt(4)
    v_mfma_f32_16x16x32_bf16 v[64:67], v[44:47], v[212:215], v[64:67]
    ds_read_b128 v[24:27], v70 offset:28672
    s_waitcnt vmcnt(9) lgkmcnt(4)
    v_mfma_f32_16x16x32_bf16 v[48:51], v[8:11], v[216:219], v[48:51]
    ds_read_b128 v[28:31], v69 offset:63488
    s_cmp_lt_u32 s3, 2
    s_cbranch_scc0 L_c20
    s_add_u32 s9, s73, 368640
    s_add_u32 m0, s16, 40960
    s_nop 0
    buffer_load_dwordx4 v0, s[20:23], s9 offen sc1 lds
    s_add_u32 s9, s73, 369664
    s_add_u32 m0, s16, 49152
    s_nop 0
    buffer_load_dwordx4 v0, s[20:23], s9 offen sc1 lds
    s_add_u32 s9, s73, 370688
    s_add_u32 m0, s16, 57344
    s_nop 0
    buffer_load_dwordx4 v0, s[20:23], s9 offen sc1 lds
    s_add_u32 s9, s73, 371712
    s_add_u32 m0, s16, 65536
    s_nop 0
    buffer_load_dwordx4 v0, s[20:23], s9 offen sc1 lds
    s_add_u32 s9, s73, 372736
    s_add_u32 m0, s16, 73728
    s_nop 0
    buffer_load_dwordx4 v0, s[20:23], s9 offen sc1 lds
L_c20:
    s_waitcnt lgkmcnt(4)
    v_mfma_f32_16x16x32_bf16 v[52:55], v[12:15], v[216:219], v[52:55]
    ds_read_b128 v[32:35], v70 offset:6144
    s_add_u32 s9, s72, 143360
    buffer_load_dwordx4 v[236:239], v0, s[20:23], s9 offen sc1
    s_waitcnt lgkmcnt(4)
    v_mfma_f32_16x16x32_bf16 v[56:59], v[16:19], v[216:219], v[56:59]
    ds_read_b128 v[36:39], v70 offset:14336
    s_waitcnt lgkmcnt(4)
    v_mfma_f32_16x16x32_bf16 v[60:63], v[20:23], v[216:219], v[60:63]
    ds_read_b128 v[40:43], v70 offset:22528
    s_waitcnt lgkmcnt(4)
    v_mfma_f32_16x16x32_bf16 v[64:67], v[24:27], v[216:219], v[64:67]
    ds_read_b128 v[44:47], v70 offset:30720
    s_waitcnt vmcnt(5) lgkmcnt(0)
    s_barrier
    s_waitcnt vmcnt(4)
    v_mfma_f32_16x16x32_bf16 v[48:51], v[28:31], v[220:223], v[48:51]
    ds_read_b128 v[8:11], v68
    s_add_u32 s9, s72, 147456
    buffer_load_dwordx4 v[240:243], v0, s[20:23], s9 offen sc1
    v_mfma_f32_16x16x32_bf16 v[52:55], v[32:35], v[220:223], v[52:55]
    ds_read_b128 v[12:15], v68 offset:8192
    v_mfma_f32_16x16x32_bf16 v[56:59], v[36:39], v[220:223], v[56:59]
    ds_read_b128 v[16:19], v68 offset:16384
    v_mfma_f32_16x16x32_bf16 v[60:63], v[40:43], v[220:223], v[60:63]
    ds_read_b128 v[20:23], v68 offset:24576
    v_mfma_f32_16x16x32_bf16 v[64:67], v[44:47], v[220:223], v[64:67]
    ds_read_b128 v[24:27], v68 offset:32768
    s_waitcnt vmcnt(4) lgkmcnt(4)
    v_mfma_f32_16x16x32_bf16 v[48:51], v[8:11], v[224:227], v[48:51]
    ds_read_b128 v[28:31], v68 offset:2048
    s_waitcnt lgkmcnt(4)
    v_mfma_f32_16x16x32_bf16 v[52:55], v[12:15], v[224:227], v[52:55]
    ds_read_b128 v[32:35], v68 offset:10240
    s_waitcnt lgkmcnt(4)
    v_mfma_f32_16x16x32_bf16 v[56:59], v[16:19], v[224:227], v[56:59]
    ds_read_b128 v[36:39], v68 offset:18432
    s_waitcnt lgkmcnt(4)
    v_mfma_f32_16x16x32_bf16 v[60:63], v[20:23], v[224:227], v[60:63]
    ds_read_b128 v[40:43], v68 offset:26624
    s_waitcnt lgkmcnt(4)
    v_mfma_f32_16x16x32_bf16 v[64:67], v[24:27], v[224:227], v[64:67]
    ds_read_b128 v[44:47], v68 offset:34816
    s_waitcnt vmcnt(3) lgkmcnt(4)
    v_mfma_f32_16x16x32_bf16 v[48:51], v[28:31], v[228:231], v[48:51]
    ds_read_b128 v[8:11], v68 offset:4096
    s_waitcnt lgkmcnt(4)
    v_mfma_f32_16x16x32_bf16 v[52:55], v[32:35], v[228:231], v[52:55]
    ds_read_b128 v[12:15], v68 offset:12288
    s_waitcnt lgkmcnt(4)
    v_mfma_f32_16x16x32_bf16 v[56:59], v[36:39], v[228:231], v[56:59]
    ds_read_b128 v[16:19], v68 offset:20480
    s_waitcnt lgkmcnt(4)
    v_mfma_f32_16x16x32_bf16 v[60:63], v[40:43], v[228:231], v[60:63]
    ds_read_b128 v[20:23], v68 offset:28672
    s_waitcnt lgkmcnt(4)
    v_mfma_f32_16x16x32_bf16 v[64:67], v[44:47], v[228:231], v[64:67]
    ds_read_b128 v[24:27], v68 offset:36864
    s_waitcnt vmcnt(2) lgkmcnt(4)
    v_mfma_f32_16x16x32_bf16 v[48:51], v[8:11], v[232:235], v[48:51]
    ds_read_b128 v[28:31], v68 offset:6144
    s_waitcnt lgkmcnt(4)
    v_mfma_f32_16x16x32_bf16 v[52:55], v[12:15], v[232:235], v[52:55]
    ds_read_b128 v[32:35], v68 offset:14336
    s_waitcnt lgkmcnt(4)
    v_mfma_f32_16x16x32_bf16 v[56:59], v[16:19], v[232:235], v[56:59]
    ds_read_b128 v[36:39], v68 offset:22528
    s_waitcnt lgkmcnt(4)
    v_mfma_f32_16x16x32_bf16 v[60:63], v[20:23], v[232:235], v[60:63]
    ds_read_b128 v[40:43], v68 offset:30720
    s_waitcnt lgkmcnt(4)
    v_mfma_f32_16x16x32_bf16 v[64:67], v[24:27], v[232:235], v[64:67]
    ds_read_b128 v[44:47], v68 offset:38912
    s_waitcnt vmcnt(2) lgkmcnt(0)
    s_barrier
    s_waitcnt vmcnt(1)
    v_mfma_f32_16x16x32_bf16 v[48:51], v[28:31], v[236:239], v[48:51]
    ds_read_b128 v[8:11], v68 offset:40960
    v_mfma_f32_16x16x32_bf16 v[52:55], v[32:35], v[236:239], v[52:55]
    ds_read_b128 v[12:15], v68 offset:49152
    v_mfma_f32_16x16x32_bf16 v[56:59], v[36:39], v[236:239], v[56:59]
    ds_read_b128 v[16:19], v68 offset:57344
    v_mfma_f32_16x16x32_bf16 v[60:63], v[40:43], v[236:239], v[60:63]
    ds_read_b128 v[20:23], v69
    v_mfma_f32_16x16x32_bf16 v[64:67], v[44:47], v[236:239], v[64:67]
    ds_read_b128 v[24:27], v69 offset:8192
    s_waitcnt vmcnt(0) lgkmcnt(4)
    v_mfma_f32_16x16x32_bf16 v[48:51], v[8:11], v[240:243], v[48:51]
    s_waitcnt lgkmcnt(3)
    v_mfma_f32_16x16x32_bf16 v[52:55], v[12:15], v[240:243], v[52:55]
    s_waitcnt lgkmcnt(2)
    v_mfma_f32_16x16x32_bf16 v[56:59], v[16:19], v[240:243], v[56:59]
    s_waitcnt lgkmcnt(1)
    v_mfma_f32_16x16x32_bf16 v[60:63], v[20:23], v[240:243], v[60:63]
    s_waitcnt lgkmcnt(0)
    v_mfma_f32_16x16x32_bf16 v[64:67], v[24:27], v[240:243], v[64:67]
    ds_write_b128 v75, v[48:51]
    s_nop 0
    ds_write_b128 v75, v[52:55] offset:64
    s_nop 0
    ds_write_b128 v75, v[56:59] offset:128
    s_nop 0
    ds_write_b128 v75, v[60:63] offset:192
    s_nop 0
    ds_write_b128 v75, v[64:67] offset:256
    v_lshlrev_b32 v8, 16, v244
    v_and_b32 v9, 0xffff0000, v244
    v_lshlrev_b32 v10, 16, v245
    v_and_b32 v11, 0xffff0000, v245
    v_lshlrev_b32 v12, 16, v246
    v_and_b32 v13, 0xffff0000, v246
    v_lshlrev_b32 v14, 16, v247
    v_and_b32 v15, 0xffff0000, v247
    v_lshlrev_b32 v16, 16, v248
    v_and_b32 v17, 0xffff0000, v248
    v_lshlrev_b32 v18, 16, v249
    v_and_b32 v19, 0xffff0000, v249
    v_lshlrev_b32 v20, 16, v250
    v_and_b32 v21, 0xffff0000, v250
    v_lshlrev_b32 v22, 16, v251
    v_and_b32 v23, 0xffff0000, v251
    s_waitcnt lgkmcnt(0)
    s_barrier
    ds_read_b128 v[96:99], v73
    ds_read_b128 v[100:103], v73 offset:16
    ds_read_b128 v[104:107], v73 offset:21504
    ds_read_b128 v[108:111], v73 offset:21520
    s_cmp_lt_u32 s3, 2
    s_cbranch_scc1 L_f7
    s_waitcnt lgkmcnt(3)
    v_add_f32 v8, v8, v96
    v_add_f32 v9, v9, v97
    v_add_f32 v10, v10, v98
    v_add_f32 v11, v11, v99
    s_waitcnt lgkmcnt(2)
    v_add_f32 v12, v12, v100
    v_add_f32 v13, v13, v101
    v_add_f32 v14, v14, v102
    v_add_f32 v15, v15, v103
    s_waitcnt lgkmcnt(1)
    v_add_f32 v8, v8, v104
    v_add_f32 v9, v9, v105
    v_add_f32 v10, v10, v106
    v_add_f32 v11, v11, v107
    s_waitcnt lgkmcnt(0)
    v_add_f32 v12, v12, v108
    v_add_f32 v13, v13, v109
    v_add_f32 v14, v14, v110
    v_add_f32 v15, v15, v111
    v_cvt_pk_bf16_f32 v244, v8, v9
    v_cvt_pk_bf16_f32 v245, v10, v11
    v_cvt_pk_bf16_f32 v246, v12, v13
    v_cvt_pk_bf16_f32 v247, v14, v15
    buffer_store_dwordx4 v[244:247], v71, s[64:67], s74 offen nt
    s_branch L_f7e
L_f7:
    ds_read_b128 v[112:115], v74
    ds_read_b128 v[116:119], v74 offset:16
    ds_read_b128 v[120:123], v74 offset:21504
    ds_read_b128 v[124:127], v74 offset:21520
    s_waitcnt lgkmcnt(7)
    v_add_f32 v8, v8, v96
    v_add_f32 v9, v9, v97
    v_add_f32 v10, v10, v98
    v_add_f32 v11, v11, v99
    s_waitcnt lgkmcnt(6)
    v_add_f32 v12, v12, v100
    v_add_f32 v13, v13, v101
    v_add_f32 v14, v14, v102
    v_add_f32 v15, v15, v103
    s_waitcnt lgkmcnt(5)
    v_add_f32 v8, v8, v104
    v_add_f32 v9, v9, v105
    v_add_f32 v10, v10, v106
    v_add_f32 v11, v11, v107
    s_waitcnt lgkmcnt(4)
    v_add_f32 v12, v12, v108
    v_add_f32 v13, v13, v109
    v_add_f32 v14, v14, v110
    v_add_f32 v15, v15, v111
    v_cvt_pk_bf16_f32 v244, v8, v9
    v_cvt_pk_bf16_f32 v245, v10, v11
    v_cvt_pk_bf16_f32 v246, v12, v13
    v_cvt_pk_bf16_f32 v247, v14, v15
    buffer_store_dwordx4 v[244:247], v71, s[64:67], s74 offen nt
    s_waitcnt lgkmcnt(3)
    v_add_f32 v16, v16, v112
    v_add_f32 v17, v17, v113
    v_add_f32 v18, v18, v114
    v_add_f32 v19, v19, v115
    s_waitcnt lgkmcnt(2)
    v_add_f32 v20, v20, v116
    v_add_f32 v21, v21, v117
    v_add_f32 v22, v22, v118
    v_add_f32 v23, v23, v119
    s_waitcnt lgkmcnt(1)
    v_add_f32 v16, v16, v120
    v_add_f32 v17, v17, v121
    v_add_f32 v18, v18, v122
    v_add_f32 v19, v19, v123
    s_waitcnt lgkmcnt(0)
    v_add_f32 v20, v20, v124
    v_add_f32 v21, v21, v125
    v_add_f32 v22, v22, v126
    v_add_f32 v23, v23, v127
    v_cvt_pk_bf16_f32 v248, v16, v17
    v_cvt_pk_bf16_f32 v249, v18, v19
    v_cvt_pk_bf16_f32 v250, v20, v21
    v_cvt_pk_bf16_f32 v251, v22, v23
    buffer_store_dwordx4 v[248:251], v72, s[64:67], s74 offen nt
L_f7e:
    s_endpgm
L_parallel_sum__sliding_local_dilated__glu_gated_swiglu__prompt_kernel_ffn:
    s_mul_i32 s13, s11, 18
    s_add_u32 s13, s13, s12
    s_lshr_b32 s14, s13, 3
    s_and_b32 s15, s13, 7
    s_mul_i32 s4, s14, 3
    s_add_u32 s4, s4, s15
    s_mov_b32 s19, 0
    s_lshl_b32 s5, s10, 3
    s_add_u32 s15, s15, s5
    s_mul_i32 s40, s19, 221184
    s_lshl_b32 s50, s19, 7
    s_add_u32 s19, s19, 1
    s_cmp_eq_u32 s19, 1
    s_cselect_b32 s19, 0, s19
    s_add_u32 s4, s19, 1
    s_mul_i32 s41, s4, 221184
    s_lshl_b32 s51, s4, 7
    s_add_u32 s19, s19, 1
    s_cmp_eq_u32 s19, 1
    s_cselect_b32 s19, 0, s19
    s_and_b32 s4, s3, 3
    s_lshr_b32 s5, s3, 2
    s_lshl_b32 s6, s4, 3
    v_lshrrev_b32 v16, 3, v1
    v_and_b32 v17, 7, v1
    v_add_u32 v18, s6, v16
    v_bfe_u32 v19, v18, 1, 3
    v_xor_b32 v19, v17, v19
    v_and_b32 v80, 15, v18
    v_lshrrev_b32 v18, 4, v18
    v_lshl_add_u32 v80, v80, 1, v18
    s_lshl_b32 s6, s15, 7
    s_lshl_b32 s9, s5, 5
    s_add_u32 s6, s6, s9
    v_add_u32 v80, s6, v80
    v_mul_u32_u24 v80, 1280, v80
    v_lshl_add_u32 v80, v19, 4, v80
    v_add_u32 v81, 81920, v80
    v_lshrrev_b32 v18, 2, v1
    v_and_b32 v18, 4, v18
    v_xor_b32 v18, v17, v18
    v_mul_u32_u24 v5, 3456, v16
    v_lshl_add_u32 v5, v18, 4, v5
    s_mul_i32 s6, s3, 27648
    s_mul_i32 s9, s14, 384
    s_add_u32 s6, s6, s9
    v_add_u32 v5, s6, v5
    s_and_b32 s4, s2, 7
    s_lshl_b32 s4, s4, 5
    s_lshr_b32 s5, s2, 3
    s_add_u32 s4, s4, s5
    s_lshl_b32 s4, s4, 3
    s_add_u32 s4, s4, s3
    s_mul_i32 s63, s4, 1280
    s_lshl_b32 s61, s4, 4
    s_mov_b32 s62, 15106048
    v_lshlrev_b32 v244, 4, v1
    v_lshlrev_b32 v245, 2, v1
    v_lshlrev_b32 v213, 24, v1
    s_waitcnt lgkmcnt(0)
    s_add_u32 s36, s20, 14680064
    s_addc_u32 s37, s21, 0
    buffer_load_dword v213, v213, s[20:23], s62 offen sc1
    buffer_load_dwordx4 v[208:211], v244, s[24:27], s63 offen
    buffer_load_dword v212, v245, s[24:27], s63 offen offset:1024
    s_mov_b32 s81, s61
    s_bitcmp1_b32 s13, 0
    s_cselect_b32 s8, 57, 30
    s_mov_b32 s70, 2211840
    s_mov_b32 s71, 0x20000
    s_mul_i32 s9, s14, 3
    s_bfe_u32 s4, s13, 0x20001
    s_add_u32 s9, s9, s4
    s_add_u32 s8, s8, s9
    s_add_u32 m0, s16, 32768
    s_nop 0
    buffer_load_dwordx4 v80, s[24:27], s50 offen lds
    s_lshl_b32 s9, s9, 7
    s_cmp_lt_u32 s4, 2
    s_cselect_b32 s9, s9, 0x7ff00000
    s_cselect_b32 s7, s3, 1
    s_lshl_b32 s5, s8, 10
    s_lshl_b32 s8, s10, 9
    s_add_u32 s5, s5, s8
    s_add_u32 s5, s5, 14942208
    s_add_u32 m0, s16, 40960
    s_nop 0
    buffer_load_dwordx4 v81, s[24:27], s50 offen lds
    s_mul_i32 s8, s10, 40
    s_add_u32 s8, s8, s3
    s_mul_i32 s8, s8, 27648
    s_add_u32 s78, s8, s9
    s_cmp_eq_u32 s7, 0
    s_cselect_b32 s18, s5, 0x7ff00000
    v_lshrrev_b32 v246, 3, v1
    v_and_b32 v247, 7, v1
    s_add_u32 m0, s16, 65536
    s_nop 0
    buffer_load_dwordx4 v5, s[28:31], s40 offen lds
    v_mul_u32_u24 v246, 3456, v246
    v_lshl_add_u32 v246, v247, 4, v246
    s_and_b32 s17, s13, 6
    s_bitcmp1_b32 s13, 0
    s_cselect_b32 s68, s32, s28
    s_cselect_b32 s69, s33, s29
    s_mul_i32 s12, s10, 72
    s_add_u32 s12, s12, s13
    s_cmp_ge_u32 s12, 90
    s_cselect_b32 s0, s54, s56
    s_cselect_b32 s1, s55, s57
    s_add_u32 s4, s19, 2
    s_mul_i32 s42, s4, 221184
    s_lshl_b32 s52, s4, 7
    s_add_u32 s19, s19, 1
    s_cmp_eq_u32 s19, 1
    s_cselect_b32 s19, 0, s19
    s_add_u32 s4, s19, 3
    s_mul_i32 s43, s4, 221184
    s_lshl_b32 s53, s4, 7
    s_add_u32 s19, s19, 1
    s_cmp_eq_u32 s19, 1
    s_cselect_b32 s19, 0, s19
    s_add_u32 s4, s19, 4
    s_mul_i32 s44, s4, 221184
    s_lshl_b32 s54, s4, 7
    s_add_u32 s19, s19, 1
    s_cmp_eq_u32 s19, 1
    s_cselect_b32 s19, 0, s19
    s_add_u32 s4, s19, 5
    s_mul_i32 s45, s4, 221184
    s_lshl_b32 s55, s4, 7
    s_add_u32 s19, s19, 1
    s_cmp_eq_u32 s19, 1
    s_cselect_b32 s19, 0, s19
    s_add_u32 s4, s19, 6
    s_mul_i32 s46, s4, 221184
    s_lshl_b32 s56, s4, 7
    s_add_u32 s19, s19, 1
    s_cmp_eq_u32 s19, 1
    s_cselect_b32 s19, 0, s19
    s_add_u32 s4, s19, 7
    s_mul_i32 s47, s4, 221184
    s_lshl_b32 s57, s4, 7
    s_add_u32 s19, s19, 1
    s_cmp_eq_u32 s19, 1
    s_cselect_b32 s19, 0, s19
    s_add_u32 m0, s16, 73728
    s_nop 0
    buffer_load_dwordx4 v5, s[32:35], s40 offen lds
    s_add_u32 s4, s19, 8
    s_mul_i32 s48, s4, 221184
    s_lshl_b32 s58, s4, 7
    s_add_u32 s19, s19, 1
    s_cmp_eq_u32 s19, 1
    s_cselect_b32 s19, 0, s19
    s_add_u32 s4, s19, 9
    s_mul_i32 s49, s4, 221184
    s_lshl_b32 s59, s4, 7
    s_and_b32 s4, s3, 3
    s_lshr_b32 s5, s3, 2
    v_lshrrev_b32 v16, 5, v1
    v_lshlrev_b32 v16, 10, v16
    v_bfe_u32 v17, v1, 2, 2
    v_lshl_add_u32 v16, v17, 7, v16
    v_lshrrev_b32 v17, 1, v17
    v_xor_b32 v17, s5, v17
    v_lshl_add_u32 v16, v17, 6, v16
    v_bfe_u32 v17, v1, 4, 1
    v_lshl_add_u32 v16, v17, 5, v16
    v_and_b32 v17, 1, v1
    v_lshl_add_u32 v16, v17, 4, v16
    v_bfe_u32 v17, v1, 1, 1
    v_lshl_add_u32 v2, v17, 3, v16
    v_add_u32 v3, 0x10000, v2
    v_add_u32 v4, 0x20000, v2
    v_and_b32 v16, 31, v1
    v_lshrrev_b32 v17, 5, v1
    v_bfe_u32 v18, v1, 1, 3
    v_xor_b32 v18, v17, v18
    s_lshl_b32 s6, s4, 12
    v_lshlrev_b32 v19, 7, v16
    v_add_u32 v19, s6, v19
    v_xor_b32 v82, 0, v18
    v_lshl_add_u32 v82, v82, 4, v19
    v_xor_b32 v83, 2, v18
    v_lshl_add_u32 v83, v83, 4, v19
    v_xor_b32 v84, 4, v18
    v_lshl_add_u32 v84, v84, 4, v19
    v_xor_b32 v85, 6, v18
    s_cmp_lt_u32 s17, 4
    s_cbranch_scc0 L_c21
    buffer_load_dwordx4 v[224:227], v246, s[68:71], s78 offen
    s_add_u32 s78, s78, 221184
L_c21:
    v_lshl_add_u32 v85, v85, 4, v19
    s_mul_i32 s10, s12, 57
    s_lshr_b32 s10, s10, 9
    s_mul_i32 s4, s10, 9
    s_sub_u32 s11, s12, s4
    s_sub_u32 s4, s12, 90
    s_lshr_b32 s5, s4, 2
    s_and_b32 s4, s4, 3
    s_cmp_ge_u32 s12, 90
    s_cselect_b32 s10, s5, s10
    s_cselect_b32 s11, s4, s11
    s_cselect_b32 s4, 5, 6
    s_cselect_b32 s5, 5, 2
    s_cselect_b32 s6, 54, 0
    s_cselect_b32 s7, 2, 18
    s_cselect_b32 s8, 9, 0
    s_add_u32 s8, s8, s11
    s_lshl_b32 s8, s8, 2
    s_mul_i32 s4, s4, s11
    s_lshr_b32 s9, s3, 2
    s_add_u32 s4, s4, s9
    s_mul_i32 s5, s5, s11
    s_add_u32 s5, s5, s6
    s_add_u32 s5, s5, s9
    s_lshl_b32 s4, s4, 2
    s_and_b32 s6, s3, 3
    s_add_u32 s4, s4, s6
    s_mul_i32 s4, s4, 10240
    s_lshl_b32 s9, s10, 7
    s_add_u32 s63, s4, s9
    s_add_u32 s8, s8, s9
    s_lshl_b32 s4, s10, 2
    s_add_u32 s4, s4, s6
    s_mul_i32 s6, s4, 52
    s_lshr_b32 s6, s6, 8
    s_mul_i32 s6, s6, 365
    s_add_u32 s6, s6, s4
    s_mul_i32 s5, s5, 5
    s_add_u32 s6, s6, s5
    s_lshl_b32 s6, s6, 10
    s_cmp_lt_u32 s17, 4
    s_cbranch_scc0 L_c22
    buffer_load_dwordx4 v[228:231], v246, s[68:71], s78 offen
    s_add_u32 s78, s78, 221184
L_c22:
    s_add_u32 s76, s6, 10485760
    s_add_u32 s10, s8, 15077376
    s_cmp_lt_u32 s12, 130
    s_cselect_b32 s76, s76, 1879048192
    s_cselect_b32 s63, s63, 1879048192
    s_cselect_b32 s10, s10, 805306368
    v_lshrrev_b32 v20, 3, v1
    v_mul_u32_u24 v20, 1280, v20
    v_and_b32 v21, 7, v1
    v_lshl_add_u32 v20, v21, 4, v20
    v_lshrrev_b32 v25, 4, v1
    v_lshlrev_b32 v25, 10, v25
    v_bfe_u32 v27, v1, 2, 2
    v_lshl_add_u32 v25, v27, 7, v25
    v_and_b32 v27, 3, v1
    v_lshl_add_u32 v25, v27, 3, v25
    s_lshr_b32 s4, s3, 2
    s_lshl_b32 s4, s4, 12
    s_and_b32 s5, s3, 3
    s_lshl_b32 s5, s5, 5
    s_add_u32 s4, s4, s5
    s_add_u32 s4, s4, 131072
    v_add_u32 v25, s4, v25
    s_bfe_u32 s4, s2, 0x20001
    s_lshl_b32 s4, s4, 3
    s_bfe_u32 s5, s2, 0x30003
    s_add_u32 s4, s4, s5
    s_and_b32 s11, s2, 1
    s_lshl_b32 s11, s11, 2
    s_lshr_b32 s6, s2, 6
    s_add_u32 s11, s11, s6
    s_bfe_u32 s6, s3, 0x10001
    s_lshl_b32 s9, s4, 1
    s_add_u32 s6, s6, s9
    s_mul_i32 s72, s6, 74
    s_lshr_b32 s9, s3, 2
    s_add_u32 s72, s72, s9
    s_lshl_b32 s72, s72, 1
    s_and_b32 s9, s3, 1
    s_add_u32 s72, s72, s9
    s_lshl_b32 s72, s72, 10
    s_mul_i32 s74, s4, 81920
    s_cmp_lt_u32 s17, 4
    s_cbranch_scc0 L_c23
    buffer_load_dwordx4 v[232:235], v246, s[68:71], s78 offen
    s_add_u32 s78, s78, 221184
L_c23:
    s_mul_i32 s73, s11, 74
    s_add_u32 s73, s73, s3
    s_mul_i32 s73, s73, 5120
    s_add_u32 s73, s73, 10485760
    s_mul_i32 s6, s11, 160
    s_add_u32 s74, s74, s6
    s_lshr_b32 s6, s4, 1
    s_lshl_b32 s6, s6, 7
    s_sub_u32 s6, s6, 0
    s_mov_b32 exec_lo, 65535
    s_mov_b32 exec_hi, 0
    v_lshl_add_u32 v24, v1, 2, s6
    s_mov_b64 exec, -1
    s_lshl_b32 s6, s4, 6
    s_add_u32 s6, s6, 0
    s_max_u32 s6, s6, 14
    s_sub_u32 s6, s6, 14
    s_mul_i32 s6, s6, 7183
    s_lshr_b32 s6, s6, 20
    s_add_u32 s6, s6, 16
    s_lshl_b32 s6, s6, 7
    s_sub_u32 s6, s6, 64
    s_mov_b32 exec_lo, 16711680
    s_mov_b32 exec_hi, 0
    v_lshl_add_u32 v24, v1, 2, s6
    s_mov_b64 exec, -1
    s_lshl_b32 s6, s4, 6
    s_add_u32 s6, s6, 63
    s_max_u32 s6, s6, 14
    s_sub_u32 s6, s6, 14
    s_mul_i32 s6, s6, 7183
    s_lshr_b32 s6, s6, 20
    s_add_u32 s6, s6, 16
    s_lshl_b32 s6, s6, 7
    s_sub_u32 s6, s6, 96
    s_mov_b32 exec_lo, 4278190080
    s_mov_b32 exec_hi, 0
    v_lshl_add_u32 v24, v1, 2, s6
    s_mov_b64 exec, -1
    s_mul_i32 s6, s11, 5
    s_add_u32 s6, s6, 128
    s_lshr_b32 s6, s6, 2
    s_lshl_b32 s6, s6, 7
    s_sub_u32 s6, s6, 128
    s_mov_b32 exec_lo, 0
    s_mov_b32 exec_hi, 8191
    v_lshl_add_u32 v24, v1, 2, s6
    s_mov_b64 exec, -1
    s_cmp_lt_u32 s17, 4
    s_cbranch_scc0 L_c24
    buffer_load_dwordx4 v[236:239], v246, s[68:71], s78 offen
    s_add_u32 s78, s78, 221184
L_c24:
    s_mul_i32 s6, s11, 5
    s_add_u32 s6, s6, 132
    s_lshr_b32 s6, s6, 2
    s_lshl_b32 s6, s6, 7
    s_sub_u32 s6, s6, 180
    s_mov_b32 exec_lo, 0
    s_mov_b32 exec_hi, 4294959104
    v_lshl_add_u32 v24, v1, 2, s6
    s_mov_b64 exec, -1
    s_cmp_lt_u32 s17, 4
    s_cbranch_scc0 L_c25
    buffer_load_dwordx4 v[240:243], v246, s[68:71], s78 offen
L_c25:
    s_waitcnt vmcnt(6)
    v_readfirstlane_b32 s60, v213
    s_waitcnt vmcnt(4)
    v_lshlrev_b32 v222, 16, v212
    v_and_b32 v223, 0xffff0000, v212
    v_lshlrev_b32 v214, 16, v208
    v_and_b32 v215, 0xffff0000, v208
    v_lshlrev_b32 v216, 16, v209
    v_and_b32 v217, 0xffff0000, v209
    v_lshlrev_b32 v218, 16, v210
    v_and_b32 v219, 0xffff0000, v210
    v_lshlrev_b32 v220, 16, v211
    v_and_b32 v221, 0xffff0000, v211
    s_mul_i32 s60, s60, 0x9e3779b1
    s_add_u32 s60, s60, 0x7f4a7c15
    v_add_f32 v213, v214, v215
    v_add_f32 v212, v216, v217
    v_add_f32 v213, v213, v218
    s_add_u32 m0, s16, 49152
    s_nop 0
    buffer_load_dwordx4 v80, s[24:27], s51 offen lds
    v_add_f32 v212, v212, v219
    v_add_f32 v213, v213, v220
    v_add_f32 v212, v212, v221
    v_add_f32 v213, v213, v222
    v_add_f32 v212, v212, v223
    v_add_f32 v213, v213, v212
    s_nop 1
    v_add_f32_dpp v213, v213, v213 quad_perm:[1,0,3,2] row_mask:0xf bank_mask:0xf
    s_nop 1
    v_add_f32_dpp v213, v213, v213 quad_perm:[2,3,0,1] row_mask:0xf bank_mask:0xf
    s_nop 1
    v_add_f32_dpp v213, v213, v213 row_half_mirror row_mask:0xf bank_mask:0xf
    s_nop 1
    v_add_f32_dpp v213, v213, v213 row_ror:8 row_mask:0xf bank_mask:0xf
    v_mov_b32 v212, v213
    s_nop 1
    v_permlane16_swap_b32 v213, v212
    v_add_f32 v213, v213, v212
    v_mov_b32 v212, v213
    s_nop 1
    v_permlane32_swap_b32 v213, v212
    v_add_f32 v213, v213, v212
    s_add_u32 m0, s16, 57344
    s_nop 0
    buffer_load_dwordx4 v81, s[24:27], s51 offen lds
    v_mul_f32 v213, 0xbacccccd, v213
    v_add_f32 v214, v214, v213
    v_add_f32 v215, v215, v213
    v_add_f32 v216, v216, v213
    v_add_f32 v217, v217, v213
    v_add_f32 v218, v218, v213
    v_add_f32 v219, v219, v213
    v_add_f32 v220, v220, v213
    v_add_f32 v221, v221, v213
    v_add_f32 v222, v222, v213
    v_add_f32 v223, v223, v213
    v_mul_f32 v209, v214, v214
    v_mul_f32 v212, v215, v215
    v_fmac_f32 v209, v216, v216
    v_fmac_f32 v212, v217, v217
    v_fmac_f32 v209, v218, v218
    s_add_u32 m0, s16, 81920
    s_nop 0
    buffer_load_dwordx4 v5, s[28:31], s41 offen lds
    v_fmac_f32 v212, v219, v219
    v_fmac_f32 v209, v220, v220
    v_fmac_f32 v212, v221, v221
    v_fmac_f32 v209, v222, v222
    v_fmac_f32 v212, v223, v223
    v_add_f32 v209, v209, v212
    s_nop 1
    v_add_f32_dpp v209, v209, v209 quad_perm:[1,0,3,2] row_mask:0xf bank_mask:0xf
    s_nop 1
    v_add_f32_dpp v209, v209, v209 quad_perm:[2,3,0,1] row_mask:0xf bank_mask:0xf
    s_nop 1
    v_add_f32_dpp v209, v209, v209 row_half_mirror row_mask:0xf bank_mask:0xf
    s_nop 1
    v_add_f32_dpp v209, v209, v209 row_ror:8 row_mask:0xf bank_mask:0xf
    v_mov_b32 v212, v209
    s_nop 1
    v_permlane16_swap_b32 v209, v212
    v_add_f32 v209, v209, v212
    v_mov_b32 v212, v209
    s_nop 1
    v_permlane32_swap_b32 v209, v212
    v_add_f32 v209, v209, v212
    s_add_u32 m0, s16, 90112
    s_nop 0
    buffer_load_dwordx4 v5, s[32:35], s41 offen lds
    v_mov_b32 v211, 0x3727c5ac
    v_fmac_f32 v211, 0x3acccccd, v209
    v_rsq_f32 v210, v211
    v_cvt_pk_bf16_f32 v212, v213, v213
    v_lshlrev_b32 v212, 16, v212
    v_sub_f32 v212, v213, v212
    v_cvt_pk_bf16_f32 v208, v213, v212
    v_mov_b32 v209, s60
    v_mov_b32 v212, s16
    v_lshrrev_b32 v212, 6, v212
    v_add_u32 v212, 157696, v212
    ds_write_b128 v212, v[208:211]
    s_cmp_lt_u32 s17, 4
    s_cbranch_scc0 L_b26
    s_mov_b32 s61, 0x3f80
    s_mov_b32 s62, 0x3f800000
    s_waitcnt vmcnt(4)
    v_lshlrev_b32 v248, 16, v224
    v_and_b32 v249, 0xffff0000, v224
    v_lshlrev_b32 v250, 16, v225
    v_and_b32 v251, 0xffff0000, v225
    v_lshlrev_b32 v252, 16, v226
    v_and_b32 v253, 0xffff0000, v226
    v_lshlrev_b32 v254, 16, v227
    v_and_b32 v255, 0xffff0000, v227
    s_waitcnt vmcnt(4)
    v_dot2c_f32_bf16 v248, s61, v228
    v_dot2c_f32_bf16 v249, s62, v228
    v_dot2c_f32_bf16 v250, s61, v229
    v_dot2c_f32_bf16 v251, s62, v229
    v_dot2c_f32_bf16 v252, s61, v230
    v_dot2c_f32_bf16 v253, s62, v230
    v_dot2c_f32_bf16 v254, s61, v231
    v_dot2c_f32_bf16 v255, s62, v231
    s_waitcnt vmcnt(4)
    v_dot2c_f32_bf16 v248, s61, v232
    v_dot2c_f32_bf16 v249, s62, v232
    v_dot2c_f32_bf16 v250, s61, v233
    v_dot2c_f32_bf16 v251, s62, v233
    v_dot2c_f32_bf16 v252, s61, v234
    v_dot2c_f32_bf16 v253, s62, v234
    v_dot2c_f32_bf16 v254, s61, v235
    v_dot2c_f32_bf16 v255, s62, v235
    s_waitcnt vmcnt(4)
    v_dot2c_f32_bf16 v248, s61, v236
    v_dot2c_f32_bf16 v249, s62, v236
    v_dot2c_f32_bf16 v250, s61, v237
    v_dot2c_f32_bf16 v251, s62, v237
    v_dot2c_f32_bf16 v252, s61, v238
    v_dot2c_f32_bf16 v253, s62, v238
    v_dot2c_f32_bf16 v254, s61, v239
    v_dot2c_f32_bf16 v255, s62, v239
    s_waitcnt vmcnt(4)
    v_dot2c_f32_bf16 v248, s61, v240
    v_dot2c_f32_bf16 v249, s62, v240
    v_dot2c_f32_bf16 v250, s61, v241
    v_dot2c_f32_bf16 v251, s62, v241
    v_dot2c_f32_bf16 v252, s61, v242
    v_dot2c_f32_bf16 v253, s62, v242
    v_dot2c_f32_bf16 v254, s61, v243
    v_dot2c_f32_bf16 v255, s62, v243
    v_lshrrev_b32 v224, 4, v1
    v_lshlrev_b32 v224, 3, v224
    v_lshl_add_u32 v224, v247, 5, v224
    v_permlane32_swap_b32 v248, v252
    v_permlane32_swap_b32 v249, v253
    v_permlane32_swap_b32 v250, v254
    v_permlane32_swap_b32 v251, v255
    v_add_f32 v248, v248, v252
    v_add_f32 v249, v249, v253
    v_add_f32 v250, v250, v254
    v_add_f32 v251, v251, v255
    v_mov_b32 v225, s16
    v_lshrrev_b32 v225, 2, v225
    v_permlane16_swap_b32 v248, v250
    v_permlane16_swap_b32 v249, v251
    v_add_f32 v248, v248, v250
    v_add_f32 v249, v249, v251
    v_add_u32 v224, v224, v225
    v_add_u32 v224, 155648, v224
    v_add_f32_dpp v248, v248, v248 row_ror:8 row_mask:0xf bank_mask:0xf
    v_add_f32_dpp v249, v249, v249 row_ror:8 row_mask:0xf bank_mask:0xf
    ds_write_b64 v224, v[248:249]
    s_waitcnt lgkmcnt(0)
    s_nop 1
L_b26:
    s_mov_b32 s61, 0x01000100
    s_mov_b32 s62, 0x03020302
    s_waitcnt vmcnt(4) lgkmcnt(0)
    s_barrier
    ds_read_b128 v[96:99], v82 offset:32768
    ds_read_b128 v[100:103], v83 offset:32768
    ds_read_b128 v[104:107], v84 offset:32768
    ds_read_b128 v[108:111], v85 offset:32768
    ds_read_b64_tr_b16 v[28:29], v3
    ds_read_b64_tr_b16 v[30:31], v3 offset:512
    ds_read_b64_tr_b16 v[32:33], v3 offset:8192
    ds_read_b64_tr_b16 v[34:35], v3 offset:8704
    ds_read_b64_tr_b16 v[36:37], v3 offset:2048
    ds_read_b64_tr_b16 v[38:39], v3 offset:2560
    ds_read_b64_tr_b16 v[40:41], v3 offset:10240
    ds_read_b64_tr_b16 v[42:43], v3 offset:10752
    s_waitcnt lgkmcnt(6)
    v_mfma_f32_32x32x16_bf16 v[48:63], v[28:31], v[96:99], 0
    ds_read_b64_tr_b16 v[44:45], v3 offset:4096
    ds_read_b64_tr_b16 v[46:47], v3 offset:4608
    s_add_u32 m0, s16, 0
    s_nop 0
    buffer_load_dwordx4 v80, s[24:27], s52 offen lds
    s_cmp_eq_u32 s3, 1
    s_cbranch_scc0 L_b27
    v_and_b32 v212, 0x70, v244
    v_add_u32 v212, 157696, v212
    ds_read_b128 v[208:211], v212
    v_lshrrev_b32 v213, 7, v244
    v_lshl_add_u32 v213, v213, 24, v244
    s_sub_u32 s81, s81, 16
    s_waitcnt lgkmcnt(0)
    buffer_store_dwordx4 v[208:211], v213, s[36:39], s81 offen sc1
    s_nop 1
L_b27:
    s_cmp_lt_u32 s18, 0x7ff00000
    s_cbranch_scc0 L_b28
    v_lshlrev_b32 v214, 2, v1
    v_add_u32 v214, 155648, v214
    s_waitcnt vmcnt(5)
    ds_read_b32 v224, v214
    ds_read_b32 v225, v214 offset:256
    ds_read_b32 v226, v214 offset:512
    ds_read_b32 v227, v214 offset:768
    s_waitcnt vmcnt(5)
    ds_read_b32 v228, v214 offset:1024
    ds_read_b32 v229, v214 offset:1280
    ds_read_b32 v230, v214 offset:1536
    ds_read_b32 v231, v214 offset:1792
    s_waitcnt lgkmcnt(3)
    v_add_f32 v224, v224, v228
    s_waitcnt lgkmcnt(2)
    v_add_f32 v225, v225, v229
    s_waitcnt lgkmcnt(1)
    v_add_f32 v226, v226, v230
    s_waitcnt lgkmcnt(0)
    v_add_f32 v227, v227, v231
    v_add_f32 v224, v224, v225
    v_add_f32 v226, v226, v227
    v_add_f32 v224, v224, v226
    v_cvt_pk_bf16_f32 v228, v224, v224
    v_lshlrev_b32 v230, 16, v228
    v_sub_f32 v230, v224, v230
    v_cvt_pk_bf16_f32 v228, v224, v230
    v_mov_b32 v229, s60
    v_lshlrev_b32 v214, 3, v1
    buffer_store_dwordx2 v[228:229], v214, s[20:23], s18 offen sc1
    s_nop 1
L_b28:
    s_and_b32 s4, s3, 3
    s_lshr_b32 s5, s3, 2
    s_lshl_b32 s6, s15, 2
    s_add_u32 s6, s6, s4
    s_lshl_b32 s19, s6, 9
    s_mul_i32 s6, s6, 74
    s_lshl_b32 s7, s14, 1
    s_add_u32 s6, s6, s7
    s_add_u32 s6, s6, s5
    s_lshl_b32 s13, s6, 11
    s_waitcnt lgkmcnt(6)
    v_mfma_f32_32x32x16_bf16 v[64:79], v[32:35], v[96:99], 0
    ds_read_b64_tr_b16 v[28:29], v3 offset:12288
    ds_read_b64_tr_b16 v[30:31], v3 offset:12800
    s_add_u32 m0, s16, 8192
    s_nop 0
    buffer_load_dwordx4 v81, s[24:27], s52 offen lds
    v_lshrrev_b32 v17, 5, v1
    v_and_b32 v18, 15, v1
    v_bfe_u32 v19, v1, 4, 1
    s_waitcnt lgkmcnt(6)
    v_mfma_f32_32x32x16_bf16 v[48:63], v[36:39], v[100:103], v[48:63]
    ds_read_b64_tr_b16 v[32:33], v3 offset:6144
    ds_read_b64_tr_b16 v[34:35], v3 offset:6656
    s_add_u32 m0, s16, 98304
    s_nop 0
    buffer_load_dwordx4 v5, s[28:31], s42 offen lds
    v_lshl_add_u32 v86, v18, 1, v19
    v_lshlrev_b32 v86, 4, v86
    v_lshlrev_b32 v6, 10, v19
    s_waitcnt lgkmcnt(6)
    v_mfma_f32_32x32x16_bf16 v[64:79], v[40:43], v[100:103], v[64:79]
    ds_read_b64_tr_b16 v[36:37], v3 offset:14336
    ds_read_b64_tr_b16 v[38:39], v3 offset:14848
    v_lshl_add_u32 v6, v17, 8, v6
    v_lshl_add_u32 v6, v18, 4, v6
    v_and_b32 v7, 19, v1
    v_bfe_u32 v18, v1, 2, 1
    s_waitcnt lgkmcnt(6)
    v_mfma_f32_32x32x16_bf16 v[48:63], v[44:47], v[104:107], v[48:63]
    s_waitcnt vmcnt(3)
    s_barrier
    ds_read_b128 v[112:115], v82 offset:49152
    ds_read_b128 v[116:119], v83 offset:49152
    ds_read_b128 v[120:123], v84 offset:49152
    ds_read_b128 v[124:127], v85 offset:49152
    ds_read_b64_tr_b16 v[40:41], v3 offset:16384
    ds_read_b64_tr_b16 v[42:43], v3 offset:16896
    v_lshl_add_u32 v7, v18, 3, v7
    v_bfe_u32 v18, v1, 3, 1
    v_lshl_add_u32 v7, v18, 2, v7
    s_mul_i32 s6, s14, 384
    s_lshr_b32 s5, s3, 2
    s_lshl_b32 s7, s5, 5
    s_add_u32 s6, s6, s7
    v_add_u32 v7, s6, v7
    s_waitcnt lgkmcnt(10)
    v_mfma_f32_32x32x16_bf16 v[64:79], v[28:31], v[104:107], v[64:79]
    ds_read_b64_tr_b16 v[44:45], v3 offset:24576
    ds_read_b64_tr_b16 v[46:47], v3 offset:25088
    s_add_u32 m0, s16, 106496
    s_nop 0
    buffer_load_dwordx4 v5, s[32:35], s42 offen lds
    v_lshlrev_b32 v7, 3, v7
    v_lshl_add_u32 v7, v17, 9, v7
    s_lshl_b32 s17, s15, 7
    s_lshl_b32 s6, s14, 2
    s_add_u32 s17, s17, s6
    s_add_u32 s17, s17, 15073280
    s_waitcnt lgkmcnt(10)
    v_mfma_f32_32x32x16_bf16 v[48:63], v[32:35], v[108:111], v[48:63]
    ds_read_b64_tr_b16 v[28:29], v3 offset:18432
    ds_read_b64_tr_b16 v[30:31], v3 offset:18944
    s_add_u32 m0, s16, 16384
    s_nop 0
    buffer_load_dwordx4 v80, s[24:27], s53 offen lds
    s_mov_b32 s14, 14972928
    s_mov_b32 s15, 15000576
    v_lshlrev_b32 v0, 4, v1
    v_or_b32 v26, s16, v1
    s_waitcnt lgkmcnt(10)
    v_mfma_f32_32x32x16_bf16 v[64:79], v[36:39], v[108:111], v[64:79]
    ds_read_b64_tr_b16 v[32:33], v3 offset:26624
    ds_read_b64_tr_b16 v[34:35], v3 offset:27136
    s_add_u32 m0, s16, 24576
    s_nop 0
    buffer_load_dwordx4 v81, s[24:27], s53 offen lds
    v_min_u32 v26, 1, v26
    v_lshlrev_b32 v26, 30, v26
    s_waitcnt lgkmcnt(6)
    v_mfma_f32_32x32x16_bf16 v[48:63], v[40:43], v[112:115], v[48:63]
    ds_read_b64_tr_b16 v[36:37], v3 offset:20480
    ds_read_b64_tr_b16 v[38:39], v3 offset:20992
    s_add_u32 m0, s16, 114688
    s_nop 0
    buffer_load_dwordx4 v5, s[28:31], s43 offen lds
    s_waitcnt lgkmcnt(6)
    v_mfma_f32_32x32x16_bf16 v[64:79], v[44:47], v[112:115], v[64:79]
    ds_read_b64_tr_b16 v[40:41], v3 offset:28672
    ds_read_b64_tr_b16 v[42:43], v3 offset:29184
    s_add_u32 m0, s16, 122880
    s_nop 0
    buffer_load_dwordx4 v5, s[32:35], s43 offen lds
    s_waitcnt lgkmcnt(6)
    v_mfma_f32_32x32x16_bf16 v[48:63], v[28:31], v[116:119], v[48:63]
    ds_read_b64_tr_b16 v[44:45], v3 offset:22528
    ds_read_b64_tr_b16 v[46:47], v3 offset:23040
    s_add_u32 m0, s16, 131072
    s_nop 0
    buffer_load_dwordx4 v5, s[28:31], s44 offen lds
    s_waitcnt lgkmcnt(6)
    v_mfma_f32_32x32x16_bf16 v[64:79], v[32:35], v[116:119], v[64:79]
    ds_read_b64_tr_b16 v[28:29], v3 offset:30720
    ds_read_b64_tr_b16 v[30:31], v3 offset:31232
    s_waitcnt lgkmcnt(6)
    v_mfma_f32_32x32x16_bf16 v[48:63], v[36:39], v[120:123], v[48:63]
    s_waitcnt vmcnt(5)
    s_barrier
    ds_read_b128 v[128:131], v82
    ds_read_b128 v[132:135], v83
    ds_read_b128 v[136:139], v84
    ds_read_b128 v[140:143], v85
    ds_read_b64_tr_b16 v[32:33], v3 offset:32768
    ds_read_b64_tr_b16 v[34:35], v3 offset:33280
    s_waitcnt lgkmcnt(10)
    v_mfma_f32_32x32x16_bf16 v[64:79], v[40:43], v[120:123], v[64:79]
    ds_read_b64_tr_b16 v[36:37], v3 offset:40960
    ds_read_b64_tr_b16 v[38:39], v3 offset:41472
    s_add_u32 m0, s16, 139264
    s_nop 0
    buffer_load_dwordx4 v5, s[32:35], s44 offen lds
    s_waitcnt lgkmcnt(10)
    v_mfma_f32_32x32x16_bf16 v[48:63], v[44:47], v[124:127], v[48:63]
    ds_read_b64_tr_b16 v[40:41], v3 offset:34816
    ds_read_b64_tr_b16 v[42:43], v3 offset:35328
    s_add_u32 m0, s16, 32768
    s_nop 0
    buffer_load_dwordx4 v80, s[24:27], s54 offen lds
    s_waitcnt lgkmcnt(10)
    v_mfma_f32_32x32x16_bf16 v[64:79], v[28:31], v[124:127], v[64:79]
    ds_read_b64_tr_b16 v[44:45], v3 offset:43008
    ds_read_b64_tr_b16 v[46:47], v3 offset:43520
    s_add_u32 m0, s16, 40960
    s_nop 0
    buffer_load_dwordx4 v81, s[24:27], s54 offen lds
    s_waitcnt lgkmcnt(6)
    v_mfma_f32_32x32x16_bf16 v[48:63], v[32:35], v[128:131], v[48:63]
    ds_read_b64_tr_b16 v[28:29], v3 offset:36864
    ds_read_b64_tr_b16 v[30:31], v3 offset:37376
    s_add_u32 m0, s16, 49152
    s_nop 0
    buffer_load_dwordx4 v80, s[24:27], s55 offen lds
    s_waitcnt lgkmcnt(6)
    v_mfma_f32_32x32x16_bf16 v[64:79], v[36:39], v[128:131], v[64:79]
    ds_read_b64_tr_b16 v[32:33], v3 offset:45056
    ds_read_b64_tr_b16 v[34:35], v3 offset:45568
    s_add_u32 m0, s16, 57344
    s_nop 0
    buffer_load_dwordx4 v81, s[24:27], s55 offen lds
    s_waitcnt lgkmcnt(6)
    v_mfma_f32_32x32x16_bf16 v[48:63], v[40:43], v[132:135], v[48:63]
    ds_read_b64_tr_b16 v[36:37], v3 offset:38912
    ds_read_b64_tr_b16 v[38:39], v3 offset:39424
    s_add_u32 m0, s16, 65536
    s_nop 0
    buffer_load_dwordx4 v5, s[28:31], s45 offen lds
    s_waitcnt lgkmcnt(6)
    v_mfma_f32_32x32x16_bf16 v[64:79], v[44:47], v[132:135], v[64:79]
    ds_read_b64_tr_b16 v[40:41], v3 offset:47104
    ds_read_b64_tr_b16 v[42:43], v3 offset:47616
    s_waitcnt lgkmcnt(6)
    v_mfma_f32_32x32x16_bf16 v[48:63], v[28:31], v[136:139], v[48:63]
    s_waitcnt vmcnt(7)
    s_barrier
    ds_read_b128 v[144:147], v82 offset:16384
    ds_read_b128 v[148:151], v83 offset:16384
    ds_read_b128 v[152:155], v84 offset:16384
    ds_read_b128 v[156:159], v85 offset:16384
    ds_read_b64_tr_b16 v[44:45], v3 offset:49152
    ds_read_b64_tr_b16 v[46:47], v3 offset:49664
    s_waitcnt lgkmcnt(10)
    v_mfma_f32_32x32x16_bf16 v[64:79], v[32:35], v[136:139], v[64:79]
    ds_read_b64_tr_b16 v[28:29], v3 offset:57344
    ds_read_b64_tr_b16 v[30:31], v3 offset:57856
    s_add_u32 m0, s16, 73728
    s_nop 0
    buffer_load_dwordx4 v5, s[32:35], s45 offen lds
    s_waitcnt lgkmcnt(10)
    v_mfma_f32_32x32x16_bf16 v[48:63], v[36:39], v[140:143], v[48:63]
    ds_read_b64_tr_b16 v[32:33], v3 offset:51200
    ds_read_b64_tr_b16 v[34:35], v3 offset:51712
    s_add_u32 m0, s16, 0
    s_nop 0
    buffer_load_dwordx4 v80, s[24:27], s56 offen lds
    s_waitcnt lgkmcnt(10)
    v_mfma_f32_32x32x16_bf16 v[64:79], v[40:43], v[140:143], v[64:79]
    ds_read_b64_tr_b16 v[36:37], v3 offset:59392
    ds_read_b64_tr_b16 v[38:39], v3 offset:59904
    s_add_u32 m0, s16, 8192
    s_nop 0
    buffer_load_dwordx4 v81, s[24:27], s56 offen lds
    s_waitcnt lgkmcnt(6)
    v_mfma_f32_32x32x16_bf16 v[48:63], v[44:47], v[144:147], v[48:63]
    ds_read_b64_tr_b16 v[40:41], v3 offset:53248
    ds_read_b64_tr_b16 v[42:43], v3 offset:53760
    s_add_u32 m0, s16, 81920
    s_nop 0
    buffer_load_dwordx4 v5, s[28:31], s46 offen lds
    s_waitcnt lgkmcnt(6)
    v_mfma_f32_32x32x16_bf16 v[64:79], v[28:31], v[144:147], v[64:79]
    ds_read_b64_tr_b16 v[44:45], v3 offset:61440
    ds_read_b64_tr_b16 v[46:47], v3 offset:61952
    s_add_u32 m0, s16, 90112
    s_nop 0
    buffer_load_dwordx4 v5, s[32:35], s46 offen lds
    s_waitcnt lgkmcnt(6)
    v_mfma_f32_32x32x16_bf16 v[48:63], v[32:35], v[148:151], v[48:63]
    ds_read_b64_tr_b16 v[28:29], v3 offset:55296
    ds_read_b64_tr_b16 v[30:31], v3 offset:55808
    s_waitcnt lgkmcnt(6)
    v_mfma_f32_32x32x16_bf16 v[64:79], v[36:39], v[148:151], v[64:79]
    ds_read_b64_tr_b16 v[32:33], v3 offset:63488
    ds_read_b64_tr_b16 v[34:35], v3 offset:64000
    s_waitcnt lgkmcnt(6)
    v_mfma_f32_32x32x16_bf16 v[48:63], v[40:43], v[152:155], v[48:63]
    s_waitcnt vmcnt(8)
    s_barrier
    ds_read_b128 v[160:163], v82 offset:32768
    ds_read_b128 v[164:167], v83 offset:32768
    ds_read_b128 v[168:171], v84 offset:32768
    ds_read_b128 v[172:175], v85 offset:32768
    ds_read_b64_tr_b16 v[36:37], v4
    ds_read_b64_tr_b16 v[38:39], v4 offset:512
    s_waitcnt lgkmcnt(10)
    v_mfma_f32_32x32x16_bf16 v[64:79], v[44:47], v[152:155], v[64:79]
    ds_read_b64_tr_b16 v[40:41], v4 offset:8192
    ds_read_b64_tr_b16 v[42:43], v4 offset:8704
    s_add_u32 m0, s16, 16384
    s_nop 0
    buffer_load_dwordx4 v80, s[24:27], s57 offen lds
    s_waitcnt lgkmcnt(10)
    v_mfma_f32_32x32x16_bf16 v[48:63], v[28:31], v[156:159], v[48:63]
    ds_read_b64_tr_b16 v[44:45], v4 offset:2048
    ds_read_b64_tr_b16 v[46:47], v4 offset:2560
    s_add_u32 m0, s16, 24576
    s_nop 0
    buffer_load_dwordx4 v81, s[24:27], s57 offen lds
    s_waitcnt lgkmcnt(10)
    v_mfma_f32_32x32x16_bf16 v[64:79], v[32:35], v[156:159], v[64:79]
    ds_read_b64_tr_b16 v[28:29], v4 offset:10240
    ds_read_b64_tr_b16 v[30:31], v4 offset:10752
    s_add_u32 m0, s16, 98304
    s_nop 0
    buffer_load_dwordx4 v5, s[28:31], s47 offen lds
    s_waitcnt lgkmcnt(6)
    v_mfma_f32_32x32x16_bf16 v[48:63], v[36:39], v[160:163], v[48:63]
    ds_read_b64_tr_b16 v[32:33], v4 offset:4096
    ds_read_b64_tr_b16 v[34:35], v4 offset:4608
    s_add_u32 m0, s16, 106496
    s_nop 0
    buffer_load_dwordx4 v5, s[32:35], s47 offen lds
    s_waitcnt lgkmcnt(6)
    v_mfma_f32_32x32x16_bf16 v[64:79], v[40:43], v[160:163], v[64:79]
    ds_read_b64_tr_b16 v[36:37], v4 offset:12288
    ds_read_b64_tr_b16 v[38:39], v4 offset:12800
    s_waitcnt lgkmcnt(6)
    v_mfma_f32_32x32x16_bf16 v[48:63], v[44:47], v[164:167], v[48:63]
    ds_read_b64_tr_b16 v[40:41], v4 offset:6144
    ds_read_b64_tr_b16 v[42:43], v4 offset:6656
    s_waitcnt lgkmcnt(6)
    v_mfma_f32_32x32x16_bf16 v[64:79], v[28:31], v[164:167], v[64:79]
    ds_read_b64_tr_b16 v[44:45], v4 offset:14336
    ds_read_b64_tr_b16 v[46:47], v4 offset:14848
    s_waitcnt lgkmcnt(6)
    v_mfma_f32_32x32x16_bf16 v[48:63], v[32:35], v[168:171], v[48:63]
    s_waitcnt vmcnt(8)
    s_barrier
    ds_read_b128 v[176:179], v82 offset:49152
    ds_read_b128 v[180:183], v83 offset:49152
    ds_read_b128 v[184:187], v84 offset:49152
    ds_read_b128 v[188:191], v85 offset:49152
    ds_read_b64_tr_b16 v[28:29], v3
    ds_read_b64_tr_b16 v[30:31], v3 offset:512
    s_waitcnt lgkmcnt(10)
    v_mfma_f32_32x32x16_bf16 v[64:79], v[36:39], v[168:171], v[64:79]
    ds_read_b64_tr_b16 v[32:33], v3 offset:8192
    ds_read_b64_tr_b16 v[34:35], v3 offset:8704
    s_add_u32 m0, s16, 32768
    s_nop 0
    buffer_load_dwordx4 v80, s[24:27], s58 offen lds
    s_waitcnt lgkmcnt(10)
    v_mfma_f32_32x32x16_bf16 v[48:63], v[40:43], v[172:175], v[48:63]
    ds_read_b64_tr_b16 v[36:37], v3 offset:2048
    ds_read_b64_tr_b16 v[38:39], v3 offset:2560
    s_add_u32 m0, s16, 40960
    s_nop 0
    buffer_load_dwordx4 v81, s[24:27], s58 offen lds
    s_waitcnt lgkmcnt(10)
    v_mfma_f32_32x32x16_bf16 v[64:79], v[44:47], v[172:175], v[64:79]
    ds_read_b64_tr_b16 v[40:41], v3 offset:10240
    ds_read_b64_tr_b16 v[42:43], v3 offset:10752
    s_add_u32 m0, s16, 114688
    s_nop 0
    buffer_load_dwordx4 v5, s[28:31], s48 offen lds
    s_waitcnt lgkmcnt(6)
    v_mfma_f32_32x32x16_bf16 v[48:63], v[28:31], v[176:179], v[48:63]
    ds_read_b64_tr_b16 v[44:45], v3 offset:4096
    ds_read_b64_tr_b16 v[46:47], v3 offset:4608
    s_add_u32 m0, s16, 122880
    s_nop 0
    buffer_load_dwordx4 v5, s[32:35], s48 offen lds
    s_waitcnt lgkmcnt(6)
    v_mfma_f32_32x32x16_bf16 v[64:79], v[32:35], v[176:179], v[64:79]
    ds_read_b64_tr_b16 v[28:29], v3 offset:12288
    ds_read_b64_tr_b16 v[30:31], v3 offset:12800
    s_waitcnt lgkmcnt(6)
    v_mfma_f32_32x32x16_bf16 v[48:63], v[36:39], v[180:183], v[48:63]
    ds_read_b64_tr_b16 v[32:33], v3 offset:6144
    ds_read_b64_tr_b16 v[34:35], v3 offset:6656
    s_waitcnt lgkmcnt(6)
    v_mfma_f32_32x32x16_bf16 v[64:79], v[40:43], v[180:183], v[64:79]
    ds_read_b64_tr_b16 v[36:37], v3 offset:14336
    ds_read_b64_tr_b16 v[38:39], v3 offset:14848
    s_waitcnt lgkmcnt(6)
    v_mfma_f32_32x32x16_bf16 v[48:63], v[44:47], v[184:187], v[48:63]
    s_waitcnt vmcnt(8)
    s_barrier
    ds_read_b128 v[192:195], v82
    ds_read_b128 v[196:199], v83
    ds_read_b128 v[200:203], v84
    ds_read_b128 v[204:207], v85
    ds_read_b64_tr_b16 v[40:41], v3 offset:16384
    ds_read_b64_tr_b16 v[42:43], v3 offset:16896
    v_mov_b32 v16, s60
    v_mov_b32 v17, s60
    v_mov_b32 v18, s60
    v_mov_b32 v19, s60
    s_and_b32 s4, s3, 3
    s_cmp_eq_u32 s4, 0
    s_cbranch_scc0 L_c29
    buffer_load_dword v16, v7, s[20:23], s14 offen offset:4 sc1
    buffer_load_dword v17, v7, s[20:23], s15 offen offset:4 sc1
    buffer_load_dword v18, v7, s[20:23], s14 offen offset:1028 sc1
    buffer_load_dword v19, v7, s[20:23], s15 offen offset:1028 sc1
L_c29:
    s_waitcnt lgkmcnt(10)
    v_mfma_f32_32x32x16_bf16 v[64:79], v[28:31], v[184:187], v[64:79]
    ds_read_b64_tr_b16 v[44:45], v3 offset:24576
    ds_read_b64_tr_b16 v[46:47], v3 offset:25088
    s_add_u32 m0, s16, 49152
    s_nop 0
    buffer_load_dwordx4 v80, s[24:27], s59 offen lds
    s_waitcnt lgkmcnt(10)
    v_mfma_f32_32x32x16_bf16 v[48:63], v[32:35], v[188:191], v[48:63]
    ds_read_b64_tr_b16 v[28:29], v3 offset:18432
    ds_read_b64_tr_b16 v[30:31], v3 offset:18944
    s_add_u32 m0, s16, 57344
    s_nop 0
    buffer_load_dwordx4 v81, s[24:27], s59 offen lds
    s_waitcnt lgkmcnt(10)
    v_mfma_f32_32x32x16_bf16 v[64:79], v[36:39], v[188:191], v[64:79]
    ds_read_b64_tr_b16 v[32:33], v3 offset:26624
    ds_read_b64_tr_b16 v[34:35], v3 offset:27136
    s_waitcnt lgkmcnt(6)
    v_mfma_f32_32x32x16_bf16 v[48:63], v[40:43], v[192:195], v[48:63]
    ds_read_b64_tr_b16 v[36:37], v3 offset:20480
    ds_read_b64_tr_b16 v[38:39], v3 offset:20992
    s_waitcnt lgkmcnt(6)
    v_mfma_f32_32x32x16_bf16 v[64:79], v[44:47], v[192:195], v[64:79]
    ds_read_b64_tr_b16 v[40:41], v3 offset:28672
    ds_read_b64_tr_b16 v[42:43], v3 offset:29184
    s_waitcnt lgkmcnt(6)
    v_mfma_f32_32x32x16_bf16 v[48:63], v[28:31], v[196:199], v[48:63]
    ds_read_b64_tr_b16 v[44:45], v3 offset:22528
    ds_read_b64_tr_b16 v[46:47], v3 offset:23040
    s_waitcnt lgkmcnt(6)
    v_mfma_f32_32x32x16_bf16 v[64:79], v[32:35], v[196:199], v[64:79]
    ds_read_b64_tr_b16 v[28:29], v3 offset:30720
    ds_read_b64_tr_b16 v[30:31], v3 offset:31232
    s_waitcnt lgkmcnt(6)
    v_mfma_f32_32x32x16_bf16 v[48:63], v[36:39], v[200:203], v[48:63]
    s_waitcnt vmcnt(6)
    s_barrier
    ds_read_b128 v[208:211], v82 offset:16384
    ds_read_b128 v[212:215], v83 offset:16384
    ds_read_b128 v[216:219], v84 offset:16384
    ds_read_b128 v[220:223], v85 offset:16384
    ds_read_b64_tr_b16 v[32:33], v3 offset:32768
    ds_read_b64_tr_b16 v[34:35], v3 offset:33280
    s_waitcnt lgkmcnt(10)
    v_mfma_f32_32x32x16_bf16 v[64:79], v[40:43], v[200:203], v[64:79]
    ds_read_b64_tr_b16 v[36:37], v3 offset:40960
    ds_read_b64_tr_b16 v[38:39], v3 offset:41472
    s_add_u32 m0, s16, 65536
    s_nop 0
    buffer_load_dwordx4 v5, s[28:31], s49 offen lds
    s_waitcnt lgkmcnt(10)
    v_mfma_f32_32x32x16_bf16 v[48:63], v[44:47], v[204:207], v[48:63]
    ds_read_b64_tr_b16 v[40:41], v3 offset:34816
    ds_read_b64_tr_b16 v[42:43], v3 offset:35328
    s_add_u32 m0, s16, 73728
    s_nop 0
    buffer_load_dwordx4 v5, s[32:35], s49 offen lds
    s_waitcnt lgkmcnt(10)
    v_mfma_f32_32x32x16_bf16 v[64:79], v[28:31], v[204:207], v[64:79]
    ds_read_b64_tr_b16 v[44:45], v3 offset:43008
    ds_read_b64_tr_b16 v[46:47], v3 offset:43520
    v_add_u32 v5, 128, v5
    s_add_u32 m0, s16, 0
    s_nop 0
    buffer_load_dwordx4 v5, s[28:31], s40 offen lds
    s_waitcnt lgkmcnt(6)
    v_mfma_f32_32x32x16_bf16 v[48:63], v[32:35], v[208:211], v[48:63]
    ds_read_b64_tr_b16 v[28:29], v3 offset:36864
    ds_read_b64_tr_b16 v[30:31], v3 offset:37376
    s_add_u32 m0, s16, 8192
    s_nop 0
    buffer_load_dwordx4 v5, s[28:31], s41 offen lds
    s_waitcnt lgkmcnt(6)
    v_mfma_f32_32x32x16_bf16 v[64:79], v[36:39], v[208:211], v[64:79]
    ds_read_b64_tr_b16 v[32:33], v3 offset:45056
    ds_read_b64_tr_b16 v[34:35], v3 offset:45568
    buffer_load_dwordx4 v[8:11], v86, s[36:39], s19 offen sc1
    s_waitcnt lgkmcnt(6)
    v_mfma_f32_32x32x16_bf16 v[48:63], v[40:43], v[212:215], v[48:63]
    ds_read_b64_tr_b16 v[36:37], v3 offset:38912
    ds_read_b64_tr_b16 v[38:39], v3 offset:39424
    s_waitcnt lgkmcnt(6)
    v_mfma_f32_32x32x16_bf16 v[64:79], v[44:47], v[212:215], v[64:79]
    ds_read_b64_tr_b16 v[40:41], v3 offset:47104
    ds_read_b64_tr_b16 v[42:43], v3 offset:47616
    s_waitcnt vmcnt(7)
    v_xor_b32 v27, s60, v16
    s_waitcnt vmcnt(7)
    v_bitop3_b32 v27, v27, v17, s60 bitop3:0xf6
    s_waitcnt vmcnt(7)
    v_bitop3_b32 v27, v27, v18, s60 bitop3:0xf6
    s_waitcnt vmcnt(7)
    v_bitop3_b32 v27, v27, v19, s60 bitop3:0xf6
    v_cmp_ne_u32 vcc, 0, v27
    s_nop 1
    s_cmp_lg_u64 vcc, 0
    s_cbranch_scc0 L_ck8_ok
L_ck8_sp:
    s_sleep 2
    buffer_load_dword v16, v7, s[20:23], s14 offen offset:4 sc1
    buffer_load_dword v17, v7, s[20:23], s15 offen offset:4 sc1
    buffer_load_dword v18, v7, s[20:23], s14 offen offset:1028 sc1
    buffer_load_dword v19, v7, s[20:23], s15 offen offset:1028 sc1
    s_waitcnt vmcnt(0)
    s_add_u32 s75, s75, 1
    s_cmp_gt_u32 s75, 30000
    s_cbranch_scc1 L_ck8_ok
    v_xor_b32 v27, s60, v16
    s_nop 3
    v_bitop3_b32 v27, v27, v17, s60 bitop3:0xf6
    s_nop 3
    v_bitop3_b32 v27, v27, v18, s60 bitop3:0xf6
    s_nop 3
    v_bitop3_b32 v27, v27, v19, s60 bitop3:0xf6
    s_nop 3
    v_cmp_ne_u32 vcc, 0, v27
    s_nop 3
    s_cmp_lg_u64 vcc, 0
    s_nop 3
    s_cbranch_scc1 L_ck8_sp
L_ck8_ok:
    s_waitcnt lgkmcnt(6)
    v_mfma_f32_32x32x16_bf16 v[48:63], v[28:31], v[216:219], v[48:63]
    s_barrier
    ds_read_b128 v[224:227], v82 offset:32768
    ds_read_b128 v[228:231], v83 offset:32768
    ds_read_b128 v[232:235], v84 offset:32768
    ds_read_b128 v[236:239], v85 offset:32768
    ds_read_b64_tr_b16 v[44:45], v3 offset:49152
    ds_read_b64_tr_b16 v[46:47], v3 offset:49664
    s_mov_b32 s68, s0
    s_mov_b32 s69, s1
    s_mov_b32 s70, 2211840
    s_mov_b32 s7, 92160
    s_cmp_ge_u32 s12, 90
    s_cselect_b32 s70, 819200, s70
    s_cselect_b32 s7, 10240, s7
    s_add_u32 s0, s76, s7
    s_add_u32 s1, s0, s7
    s_waitcnt lgkmcnt(10)
    v_mfma_f32_32x32x16_bf16 v[64:79], v[32:35], v[216:219], v[64:79]
    ds_read_b64_tr_b16 v[28:29], v3 offset:57344
    ds_read_b64_tr_b16 v[30:31], v3 offset:57856
    s_lshr_b32 s4, s3, 2
    s_mul_i32 s4, s4, s12
    s_cmp_ge_u32 s4, 90
    s_cselect_b32 s1, 1879048192, s1
    s_waitcnt lgkmcnt(10)
    v_mfma_f32_32x32x16_bf16 v[48:63], v[36:39], v[220:223], v[48:63]
    ds_read_b64_tr_b16 v[32:33], v3 offset:51200
    ds_read_b64_tr_b16 v[34:35], v3 offset:51712
    buffer_load_dword v12, v7, s[20:23], s14 offen sc1
    s_add_u32 m0, s16, 131072
    s_nop 0
    buffer_load_dwordx4 v20, s[68:71], s63 offen nt lds
    s_add_u32 s63, s63, 81920
    s_waitcnt lgkmcnt(10)
    v_mfma_f32_32x32x16_bf16 v[64:79], v[40:43], v[220:223], v[64:79]
    ds_read_b64_tr_b16 v[36:37], v3 offset:59392
    ds_read_b64_tr_b16 v[38:39], v3 offset:59904
    s_add_u32 m0, s16, 139264
    s_nop 0
    buffer_load_dwordx4 v20, s[68:71], s63 offen nt lds
    s_add_u32 s63, s63, 81920
    s_waitcnt lgkmcnt(6)
    v_mfma_f32_32x32x16_bf16 v[48:63], v[44:47], v[224:227], v[48:63]
    ds_read_b64_tr_b16 v[40:41], v3 offset:53248
    ds_read_b64_tr_b16 v[42:43], v3 offset:53760
    s_add_u32 m0, s16, 147456
    s_nop 0
    buffer_load_dwordx4 v20, s[68:71], s63 offen nt lds
    s_add_u32 s63, s63, 81920
    s_waitcnt lgkmcnt(6)
    v_mfma_f32_32x32x16_bf16 v[64:79], v[28:31], v[224:227], v[64:79]
    ds_read_b64_tr_b16 v[44:45], v3 offset:61440
    ds_read_b64_tr_b16 v[46:47], v3 offset:61952
    buffer_load_dword v14, v7, s[20:23], s15 offen sc1
    s_add_u32 m0, s16, 16384
    s_nop 0
    buffer_load_dwordx4 v5, s[28:31], s42 offen lds
    s_waitcnt lgkmcnt(6)
    v_mfma_f32_32x32x16_bf16 v[48:63], v[32:35], v[228:231], v[48:63]
    ds_read_b64_tr_b16 v[28:29], v3 offset:55296
    ds_read_b64_tr_b16 v[30:31], v3 offset:55808
    s_add_u32 m0, s16, 24576
    s_nop 0
    buffer_load_dwordx4 v5, s[28:31], s43 offen lds
    s_waitcnt lgkmcnt(6)
    v_mfma_f32_32x32x16_bf16 v[64:79], v[36:39], v[228:231], v[64:79]
    ds_read_b64_tr_b16 v[32:33], v3 offset:63488
    ds_read_b64_tr_b16 v[34:35], v3 offset:64000
    s_waitcnt lgkmcnt(6)
    v_mfma_f32_32x32x16_bf16 v[48:63], v[40:43], v[232:235], v[48:63]
    s_waitcnt vmcnt(10)
    s_barrier
    ds_read_b128 v[240:243], v82 offset:49152
    ds_read_b128 v[244:247], v83 offset:49152
    ds_read_b128 v[248:251], v84 offset:49152
    ds_read_b128 v[252:255], v85 offset:49152
    ds_read_b64_tr_b16 v[36:37], v3
    ds_read_b64_tr_b16 v[38:39], v3 offset:512
    s_waitcnt lgkmcnt(10)
    v_mfma_f32_32x32x16_bf16 v[64:79], v[44:47], v[232:235], v[64:79]
    ds_read_b64_tr_b16 v[40:41], v3 offset:8192
    ds_read_b64_tr_b16 v[42:43], v3 offset:8704
    s_add_u32 m0, s16, 32768
    s_nop 0
    buffer_load_dwordx4 v5, s[28:31], s44 offen lds
    s_waitcnt lgkmcnt(10)
    v_mfma_f32_32x32x16_bf16 v[48:63], v[28:31], v[236:239], v[48:63]
    ds_read_b64_tr_b16 v[44:45], v3 offset:2048
    ds_read_b64_tr_b16 v[46:47], v3 offset:2560
    s_add_u32 m0, s16, 40960
    s_nop 0
    buffer_load_dwordx4 v5, s[28:31], s45 offen lds
    s_waitcnt lgkmcnt(10)
    v_mfma_f32_32x32x16_bf16 v[64:79], v[32:35], v[236:239], v[64:79]
    ds_read_b64_tr_b16 v[28:29], v3 offset:10240
    ds_read_b64_tr_b16 v[30:31], v3 offset:10752
    s_waitcnt lgkmcnt(6)
    v_mfma_f32_32x32x16_bf16 v[48:63], v[36:39], v[240:243], v[48:63]
    ds_read_b64_tr_b16 v[32:33], v3 offset:4096
    ds_read_b64_tr_b16 v[34:35], v3 offset:4608
    s_waitcnt lgkmcnt(6)
    v_mfma_f32_32x32x16_bf16 v[64:79], v[40:43], v[240:243], v[64:79]
    ds_read_b64_tr_b16 v[36:37], v3 offset:12288
    ds_read_b64_tr_b16 v[38:39], v3 offset:12800
    s_waitcnt lgkmcnt(6)
    v_mfma_f32_32x32x16_bf16 v[48:63], v[44:47], v[244:247], v[48:63]
    ds_read_b64_tr_b16 v[40:41], v3 offset:6144
    ds_read_b64_tr_b16 v[42:43], v3 offset:6656
    s_waitcnt lgkmcnt(6)
    v_mfma_f32_32x32x16_bf16 v[64:79], v[28:31], v[244:247], v[64:79]
    ds_read_b64_tr_b16 v[44:45], v3 offset:14336
    ds_read_b64_tr_b16 v[46:47], v3 offset:14848
    s_waitcnt lgkmcnt(6)
    v_mfma_f32_32x32x16_bf16 v[48:63], v[32:35], v[248:251], v[48:63]
    s_waitcnt vmcnt(10)
    s_barrier
    ds_read_b64_tr_b16 v[28:29], v2
    ds_read_b64_tr_b16 v[30:31], v2 offset:512
    s_waitcnt lgkmcnt(6)
    v_mfma_f32_32x32x16_bf16 v[64:79], v[36:39], v[248:251], v[64:79]
    ds_read_b64_tr_b16 v[32:33], v2 offset:2048
    ds_read_b64_tr_b16 v[34:35], v2 offset:2560
    s_add_u32 m0, s16, 49152
    s_nop 0
    buffer_load_dwordx4 v5, s[28:31], s46 offen lds
    s_waitcnt lgkmcnt(6)
    v_mfma_f32_32x32x16_bf16 v[48:63], v[40:43], v[252:255], v[48:63]
    ds_read_b64_tr_b16 v[36:37], v2 offset:4096
    ds_read_b64_tr_b16 v[38:39], v2 offset:4608
    s_add_u32 m0, s16, 57344
    s_nop 0
    buffer_load_dwordx4 v5, s[28:31], s47 offen lds
    s_waitcnt lgkmcnt(6)
    v_mfma_f32_32x32x16_bf16 v[64:79], v[44:47], v[252:255], v[64:79]
    ds_read_b64_tr_b16 v[40:41], v2 offset:6144
    ds_read_b64_tr_b16 v[42:43], v2 offset:6656
    s_waitcnt vmcnt(11)
    v_xor_b32 v27, s60, v9
    v_cmp_ne_u32 vcc, 0, v27
    s_nop 1
    s_cmp_lg_u64 vcc, 0
    s_cbranch_scc0 L_ck9_ok
L_ck9_sp:
    s_sleep 2
    buffer_load_dwordx4 v[8:11], v86, s[36:39], s19 offen sc1
    s_waitcnt vmcnt(0)
    s_add_u32 s75, s75, 1
    s_cmp_gt_u32 s75, 30000
    s_cbranch_scc1 L_ck9_ok
    v_xor_b32 v27, s60, v9
    s_nop 3
    v_cmp_ne_u32 vcc, 0, v27
    s_nop 3
    s_cmp_lg_u64 vcc, 0
    s_nop 3
    s_cbranch_scc1 L_ck9_sp
L_ck9_ok:
    s_waitcnt vmcnt(10)
    v_perm_b32 v13, v12, v12, s62
    v_perm_b32 v12, v12, v12, s61
    s_waitcnt vmcnt(6)
    v_perm_b32 v15, v14, v14, s62
    v_perm_b32 v14, v14, v14, s61
    v_mov_b32 v9, v8
    v_mul_f32 v10, 0xbfb8aa3b, v10
    s_waitcnt lgkmcnt(6)
    v_mfma_f32_32x32x16_bf16 v[80:95], v[28:31], v[96:99], 0
    ds_read_b64_tr_b16 v[44:45], v2 offset:8192
    ds_read_b64_tr_b16 v[46:47], v2 offset:8704
    s_waitcnt lgkmcnt(6)
    v_mfma_f32_32x32x16_bf16 v[80:95], v[32:35], v[100:103], v[80:95]
    ds_read_b64_tr_b16 v[28:29], v2 offset:10240
    ds_read_b64_tr_b16 v[30:31], v2 offset:10752
    s_waitcnt lgkmcnt(6)
    v_mfma_f32_32x32x16_bf16 v[80:95], v[36:39], v[104:107], v[80:95]
    ds_read_b64_tr_b16 v[32:33], v2 offset:12288
    ds_read_b64_tr_b16 v[34:35], v2 offset:12800
    v_mfma_f32_32x32x8_bf16 v[48:63], v[12:13], v[8:9], v[48:63]
    v_mfma_f32_32x32x8_bf16 v[64:79], v[14:15], v[8:9], v[64:79]
    s_waitcnt lgkmcnt(6)
    v_mfma_f32_32x32x16_bf16 v[80:95], v[40:43], v[108:111], v[80:95]
    ds_read_b64_tr_b16 v[36:37], v2 offset:14336
    ds_read_b64_tr_b16 v[38:39], v2 offset:14848
    s_nop 6
    v_mul_f32 v16, v48, v10
    v_mul_f32 v17, v49, v10
    v_mul_f32 v18, v50, v10
    v_mul_f32 v19, v51, v10
    v_exp_f32 v16, v16
    s_waitcnt lgkmcnt(6)
    v_mfma_f32_32x32x16_bf16 v[80:95], v[44:47], v[112:115], v[80:95]
    s_waitcnt vmcnt(4)
    s_barrier
    ds_read_b64_tr_b16 v[40:41], v2 offset:16384
    ds_read_b64_tr_b16 v[42:43], v2 offset:16896
    v_exp_f32 v17, v17
    v_exp_f32 v18, v18
    v_exp_f32 v19, v19
    s_waitcnt lgkmcnt(6)
    v_mfma_f32_32x32x16_bf16 v[80:95], v[28:31], v[116:119], v[80:95]
    ds_read_b64_tr_b16 v[44:45], v2 offset:18432
    ds_read_b64_tr_b16 v[46:47], v2 offset:18944
    v_fma_f32 v16, v16, v11, v11
    v_fma_f32 v17, v17, v11, v11
    v_fma_f32 v18, v18, v11, v11
    v_fma_f32 v19, v19, v11, v11
    v_rcp_f32 v16, v16
    s_waitcnt lgkmcnt(6)
    v_mfma_f32_32x32x16_bf16 v[80:95], v[32:35], v[120:123], v[80:95]
    ds_read_b64_tr_b16 v[28:29], v2 offset:20480
    ds_read_b64_tr_b16 v[30:31], v2 offset:20992
    ds_read_b64_tr_b16 v[20:21], v25
    ds_read_b64_tr_b16 v[22:23], v25 offset:512
    s_add_u32 m0, s16, 65536
    s_nop 0
    buffer_load_dwordx4 v5, s[28:31], s48 offen lds
    v_rcp_f32 v17, v17
    v_rcp_f32 v18, v18
    s_waitcnt lgkmcnt(8)
    v_mfma_f32_32x32x16_bf16 v[80:95], v[36:39], v[124:127], v[80:95]
    ds_read_b64_tr_b16 v[32:33], v2 offset:22528
    ds_read_b64_tr_b16 v[34:35], v2 offset:23040
    v_rcp_f32 v19, v19
    v_mul_f32 v48, v48, v16
    v_mul_f32 v49, v49, v17
    v_mul_f32 v50, v50, v18
    s_waitcnt lgkmcnt(8)
    v_mfma_f32_32x32x16_bf16 v[80:95], v[40:43], v[128:131], v[80:95]
    ds_read_b64_tr_b16 v[36:37], v2 offset:24576
    ds_read_b64_tr_b16 v[38:39], v2 offset:25088
    s_add_u32 m0, s16, 73728
    s_nop 0
    buffer_load_dwordx4 v5, s[28:31], s49 offen lds
    v_mul_f32 v51, v51, v19
    v_mul_f32 v16, v52, v10
    v_mul_f32 v17, v53, v10
    v_mul_f32 v18, v54, v10
    s_waitcnt lgkmcnt(8)
    v_mfma_f32_32x32x16_bf16 v[80:95], v[44:47], v[132:135], v[80:95]
    ds_read_b64_tr_b16 v[40:41], v2 offset:26624
    ds_read_b64_tr_b16 v[42:43], v2 offset:27136
    s_waitcnt lgkmcnt(6)
    buffer_store_dwordx4 v[20:23], v0, s[20:23], s76 offen sc1
    v_mul_f32 v19, v55, v10
    v_exp_f32 v16, v16
    v_exp_f32 v17, v17
    v_mfma_f32_32x32x16_bf16 v[80:95], v[28:31], v[136:139], v[80:95]
    ds_read_b64_tr_b16 v[44:45], v2 offset:28672
    ds_read_b64_tr_b16 v[46:47], v2 offset:29184
    ds_read_b64_tr_b16 v[20:21], v25 offset:8192
    ds_read_b64_tr_b16 v[22:23], v25 offset:8704
    s_add_u32 m0, s16, 81920
    s_nop 0
    buffer_load_dwordx4 v5, s[32:35], s40 offen lds
    v_exp_f32 v18, v18
    v_exp_f32 v19, v19
    s_waitcnt lgkmcnt(8)
    v_mfma_f32_32x32x16_bf16 v[80:95], v[32:35], v[140:143], v[80:95]
    ds_read_b64_tr_b16 v[28:29], v2 offset:30720
    ds_read_b64_tr_b16 v[30:31], v2 offset:31232
    v_fma_f32 v16, v16, v11, v11
    v_fma_f32 v17, v17, v11, v11
    v_fma_f32 v18, v18, v11, v11
    v_fma_f32 v19, v19, v11, v11
    v_rcp_f32 v16, v16
    s_waitcnt lgkmcnt(8)
    v_mfma_f32_32x32x16_bf16 v[80:95], v[36:39], v[144:147], v[80:95]
    s_waitcnt vmcnt(6)
    s_barrier
    ds_read_b64_tr_b16 v[32:33], v2 offset:32768
    ds_read_b64_tr_b16 v[34:35], v2 offset:33280
    v_rcp_f32 v17, v17
    v_rcp_f32 v18, v18
    v_rcp_f32 v19, v19
    s_waitcnt lgkmcnt(8)
    v_mfma_f32_32x32x16_bf16 v[80:95], v[40:43], v[148:151], v[80:95]
    ds_read_b64_tr_b16 v[36:37], v2 offset:34816
    ds_read_b64_tr_b16 v[38:39], v2 offset:35328
    s_waitcnt lgkmcnt(6)
    buffer_store_dwordx4 v[20:23], v0, s[20:23], s0 offen sc1
    v_mul_f32 v52, v52, v16
    v_mul_f32 v53, v53, v17
    v_mul_f32 v54, v54, v18
    v_mul_f32 v55, v55, v19
    v_mul_f32 v16, v56, v10
    v_mfma_f32_32x32x16_bf16 v[80:95], v[44:47], v[152:155], v[80:95]
    ds_read_b64_tr_b16 v[40:41], v2 offset:36864
    ds_read_b64_tr_b16 v[42:43], v2 offset:37376
    ds_read_b64_tr_b16 v[20:21], v25 offset:16384
    ds_read_b64_tr_b16 v[22:23], v25 offset:16896
    s_add_u32 m0, s16, 90112
    s_nop 0
    buffer_load_dwordx4 v5, s[32:35], s41 offen lds
    v_mul_f32 v17, v57, v10
    v_mul_f32 v18, v58, v10
    v_mul_f32 v19, v59, v10
    v_exp_f32 v16, v16
    s_waitcnt lgkmcnt(8)
    v_mfma_f32_32x32x16_bf16 v[80:95], v[28:31], v[156:159], v[80:95]
    ds_read_b64_tr_b16 v[44:45], v2 offset:38912
    ds_read_b64_tr_b16 v[46:47], v2 offset:39424
    v_exp_f32 v17, v17
    v_exp_f32 v18, v18
    v_exp_f32 v19, v19
    s_waitcnt lgkmcnt(8)
    v_mfma_f32_32x32x16_bf16 v[80:95], v[32:35], v[160:163], v[80:95]
    ds_read_b64_tr_b16 v[28:29], v2 offset:40960
    ds_read_b64_tr_b16 v[30:31], v2 offset:41472
    s_add_u32 m0, s16, 98304
    s_nop 0
    buffer_load_dwordx4 v5, s[32:35], s42 offen lds
    v_fma_f32 v16, v16, v11, v11
    v_fma_f32 v17, v17, v11, v11
    v_fma_f32 v18, v18, v11, v11
    v_fma_f32 v19, v19, v11, v11
    s_waitcnt lgkmcnt(8)
    v_mfma_f32_32x32x16_bf16 v[80:95], v[36:39], v[164:167], v[80:95]
    ds_read_b64_tr_b16 v[32:33], v2 offset:43008
    ds_read_b64_tr_b16 v[34:35], v2 offset:43520
    s_waitcnt lgkmcnt(6)
    buffer_store_dwordx4 v[20:23], v0, s[20:23], s1 offen sc1
    v_rcp_f32 v16, v16
    v_rcp_f32 v17, v17
    v_rcp_f32 v18, v18
    v_mfma_f32_32x32x16_bf16 v[80:95], v[40:43], v[168:171], v[80:95]
    ds_read_b64_tr_b16 v[36:37], v2 offset:45056
    ds_read_b64_tr_b16 v[38:39], v2 offset:45568
    s_add_u32 m0, s16, 106496
    s_nop 0
    buffer_load_dwordx4 v5, s[32:35], s43 offen lds
    v_rcp_f32 v19, v19
    v_mul_f32 v56, v56, v16
    v_mul_f32 v57, v57, v17
    s_waitcnt lgkmcnt(6)
    v_mfma_f32_32x32x16_bf16 v[80:95], v[44:47], v[172:175], v[80:95]
    ds_read_b64_tr_b16 v[40:41], v2 offset:47104
    ds_read_b64_tr_b16 v[42:43], v2 offset:47616
    v_mul_f32 v58, v58, v18
    v_mul_f32 v59, v59, v19
    v_mul_f32 v16, v60, v10
    v_mul_f32 v17, v61, v10
    v_mul_f32 v18, v62, v10
    s_waitcnt lgkmcnt(6)
    v_mfma_f32_32x32x16_bf16 v[80:95], v[28:31], v[176:179], v[80:95]
    s_waitcnt vmcnt(9)
    s_barrier
    ds_read_b64_tr_b16 v[44:45], v2 offset:49152
    ds_read_b64_tr_b16 v[46:47], v2 offset:49664
    v_mul_f32 v19, v63, v10
    v_exp_f32 v16, v16
    v_exp_f32 v17, v17
    s_waitcnt lgkmcnt(6)
    v_mfma_f32_32x32x16_bf16 v[80:95], v[32:35], v[180:183], v[80:95]
    ds_read_b64_tr_b16 v[28:29], v2 offset:51200
    ds_read_b64_tr_b16 v[30:31], v2 offset:51712
    buffer_load_dword v12, v7, s[20:23], s14 offen offset:1024 sc1
    v_exp_f32 v18, v18
    v_exp_f32 v19, v19
    v_fma_f32 v16, v16, v11, v11
    s_waitcnt lgkmcnt(6)
    v_mfma_f32_32x32x16_bf16 v[80:95], v[36:39], v[184:187], v[80:95]
    ds_read_b64_tr_b16 v[32:33], v2 offset:53248
    ds_read_b64_tr_b16 v[34:35], v2 offset:53760
    s_add_u32 m0, s16, 114688
    s_nop 0
    buffer_load_dwordx4 v5, s[32:35], s44 offen lds
    v_fma_f32 v17, v17, v11, v11
    v_fma_f32 v18, v18, v11, v11
    v_fma_f32 v19, v19, v11, v11
    v_rcp_f32 v16, v16
    s_waitcnt lgkmcnt(6)
    v_mfma_f32_32x32x16_bf16 v[80:95], v[40:43], v[188:191], v[80:95]
    ds_read_b64_tr_b16 v[36:37], v2 offset:55296
    ds_read_b64_tr_b16 v[38:39], v2 offset:55808
    v_rcp_f32 v17, v17
    v_rcp_f32 v18, v18
    v_rcp_f32 v19, v19
    s_waitcnt lgkmcnt(6)
    v_mfma_f32_32x32x16_bf16 v[80:95], v[44:47], v[192:195], v[80:95]
    ds_read_b64_tr_b16 v[40:41], v2 offset:57344
    ds_read_b64_tr_b16 v[42:43], v2 offset:57856
    s_add_u32 m0, s16, 122880
    s_nop 0
    buffer_load_dwordx4 v5, s[32:35], s45 offen lds
    v_mul_f32 v60, v60, v16
    v_mul_f32 v61, v61, v17
    v_mul_f32 v62, v62, v18
    v_mul_f32 v63, v63, v19
    s_waitcnt lgkmcnt(6)
    v_mfma_f32_32x32x16_bf16 v[80:95], v[28:31], v[196:199], v[80:95]
    ds_read_b64_tr_b16 v[44:45], v2 offset:59392
    ds_read_b64_tr_b16 v[46:47], v2 offset:59904
    buffer_load_dword v14, v7, s[20:23], s15 offen offset:1024 sc1
    v_mul_f32 v48, v48, v64
    v_mul_f32 v49, v49, v65
    v_mul_f32 v50, v50, v66
    v_mul_f32 v51, v51, v67
    v_mul_f32 v52, v52, v68
    s_waitcnt lgkmcnt(6)
    v_mfma_f32_32x32x16_bf16 v[80:95], v[32:35], v[200:203], v[80:95]
    ds_read_b64_tr_b16 v[28:29], v2 offset:61440
    ds_read_b64_tr_b16 v[30:31], v2 offset:61952
    s_add_u32 m0, s16, 131072
    s_nop 0
    buffer_load_dwordx4 v5, s[32:35], s46 offen lds
    v_mul_f32 v53, v53, v69
    v_mul_f32 v54, v54, v70
    v_mul_f32 v55, v55, v71
    v_cvt_pk_bf16_f32 v20, v48, v49
    s_waitcnt lgkmcnt(6)
    v_mfma_f32_32x32x16_bf16 v[80:95], v[36:39], v[204:207], v[80:95]
    ds_read_b64_tr_b16 v[32:33], v2 offset:63488
    ds_read_b64_tr_b16 v[34:35], v2 offset:64000
    v_cvt_pk_bf16_f32 v21, v50, v51
    v_cvt_pk_bf16_f32 v22, v52, v53
    v_cvt_pk_bf16_f32 v23, v54, v55
    buffer_store_dwordx4 v[20:23], v6, s[20:23], s13 offen sc1
    v_mul_f32 v56, v56, v72
    s_waitcnt lgkmcnt(6)
    v_mfma_f32_32x32x16_bf16 v[80:95], v[40:43], v[208:211], v[80:95]
    s_waitcnt vmcnt(7)
    s_barrier
    s_cmp_eq_u32 s3, 0
    s_cbranch_scc0 L_c30
    s_add_u32 s9, s10, 0
    v_mov_b32 v27, s60
    buffer_store_dword v27, v26, s[20:23], s9 offen sc1
L_c30:
    ds_read_b64_tr_b16 v[36:37], v3
    ds_read_b64_tr_b16 v[38:39], v3 offset:512
    v_mul_f32 v57, v57, v73
    v_mul_f32 v58, v58, v74
    v_mul_f32 v59, v59, v75
    v_mul_f32 v60, v60, v76
    v_mul_f32 v61, v61, v77
    s_waitcnt lgkmcnt(6)
    v_mfma_f32_32x32x16_bf16 v[80:95], v[44:47], v[212:215], v[80:95]
    ds_read_b64_tr_b16 v[40:41], v3 offset:2048
    ds_read_b64_tr_b16 v[42:43], v3 offset:2560
    v_mul_f32 v62, v62, v78
    v_mul_f32 v63, v63, v79
    v_cvt_pk_bf16_f32 v20, v56, v57
    v_cvt_pk_bf16_f32 v21, v58, v59
    v_cvt_pk_bf16_f32 v22, v60, v61
    s_waitcnt lgkmcnt(6)
    v_mfma_f32_32x32x16_bf16 v[80:95], v[28:31], v[216:219], v[80:95]
    ds_read_b64_tr_b16 v[44:45], v3 offset:4096
    ds_read_b64_tr_b16 v[46:47], v3 offset:4608
    s_add_u32 m0, s16, 139264
    s_nop 0
    buffer_load_dwordx4 v5, s[32:35], s47 offen lds
    v_cvt_pk_bf16_f32 v23, v62, v63
    buffer_store_dwordx4 v[20:23], v6, s[20:23], s13 offen offset:512 sc1
    s_add_u32 s13, s13, 36864
    s_waitcnt lgkmcnt(6)
    v_mfma_f32_32x32x16_bf16 v[80:95], v[32:35], v[220:223], v[80:95]
    ds_read_b64_tr_b16 v[28:29], v3 offset:6144
    ds_read_b64_tr_b16 v[30:31], v3 offset:6656
    s_waitcnt lgkmcnt(6)
    v_mfma_f32_32x32x16_bf16 v[80:95], v[36:39], v[224:227], v[80:95]
    ds_read_b64_tr_b16 v[32:33], v3 offset:8192
    ds_read_b64_tr_b16 v[34:35], v3 offset:8704
    s_add_u32 m0, s16, 147456
    s_nop 0
    buffer_load_dwordx4 v5, s[32:35], s48 offen lds
    s_waitcnt lgkmcnt(6)
    v_mfma_f32_32x32x16_bf16 v[80:95], v[40:43], v[228:231], v[80:95]
    ds_read_b64_tr_b16 v[36:37], v3 offset:10240
    ds_read_b64_tr_b16 v[38:39], v3 offset:10752
    s_waitcnt lgkmcnt(6)
    v_mfma_f32_32x32x16_bf16 v[80:95], v[44:47], v[232:235], v[80:95]
    ds_read_b64_tr_b16 v[40:41], v3 offset:12288
    ds_read_b64_tr_b16 v[42:43], v3 offset:12800
    s_add_u32 m0, s16, 155648
    s_nop 0
    buffer_load_dwordx4 v5, s[32:35], s49 offen lds
    s_waitcnt lgkmcnt(6)
    v_mfma_f32_32x32x16_bf16 v[80:95], v[28:31], v[236:239], v[80:95]
    ds_read_b64_tr_b16 v[44:45], v3 offset:14336
    ds_read_b64_tr_b16 v[46:47], v3 offset:14848
    s_waitcnt lgkmcnt(6)
    v_mfma_f32_32x32x16_bf16 v[80:95], v[32:35], v[240:243], v[80:95]
    s_barrier
    ds_read_b64_tr_b16 v[28:29], v3 offset:16384
    ds_read_b64_tr_b16 v[30:31], v3 offset:16896
    s_waitcnt lgkmcnt(6)
    v_mfma_f32_32x32x16_bf16 v[80:95], v[36:39], v[244:247], v[80:95]
    ds_read_b64_tr_b16 v[32:33], v3 offset:18432
    ds_read_b64_tr_b16 v[34:35], v3 offset:18944
    s_waitcnt lgkmcnt(6)
    v_mfma_f32_32x32x16_bf16 v[80:95], v[40:43], v[248:251], v[80:95]
    ds_read_b64_tr_b16 v[36:37], v3 offset:20480
    ds_read_b64_tr_b16 v[38:39], v3 offset:20992
    v_add_u32 v5, 128, v5
    s_add_u32 m0, s16, 0
    s_nop 0
    buffer_load_dwordx4 v5, s[28:31], s40 offen lds
    s_waitcnt lgkmcnt(6)
    v_mfma_f32_32x32x16_bf16 v[80:95], v[44:47], v[252:255], v[80:95]
    ds_read_b64_tr_b16 v[40:41], v3 offset:22528
    ds_read_b64_tr_b16 v[42:43], v3 offset:23040
    s_waitcnt vmcnt(10)
    v_perm_b32 v13, v12, v12, s62
    v_perm_b32 v12, v12, v12, s61
    s_waitcnt lgkmcnt(6)
    v_mfma_f32_32x32x16_bf16 v[48:63], v[28:31], v[96:99], 0
    ds_read_b64_tr_b16 v[44:45], v3 offset:24576
    ds_read_b64_tr_b16 v[46:47], v3 offset:25088
    s_add_u32 m0, s16, 8192
    s_nop 0
    buffer_load_dwordx4 v5, s[28:31], s41 offen lds
    s_waitcnt lgkmcnt(6)
    v_mfma_f32_32x32x16_bf16 v[48:63], v[32:35], v[100:103], v[48:63]
    ds_read_b64_tr_b16 v[28:29], v3 offset:26624
    ds_read_b64_tr_b16 v[30:31], v3 offset:27136
    s_waitcnt lgkmcnt(6)
    v_mfma_f32_32x32x16_bf16 v[48:63], v[36:39], v[104:107], v[48:63]
    ds_read_b64_tr_b16 v[32:33], v3 offset:28672
    ds_read_b64_tr_b16 v[34:35], v3 offset:29184
    v_mfma_f32_32x32x8_bf16 v[80:95], v[12:13], v[8:9], v[80:95]
    s_add_u32 m0, s16, 16384
    s_nop 0
    buffer_load_dwordx4 v5, s[28:31], s42 offen lds
    s_waitcnt lgkmcnt(6)
    v_mfma_f32_32x32x16_bf16 v[48:63], v[40:43], v[108:111], v[48:63]
    ds_read_b64_tr_b16 v[36:37], v3 offset:30720
    ds_read_b64_tr_b16 v[38:39], v3 offset:31232
    s_waitcnt lgkmcnt(6)
    v_mfma_f32_32x32x16_bf16 v[48:63], v[44:47], v[112:115], v[48:63]
    s_barrier
    ds_read_b64_tr_b16 v[40:41], v3 offset:32768
    ds_read_b64_tr_b16 v[42:43], v3 offset:33280
    v_mul_f32 v16, v80, v10
    v_mul_f32 v17, v81, v10
    v_mul_f32 v18, v82, v10
    v_mul_f32 v19, v83, v10
    s_waitcnt lgkmcnt(6)
    v_mfma_f32_32x32x16_bf16 v[48:63], v[28:31], v[116:119], v[48:63]
    ds_read_b64_tr_b16 v[44:45], v3 offset:34816
    ds_read_b64_tr_b16 v[46:47], v3 offset:35328
    v_exp_f32 v16, v16
    v_exp_f32 v17, v17
    s_waitcnt lgkmcnt(6)
    v_mfma_f32_32x32x16_bf16 v[48:63], v[32:35], v[120:123], v[48:63]
    ds_read_b64_tr_b16 v[28:29], v3 offset:36864
    ds_read_b64_tr_b16 v[30:31], v3 offset:37376
    s_add_u32 m0, s16, 24576
    s_nop 0
    buffer_load_dwordx4 v5, s[28:31], s43 offen lds
    v_exp_f32 v18, v18
    v_exp_f32 v19, v19
    s_waitcnt lgkmcnt(6)
    v_mfma_f32_32x32x16_bf16 v[48:63], v[36:39], v[124:127], v[48:63]
    ds_read_b64_tr_b16 v[32:33], v3 offset:38912
    ds_read_b64_tr_b16 v[34:35], v3 offset:39424
    v_fma_f32 v16, v16, v11, v11
    v_fma_f32 v17, v17, v11, v11
    v_fma_f32 v18, v18, v11, v11
    v_fma_f32 v19, v19, v11, v11
    s_waitcnt lgkmcnt(6)
    v_mfma_f32_32x32x16_bf16 v[48:63], v[40:43], v[128:131], v[48:63]
    ds_read_b64_tr_b16 v[36:37], v3 offset:40960
    ds_read_b64_tr_b16 v[38:39], v3 offset:41472
    s_add_u32 m0, s16, 32768
    s_nop 0
    buffer_load_dwordx4 v5, s[28:31], s44 offen lds
    v_rcp_f32 v16, v16
    v_rcp_f32 v17, v17
    s_waitcnt lgkmcnt(6)
    v_mfma_f32_32x32x16_bf16 v[48:63], v[44:47], v[132:135], v[48:63]
    ds_read_b64_tr_b16 v[40:41], v3 offset:43008
    ds_read_b64_tr_b16 v[42:43], v3 offset:43520
    v_rcp_f32 v18, v18
    v_rcp_f32 v19, v19
    s_waitcnt lgkmcnt(6)
    v_mfma_f32_32x32x16_bf16 v[48:63], v[28:31], v[136:139], v[48:63]
    ds_read_b64_tr_b16 v[44:45], v3 offset:45056
    ds_read_b64_tr_b16 v[46:47], v3 offset:45568
    s_add_u32 m0, s16, 40960
    s_nop 0
    buffer_load_dwordx4 v5, s[28:31], s45 offen lds
    v_mul_f32 v80, v80, v16
    v_mul_f32 v81, v81, v17
    v_mul_f32 v82, v82, v18
    s_waitcnt lgkmcnt(6)
    v_mfma_f32_32x32x16_bf16 v[48:63], v[32:35], v[140:143], v[48:63]
    ds_read_b64_tr_b16 v[28:29], v3 offset:47104
    ds_read_b64_tr_b16 v[30:31], v3 offset:47616
    v_mul_f32 v83, v83, v19
    v_mul_f32 v16, v84, v10
    v_mul_f32 v17, v85, v10
    v_mul_f32 v18, v86, v10
    s_waitcnt lgkmcnt(6)
    v_mfma_f32_32x32x16_bf16 v[48:63], v[36:39], v[144:147], v[48:63]
    s_waitcnt vmcnt(8)
    s_barrier
    s_cmp_eq_u32 s3, 0
    s_cbranch_scc0 L_c31
    s_add_u32 s9, s17, 6144
    v_mov_b32 v27, s60
    buffer_store_dword v27, v26, s[20:23], s9 offen sc1
L_c31:
    ds_read_b64_tr_b16 v[32:33], v3 offset:49152
    ds_read_b64_tr_b16 v[34:35], v3 offset:49664
    v_mul_f32 v19, v87, v10
    v_exp_f32 v16, v16
    v_exp_f32 v17, v17
    s_waitcnt lgkmcnt(6)
    v_mfma_f32_32x32x16_bf16 v[48:63], v[40:43], v[148:151], v[48:63]
    ds_read_b64_tr_b16 v[36:37], v3 offset:51200
    ds_read_b64_tr_b16 v[38:39], v3 offset:51712
    v_exp_f32 v18, v18
    v_exp_f32 v19, v19
    s_waitcnt lgkmcnt(6)
    v_mfma_f32_32x32x16_bf16 v[48:63], v[44:47], v[152:155], v[48:63]
    ds_read_b64_tr_b16 v[40:41], v3 offset:53248
    ds_read_b64_tr_b16 v[42:43], v3 offset:53760
    s_add_u32 m0, s16, 49152
    s_nop 0
    buffer_load_dwordx4 v5, s[28:31], s46 offen lds
    v_fma_f32 v16, v16, v11, v11
    v_fma_f32 v17, v17, v11, v11
    v_fma_f32 v18, v18, v11, v11
    s_waitcnt lgkmcnt(6)
    v_mfma_f32_32x32x16_bf16 v[48:63], v[28:31], v[156:159], v[48:63]
    ds_read_b64_tr_b16 v[44:45], v3 offset:55296
    ds_read_b64_tr_b16 v[46:47], v3 offset:55808
    v_fma_f32 v19, v19, v11, v11
    v_rcp_f32 v16, v16
    v_rcp_f32 v17, v17
    s_waitcnt lgkmcnt(6)
    v_mfma_f32_32x32x16_bf16 v[48:63], v[32:35], v[160:163], v[48:63]
    ds_read_b64_tr_b16 v[28:29], v3 offset:57344
    ds_read_b64_tr_b16 v[30:31], v3 offset:57856
    s_add_u32 m0, s16, 57344
    s_nop 0
    buffer_load_dwordx4 v5, s[28:31], s47 offen lds
    v_rcp_f32 v18, v18
    v_rcp_f32 v19, v19
    s_waitcnt lgkmcnt(6)
    v_mfma_f32_32x32x16_bf16 v[48:63], v[36:39], v[164:167], v[48:63]
    ds_read_b64_tr_b16 v[32:33], v3 offset:59392
    ds_read_b64_tr_b16 v[34:35], v3 offset:59904
    v_mul_f32 v84, v84, v16
    v_mul_f32 v85, v85, v17
    v_mul_f32 v86, v86, v18
    v_mul_f32 v87, v87, v19
    s_waitcnt lgkmcnt(6)
    v_mfma_f32_32x32x16_bf16 v[48:63], v[40:43], v[168:171], v[48:63]
    ds_read_b64_tr_b16 v[36:37], v3 offset:61440
    ds_read_b64_tr_b16 v[38:39], v3 offset:61952
    s_add_u32 m0, s16, 65536
    s_nop 0
    buffer_load_dwordx4 v5, s[28:31], s48 offen lds
    v_mul_f32 v16, v88, v10
    v_mul_f32 v17, v89, v10
    v_mul_f32 v18, v90, v10
    s_waitcnt lgkmcnt(6)
    v_mfma_f32_32x32x16_bf16 v[48:63], v[44:47], v[172:175], v[48:63]
    ds_read_b64_tr_b16 v[40:41], v3 offset:63488
    ds_read_b64_tr_b16 v[42:43], v3 offset:64000
    v_mul_f32 v19, v91, v10
    v_exp_f32 v16, v16
    v_exp_f32 v17, v17
    s_waitcnt lgkmcnt(6)
    v_mfma_f32_32x32x16_bf16 v[48:63], v[28:31], v[176:179], v[48:63]
    s_barrier
    ds_read_b64_tr_b16 v[44:45], v4
    ds_read_b64_tr_b16 v[46:47], v4 offset:512
    v_exp_f32 v18, v18
    v_exp_f32 v19, v19
    s_waitcnt lgkmcnt(6)
    v_mfma_f32_32x32x16_bf16 v[48:63], v[32:35], v[180:183], v[48:63]
    ds_read_b64_tr_b16 v[28:29], v4 offset:2048
    ds_read_b64_tr_b16 v[30:31], v4 offset:2560
    v_fma_f32 v16, v16, v11, v11
    v_fma_f32 v17, v17, v11, v11
    v_fma_f32 v18, v18, v11, v11
    v_fma_f32 v19, v19, v11, v11
    s_waitcnt lgkmcnt(6)
    v_mfma_f32_32x32x16_bf16 v[48:63], v[36:39], v[184:187], v[48:63]
    ds_read_b64_tr_b16 v[32:33], v4 offset:4096
    ds_read_b64_tr_b16 v[34:35], v4 offset:4608
    s_add_u32 m0, s16, 73728
    s_nop 0
    buffer_load_dwordx4 v5, s[28:31], s49 offen lds
    v_rcp_f32 v16, v16
    v_rcp_f32 v17, v17
    s_waitcnt lgkmcnt(6)
    v_mfma_f32_32x32x16_bf16 v[48:63], v[40:43], v[188:191], v[48:63]
    ds_read_b64_tr_b16 v[36:37], v4 offset:6144
    ds_read_b64_tr_b16 v[38:39], v4 offset:6656
    v_rcp_f32 v18, v18
    v_rcp_f32 v19, v19
    s_waitcnt lgkmcnt(6)
    v_mfma_f32_32x32x16_bf16 v[48:63], v[44:47], v[192:195], v[48:63]
    ds_read_b64_tr_b16 v[40:41], v4 offset:8192
    ds_read_b64_tr_b16 v[42:43], v4 offset:8704
    s_add_u32 m0, s16, 81920
    s_nop 0
    buffer_load_dwordx4 v5, s[32:35], s40 offen lds
    v_mul_f32 v88, v88, v16
    v_mul_f32 v89, v89, v17
    v_mul_f32 v90, v90, v18
    s_waitcnt lgkmcnt(6)
    v_mfma_f32_32x32x16_bf16 v[48:63], v[28:31], v[196:199], v[48:63]
    ds_read_b64_tr_b16 v[44:45], v4 offset:10240
    ds_read_b64_tr_b16 v[46:47], v4 offset:10752
    v_mul_f32 v91, v91, v19
    v_mul_f32 v16, v92, v10
    v_mul_f32 v17, v93, v10
    v_mul_f32 v18, v94, v10
    s_waitcnt lgkmcnt(6)
    v_mfma_f32_32x32x16_bf16 v[48:63], v[32:35], v[200:203], v[48:63]
    ds_read_b64_tr_b16 v[28:29], v4 offset:12288
    ds_read_b64_tr_b16 v[30:31], v4 offset:12800
    s_add_u32 m0, s16, 90112
    s_nop 0
    buffer_load_dwordx4 v5, s[32:35], s41 offen lds
    v_mul_f32 v19, v95, v10
    v_exp_f32 v16, v16
    s_waitcnt lgkmcnt(6)
    v_mfma_f32_32x32x16_bf16 v[48:63], v[36:39], v[204:207], v[48:63]
    ds_read_b64_tr_b16 v[32:33], v4 offset:14336
    ds_read_b64_tr_b16 v[34:35], v4 offset:14848
    v_exp_f32 v17, v17
    v_exp_f32 v18, v18
    s_waitcnt lgkmcnt(6)
    v_mfma_f32_32x32x16_bf16 v[48:63], v[40:43], v[208:211], v[48:63]
    s_waitcnt vmcnt(12)
    s_barrier
    ds_read_b64_tr_b16 v[36:37], v4 offset:16384
    ds_read_b64_tr_b16 v[38:39], v4 offset:16896
    v_exp_f32 v19, v19
    v_fma_f32 v16, v16, v11, v11
    v_fma_f32 v17, v17, v11, v11
    s_waitcnt lgkmcnt(6)
    v_mfma_f32_32x32x16_bf16 v[48:63], v[44:47], v[212:215], v[48:63]
    ds_read_b64_tr_b16 v[40:41], v4 offset:18432
    ds_read_b64_tr_b16 v[42:43], v4 offset:18944
    v_fma_f32 v18, v18, v11, v11
    v_fma_f32 v19, v19, v11, v11
    v_rcp_f32 v16, v16
    s_waitcnt lgkmcnt(6)
    v_mfma_f32_32x32x16_bf16 v[48:63], v[28:31], v[216:219], v[48:63]
    ds_read_b64_tr_b16 v[44:45], v4 offset:20480
    ds_read_b64_tr_b16 v[46:47], v4 offset:20992
    s_add_u32 m0, s16, 98304
    s_nop 0
    buffer_load_dwordx4 v5, s[32:35], s42 offen lds
    v_rcp_f32 v17, v17
    v_rcp_f32 v18, v18
    s_waitcnt lgkmcnt(6)
    v_mfma_f32_32x32x16_bf16 v[48:63], v[32:35], v[220:223], v[48:63]
    ds_read_b64_tr_b16 v[28:29], v4 offset:22528
    ds_read_b64_tr_b16 v[30:31], v4 offset:23040
    v_rcp_f32 v19, v19
    v_mul_f32 v92, v92, v16
    v_mul_f32 v93, v93, v17
    s_waitcnt lgkmcnt(6)
    v_mfma_f32_32x32x16_bf16 v[48:63], v[36:39], v[224:227], v[48:63]
    ds_read_b64_tr_b16 v[32:33], v4 offset:24576
    ds_read_b64_tr_b16 v[34:35], v4 offset:25088
    s_add_u32 m0, s16, 106496
    s_nop 0
    buffer_load_dwordx4 v5, s[32:35], s43 offen lds
    v_mul_f32 v94, v94, v18
    v_mul_f32 v95, v95, v19
    s_waitcnt lgkmcnt(6)
    v_mfma_f32_32x32x16_bf16 v[48:63], v[40:43], v[228:231], v[48:63]
    ds_read_b64_tr_b16 v[36:37], v4 offset:26624
    ds_read_b64_tr_b16 v[38:39], v4 offset:27136
    s_add_u32 m0, s16, 114688
    s_nop 0
    buffer_load_dwordx4 v5, s[32:35], s44 offen lds
    s_waitcnt lgkmcnt(6)
    v_mfma_f32_32x32x16_bf16 v[48:63], v[44:47], v[232:235], v[48:63]
    ds_read_b64_tr_b16 v[40:41], v4 offset:28672
    ds_read_b64_tr_b16 v[42:43], v4 offset:29184
    s_mov_b32 s9, 15073280
    s_mov_b32 exec_lo, 0
    s_mov_b32 exec_hi, 67108863
    buffer_load_dword v25, v24, s[20:23], s9 offen sc1
    s_mov_b64 exec, -1
    s_waitcnt lgkmcnt(6)
    v_mfma_f32_32x32x16_bf16 v[48:63], v[28:31], v[236:239], v[48:63]
    ds_read_b64_tr_b16 v[44:45], v4 offset:30720
    ds_read_b64_tr_b16 v[46:47], v4 offset:31232
    s_waitcnt lgkmcnt(6)
    v_mfma_f32_32x32x16_bf16 v[48:63], v[32:35], v[240:243], v[48:63]
    s_waitcnt vmcnt(14)
    s_barrier
    ds_read_b64_tr_b16 v[28:29], v2
    ds_read_b64_tr_b16 v[30:31], v2 offset:512
    s_waitcnt lgkmcnt(6)
    v_mfma_f32_32x32x16_bf16 v[48:63], v[36:39], v[244:247], v[48:63]
    ds_read_b64_tr_b16 v[32:33], v2 offset:2048
    ds_read_b64_tr_b16 v[34:35], v2 offset:2560
    s_waitcnt lgkmcnt(6)
    v_mfma_f32_32x32x16_bf16 v[48:63], v[40:43], v[248:251], v[48:63]
    ds_read_b64_tr_b16 v[36:37], v2 offset:4096
    ds_read_b64_tr_b16 v[38:39], v2 offset:4608
    s_add_u32 m0, s16, 122880
    s_nop 0
    buffer_load_dwordx4 v5, s[32:35], s45 offen lds
    s_waitcnt lgkmcnt(6)
    v_mfma_f32_32x32x16_bf16 v[48:63], v[44:47], v[252:255], v[48:63]
    ds_read_b64_tr_b16 v[40:41], v2 offset:6144
    ds_read_b64_tr_b16 v[42:43], v2 offset:6656
    v_perm_b32 v15, v14, v14, s62
    v_perm_b32 v14, v14, v14, s61
    s_add_u32 m0, s16, 131072
    s_nop 0
    buffer_load_dwordx4 v5, s[32:35], s46 offen lds
    s_waitcnt lgkmcnt(6)
    v_mfma_f32_32x32x16_bf16 v[64:79], v[28:31], v[96:99], 0
    ds_read_b64_tr_b16 v[44:45], v2 offset:8192
    ds_read_b64_tr_b16 v[46:47], v2 offset:8704
    s_waitcnt lgkmcnt(6)
    v_mfma_f32_32x32x16_bf16 v[64:79], v[32:35], v[100:103], v[64:79]
    ds_read_b64_tr_b16 v[28:29], v2 offset:10240
    ds_read_b64_tr_b16 v[30:31], v2 offset:10752
    s_add_u32 m0, s16, 139264
    s_nop 0
    buffer_load_dwordx4 v5, s[32:35], s47 offen lds
    s_waitcnt lgkmcnt(6)
    v_mfma_f32_32x32x16_bf16 v[64:79], v[36:39], v[104:107], v[64:79]
    ds_read_b64_tr_b16 v[32:33], v2 offset:12288
    ds_read_b64_tr_b16 v[34:35], v2 offset:12800
    v_mfma_f32_32x32x8_bf16 v[48:63], v[14:15], v[8:9], v[48:63]
    s_waitcnt lgkmcnt(6)
    v_mfma_f32_32x32x16_bf16 v[64:79], v[40:43], v[108:111], v[64:79]
    ds_read_b64_tr_b16 v[36:37], v2 offset:14336
    ds_read_b64_tr_b16 v[38:39], v2 offset:14848
    s_waitcnt lgkmcnt(6)
    v_mfma_f32_32x32x16_bf16 v[64:79], v[44:47], v[112:115], v[64:79]
    s_waitcnt vmcnt(15)
    s_barrier
    ds_read_b64_tr_b16 v[40:41], v2 offset:16384
    ds_read_b64_tr_b16 v[42:43], v2 offset:16896
    v_mov_b32 v16, s60
    v_mov_b32 v17, s60
    s_and_b32 s4, s3, 3
    s_cmp_eq_u32 s4, 0
    s_cbranch_scc0 L_c32
    buffer_load_dword v16, v7, s[20:23], s14 offen offset:2052 sc1
    buffer_load_dword v17, v7, s[20:23], s15 offen offset:2052 sc1
L_c32:
    v_mul_f32 v80, v80, v48
    v_mul_f32 v81, v81, v49
    v_mul_f32 v82, v82, v50
    v_mul_f32 v83, v83, v51
    s_waitcnt lgkmcnt(6)
    v_mfma_f32_32x32x16_bf16 v[64:79], v[28:31], v[116:119], v[64:79]
    ds_read_b64_tr_b16 v[44:45], v2 offset:18432
    ds_read_b64_tr_b16 v[46:47], v2 offset:18944
    v_mul_f32 v84, v84, v52
    v_mul_f32 v85, v85, v53
    v_mul_f32 v86, v86, v54
    v_mul_f32 v87, v87, v55
    s_waitcnt lgkmcnt(6)
    v_mfma_f32_32x32x16_bf16 v[64:79], v[32:35], v[120:123], v[64:79]
    ds_read_b64_tr_b16 v[28:29], v2 offset:20480
    ds_read_b64_tr_b16 v[30:31], v2 offset:20992
    v_cvt_pk_bf16_f32 v20, v80, v81
    v_cvt_pk_bf16_f32 v21, v82, v83
    v_cvt_pk_bf16_f32 v22, v84, v85
    v_cvt_pk_bf16_f32 v23, v86, v87
    s_waitcnt lgkmcnt(6)
    v_mfma_f32_32x32x16_bf16 v[64:79], v[36:39], v[124:127], v[64:79]
    ds_read_b64_tr_b16 v[32:33], v2 offset:22528
    ds_read_b64_tr_b16 v[34:35], v2 offset:23040
    s_add_u32 m0, s16, 147456
    s_nop 0
    buffer_load_dwordx4 v5, s[32:35], s48 offen lds
    buffer_store_dwordx4 v[20:23], v6, s[20:23], s13 offen sc1
    v_mul_f32 v88, v88, v56
    v_mul_f32 v89, v89, v57
    s_waitcnt lgkmcnt(6)
    v_mfma_f32_32x32x16_bf16 v[64:79], v[40:43], v[128:131], v[64:79]
    ds_read_b64_tr_b16 v[36:37], v2 offset:24576
    ds_read_b64_tr_b16 v[38:39], v2 offset:25088
    s_waitcnt vmcnt(5)
    v_cmp_ne_u32 vcc, s60, v25
    s_nop 1
    s_and_b32 vcc_hi, vcc_hi, 67108863
    s_cbranch_scc0 L_ck10_ok
L_ck10_sp:
    s_sleep 2
    s_mov_b32 s9, 15073280
    s_mov_b32 exec_lo, 0
    s_mov_b32 exec_hi, 67108863
    buffer_load_dword v25, v24, s[20:23], s9 offen sc1
    s_mov_b64 exec, -1
    s_waitcnt vmcnt(0)
    s_add_u32 s75, s75, 1
    s_cmp_gt_u32 s75, 30000
    s_cbranch_scc1 L_ck10_ok
    v_cmp_ne_u32 vcc, s60, v25
    s_nop 3
    s_and_b32 vcc_hi, vcc_hi, 67108863
    s_nop 3
    s_cbranch_scc1 L_ck10_sp
L_ck10_ok:
    v_mul_f32 v90, v90, v58
    v_mul_f32 v91, v91, v59
    v_mul_f32 v92, v92, v60
    v_mul_f32 v93, v93, v61
    s_waitcnt lgkmcnt(6)
    v_mfma_f32_32x32x16_bf16 v[64:79], v[44:47], v[132:135], v[64:79]
    ds_read_b64_tr_b16 v[40:41], v2 offset:26624
    ds_read_b64_tr_b16 v[42:43], v2 offset:27136
    s_add_u32 m0, s16, 155648
    s_nop 0
    buffer_load_dwordx4 v5, s[32:35], s49 offen lds
    v_mul_f32 v94, v94, v62
    v_mul_f32 v95, v95, v63
    v_cvt_pk_bf16_f32 v20, v88, v89
    s_waitcnt lgkmcnt(6)
    v_mfma_f32_32x32x16_bf16 v[64:79], v[28:31], v[136:139], v[64:79]
    ds_read_b64_tr_b16 v[44:45], v2 offset:28672
    ds_read_b64_tr_b16 v[46:47], v2 offset:29184
    v_cvt_pk_bf16_f32 v21, v90, v91
    v_cvt_pk_bf16_f32 v22, v92, v93
    v_cvt_pk_bf16_f32 v23, v94, v95
    buffer_store_dwordx4 v[20:23], v6, s[20:23], s13 offen offset:512 sc1
    s_waitcnt lgkmcnt(6)
    v_mfma_f32_32x32x16_bf16 v[64:79], v[32:35], v[140:143], v[64:79]
    ds_read_b64_tr_b16 v[28:29], v2 offset:30720
    ds_read_b64_tr_b16 v[30:31], v2 offset:31232
    s_add_u32 s13, s13, 36864
    s_waitcnt lgkmcnt(6)
    v_mfma_f32_32x32x16_bf16 v[64:79], v[36:39], v[144:147], v[64:79]
    s_barrier
    ds_read_b64_tr_b16 v[32:33], v2 offset:32768
    ds_read_b64_tr_b16 v[34:35], v2 offset:33280
    s_waitcnt lgkmcnt(6)
    v_mfma_f32_32x32x16_bf16 v[64:79], v[40:43], v[148:151], v[64:79]
    ds_read_b64_tr_b16 v[36:37], v2 offset:34816
    ds_read_b64_tr_b16 v[38:39], v2 offset:35328
    s_waitcnt lgkmcnt(6)
    v_mfma_f32_32x32x16_bf16 v[64:79], v[44:47], v[152:155], v[64:79]
    ds_read_b64_tr_b16 v[40:41], v2 offset:36864
    ds_read_b64_tr_b16 v[42:43], v2 offset:37376
    s_waitcnt lgkmcnt(6)
    v_mfma_f32_32x32x16_bf16 v[64:79], v[28:31], v[156:159], v[64:79]
    ds_read_b64_tr_b16 v[44:45], v2 offset:38912
    ds_read_b64_tr_b16 v[46:47], v2 offset:39424
    s_add_u32 s9, s73, 0
    s_add_u32 m0, s16, 0
    s_nop 0
    buffer_load_dwordx4 v0, s[20:23], s9 offen sc1 lds
    s_waitcnt lgkmcnt(6)
    v_mfma_f32_32x32x16_bf16 v[64:79], v[32:35], v[160:163], v[64:79]
    ds_read_b64_tr_b16 v[28:29], v2 offset:40960
    ds_read_b64_tr_b16 v[30:31], v2 offset:41472
    s_waitcnt lgkmcnt(6)
    v_mfma_f32_32x32x16_bf16 v[64:79], v[36:39], v[164:167], v[64:79]
    ds_read_b64_tr_b16 v[32:33], v2 offset:43008
    ds_read_b64_tr_b16 v[34:35], v2 offset:43520
    s_add_u32 s9, s73, 123904
    buffer_load_dwordx4 v[80:83], v0, s[20:23], s9 offen sc1
    s_add_u32 s9, s73, 1024
    s_add_u32 m0, s16, 8192
    s_nop 0
    buffer_load_dwordx4 v0, s[20:23], s9 offen sc1 lds
    s_waitcnt lgkmcnt(6)
    v_mfma_f32_32x32x16_bf16 v[64:79], v[40:43], v[168:171], v[64:79]
    ds_read_b64_tr_b16 v[36:37], v2 offset:45056
    ds_read_b64_tr_b16 v[38:39], v2 offset:45568
    s_waitcnt lgkmcnt(6)
    v_mfma_f32_32x32x16_bf16 v[64:79], v[44:47], v[172:175], v[64:79]
    ds_read_b64_tr_b16 v[40:41], v2 offset:47104
    ds_read_b64_tr_b16 v[42:43], v2 offset:47616
    s_waitcnt vmcnt(7)
    v_xor_b32 v27, s60, v16
    s_waitcnt vmcnt(7)
    v_bitop3_b32 v27, v27, v17, s60 bitop3:0xf6
    v_cmp_ne_u32 vcc, 0, v27
    s_nop 1
    s_cmp_lg_u64 vcc, 0
    s_cbranch_scc0 L_ck11_ok
L_ck11_sp:
    s_sleep 2
    buffer_load_dword v16, v7, s[20:23], s14 offen offset:2052 sc1
    buffer_load_dword v17, v7, s[20:23], s15 offen offset:2052 sc1
    s_waitcnt vmcnt(0)
    s_add_u32 s75, s75, 1
    s_cmp_gt_u32 s75, 30000
    s_cbranch_scc1 L_ck11_ok
    v_xor_b32 v27, s60, v16
    s_nop 3
    v_bitop3_b32 v27, v27, v17, s60 bitop3:0xf6
    s_nop 3
    v_cmp_ne_u32 vcc, 0, v27
    s_nop 3
    s_cmp_lg_u64 vcc, 0
    s_nop 3
    s_cbranch_scc1 L_ck11_sp
L_ck11_ok:
    s_waitcnt lgkmcnt(6)
    v_mfma_f32_32x32x16_bf16 v[64:79], v[28:31], v[176:179], v[64:79]
    s_barrier
    ds_read_b64_tr_b16 v[44:45], v2 offset:49152
    ds_read_b64_tr_b16 v[46:47], v2 offset:49664
    s_waitcnt lgkmcnt(6)
    v_mfma_f32_32x32x16_bf16 v[64:79], v[32:35], v[180:183], v[64:79]
    ds_read_b64_tr_b16 v[28:29], v2 offset:51200
    ds_read_b64_tr_b16 v[30:31], v2 offset:51712
    s_waitcnt lgkmcnt(6)
    v_mfma_f32_32x32x16_bf16 v[64:79], v[36:39], v[184:187], v[64:79]
    ds_read_b64_tr_b16 v[32:33], v2 offset:53248
    ds_read_b64_tr_b16 v[34:35], v2 offset:53760
    buffer_load_dword v12, v7, s[20:23], s14 offen offset:2048 sc1
    s_waitcnt lgkmcnt(6)
    v_mfma_f32_32x32x16_bf16 v[64:79], v[40:43], v[188:191], v[64:79]
    ds_read_b64_tr_b16 v[36:37], v2 offset:55296
    ds_read_b64_tr_b16 v[38:39], v2 offset:55808
    s_add_u32 s9, s73, 124928
    buffer_load_dwordx4 v[84:87], v0, s[20:23], s9 offen sc1
    s_add_u32 s9, s73, 2048
    s_add_u32 m0, s16, 16384
    s_nop 0
    buffer_load_dwordx4 v0, s[20:23], s9 offen sc1 lds
    s_waitcnt lgkmcnt(6)
    v_mfma_f32_32x32x16_bf16 v[64:79], v[44:47], v[192:195], v[64:79]
    ds_read_b64_tr_b16 v[40:41], v2 offset:57344
    ds_read_b64_tr_b16 v[42:43], v2 offset:57856
    s_mov_b32 s9, 15079424
    s_mov_b32 exec_lo, 511
    s_mov_b32 exec_hi, 0
    buffer_load_dword v25, v24, s[20:23], s9 offen sc1
    s_mov_b64 exec, -1
    s_waitcnt lgkmcnt(6)
    v_mfma_f32_32x32x16_bf16 v[64:79], v[28:31], v[196:199], v[64:79]
    ds_read_b64_tr_b16 v[44:45], v2 offset:59392
    ds_read_b64_tr_b16 v[46:47], v2 offset:59904
    s_add_u32 s9, s73, 3072
    s_add_u32 m0, s16, 24576
    s_nop 0
    buffer_load_dwordx4 v0, s[20:23], s9 offen sc1 lds
    s_waitcnt lgkmcnt(6)
    v_mfma_f32_32x32x16_bf16 v[64:79], v[32:35], v[200:203], v[64:79]
    ds_read_b64_tr_b16 v[28:29], v2 offset:61440
    ds_read_b64_tr_b16 v[30:31], v2 offset:61952
    buffer_load_dword v14, v7, s[20:23], s15 offen offset:2048 sc1
    s_waitcnt lgkmcnt(6)
    v_mfma_f32_32x32x16_bf16 v[64:79], v[36:39], v[204:207], v[64:79]
    ds_read_b64_tr_b16 v[32:33], v2 offset:63488
    ds_read_b64_tr_b16 v[34:35], v2 offset:64000
    s_waitcnt lgkmcnt(6)
    v_mfma_f32_32x32x16_bf16 v[64:79], v[40:43], v[208:211], v[64:79]
    s_waitcnt vmcnt(9)
    s_barrier
    s_cmp_eq_u32 s3, 0
    s_cbranch_scc0 L_c33
    s_add_u32 s9, s17, 8192
    v_mov_b32 v27, s60
    buffer_store_dword v27, v26, s[20:23], s9 offen sc1
L_c33:
    ds_read_b64_tr_b16 v[36:37], v3
    ds_read_b64_tr_b16 v[38:39], v3 offset:512
    s_waitcnt lgkmcnt(6)
    v_mfma_f32_32x32x16_bf16 v[64:79], v[44:47], v[212:215], v[64:79]
    ds_read_b64_tr_b16 v[40:41], v3 offset:2048
    ds_read_b64_tr_b16 v[42:43], v3 offset:2560
    s_add_u32 s9, s73, 125952
    buffer_load_dwordx4 v[88:91], v0, s[20:23], s9 offen sc1
    s_waitcnt lgkmcnt(6)
    v_mfma_f32_32x32x16_bf16 v[64:79], v[28:31], v[216:219], v[64:79]
    ds_read_b64_tr_b16 v[44:45], v3 offset:4096
    ds_read_b64_tr_b16 v[46:47], v3 offset:4608
    s_waitcnt lgkmcnt(6)
    v_mfma_f32_32x32x16_bf16 v[64:79], v[32:35], v[220:223], v[64:79]
    ds_read_b64_tr_b16 v[28:29], v3 offset:6144
    ds_read_b64_tr_b16 v[30:31], v3 offset:6656
    s_add_u32 s9, s73, 4096
    s_add_u32 m0, s16, 32768
    s_nop 0
    buffer_load_dwordx4 v0, s[20:23], s9 offen sc1 lds
    s_waitcnt lgkmcnt(6)
    v_mfma_f32_32x32x16_bf16 v[64:79], v[36:39], v[224:227], v[64:79]
    ds_read_b64_tr_b16 v[32:33], v3 offset:8192
    ds_read_b64_tr_b16 v[34:35], v3 offset:8704
    s_waitcnt lgkmcnt(6)
    v_mfma_f32_32x32x16_bf16 v[64:79], v[40:43], v[228:231], v[64:79]
    ds_read_b64_tr_b16 v[36:37], v3 offset:10240
    ds_read_b64_tr_b16 v[38:39], v3 offset:10752
    s_add_u32 s9, s73, 40960
    s_add_u32 m0, s16, 40960
    s_nop 0
    buffer_load_dwordx4 v0, s[20:23], s9 offen sc1 lds
    s_waitcnt lgkmcnt(6)
    v_mfma_f32_32x32x16_bf16 v[64:79], v[44:47], v[232:235], v[64:79]
    ds_read_b64_tr_b16 v[40:41], v3 offset:12288
    ds_read_b64_tr_b16 v[42:43], v3 offset:12800
    s_waitcnt lgkmcnt(6)
    v_mfma_f32_32x32x16_bf16 v[64:79], v[28:31], v[236:239], v[64:79]
    ds_read_b64_tr_b16 v[44:45], v3 offset:14336
    ds_read_b64_tr_b16 v[46:47], v3 offset:14848
    s_add_u32 s9, s73, 126976
    buffer_load_dwordx4 v[92:95], v0, s[20:23], s9 offen sc1
    s_waitcnt lgkmcnt(6)
    v_mfma_f32_32x32x16_bf16 v[64:79], v[32:35], v[240:243], v[64:79]
    s_barrier
    ds_read_b64_tr_b16 v[28:29], v3 offset:16384
    ds_read_b64_tr_b16 v[30:31], v3 offset:16896
    s_waitcnt lgkmcnt(6)
    v_mfma_f32_32x32x16_bf16 v[64:79], v[36:39], v[244:247], v[64:79]
    ds_read_b64_tr_b16 v[32:33], v3 offset:18432
    ds_read_b64_tr_b16 v[34:35], v3 offset:18944
    s_waitcnt lgkmcnt(6)
    v_mfma_f32_32x32x16_bf16 v[64:79], v[40:43], v[248:251], v[64:79]
    ds_read_b64_tr_b16 v[36:37], v3 offset:20480
    ds_read_b64_tr_b16 v[38:39], v3 offset:20992
    s_waitcnt vmcnt(6)
    v_cmp_ne_u32 vcc, s60, v25
    s_nop 1
    s_and_b32 vcc_lo, vcc_lo, 511
    s_cbranch_scc0 L_ck12_ok
L_ck12_sp:
    s_sleep 2
    s_mov_b32 s9, 15079424
    s_mov_b32 exec_lo, 511
    s_mov_b32 exec_hi, 0
    buffer_load_dword v25, v24, s[20:23], s9 offen sc1
    s_mov_b64 exec, -1
    s_waitcnt vmcnt(0)
    s_add_u32 s75, s75, 1
    s_cmp_gt_u32 s75, 30000
    s_cbranch_scc1 L_ck12_ok
    v_cmp_ne_u32 vcc, s60, v25
    s_nop 3
    s_and_b32 vcc_lo, vcc_lo, 511
    s_nop 3
    s_cbranch_scc1 L_ck12_sp
L_ck12_ok:
    s_waitcnt lgkmcnt(6)
    v_mfma_f32_32x32x16_bf16 v[64:79], v[44:47], v[252:255], v[64:79]
    ds_read_b64_tr_b16 v[40:41], v3 offset:22528
    ds_read_b64_tr_b16 v[42:43], v3 offset:23040
    v_perm_b32 v13, v12, v12, s62
    v_perm_b32 v12, v12, v12, s61
    s_add_u32 s9, s73, 41984
    s_add_u32 m0, s16, 49152
    s_nop 0
    buffer_load_dwordx4 v0, s[20:23], s9 offen sc1 lds
    s_waitcnt lgkmcnt(6)
    v_mfma_f32_32x32x16_bf16 v[48:63], v[28:31], v[96:99], 0
    ds_read_b64_tr_b16 v[44:45], v3 offset:24576
    ds_read_b64_tr_b16 v[46:47], v3 offset:25088
    s_waitcnt lgkmcnt(6)
    v_mfma_f32_32x32x16_bf16 v[48:63], v[32:35], v[100:103], v[48:63]
    ds_read_b64_tr_b16 v[28:29], v3 offset:26624
    ds_read_b64_tr_b16 v[30:31], v3 offset:27136
    s_add_u32 s9, s73, 43008
    s_add_u32 m0, s16, 57344
    s_nop 0
    buffer_load_dwordx4 v0, s[20:23], s9 offen sc1 lds
    s_waitcnt lgkmcnt(6)
    v_mfma_f32_32x32x16_bf16 v[48:63], v[36:39], v[104:107], v[48:63]
    ds_read_b64_tr_b16 v[32:33], v3 offset:28672
    ds_read_b64_tr_b16 v[34:35], v3 offset:29184
    v_mfma_f32_32x32x8_bf16 v[64:79], v[12:13], v[8:9], v[64:79]
    s_waitcnt lgkmcnt(6)
    v_mfma_f32_32x32x16_bf16 v[48:63], v[40:43], v[108:111], v[48:63]
    ds_read_b64_tr_b16 v[36:37], v3 offset:30720
    ds_read_b64_tr_b16 v[38:39], v3 offset:31232
    s_add_u32 s9, s72, 0
    buffer_load_dwordx4 v[96:99], v0, s[20:23], s9 offen sc1
    s_waitcnt lgkmcnt(6)
    v_mfma_f32_32x32x16_bf16 v[48:63], v[44:47], v[112:115], v[48:63]
    s_barrier
    ds_read_b64_tr_b16 v[40:41], v3 offset:32768
    ds_read_b64_tr_b16 v[42:43], v3 offset:33280
    s_nop 0
    v_mul_f32 v16, v64, v10
    v_mul_f32 v17, v65, v10
    v_mul_f32 v18, v66, v10
    v_mul_f32 v19, v67, v10
    s_waitcnt lgkmcnt(6)
    v_mfma_f32_32x32x16_bf16 v[48:63], v[28:31], v[116:119], v[48:63]
    ds_read_b64_tr_b16 v[44:45], v3 offset:34816
    ds_read_b64_tr_b16 v[46:47], v3 offset:35328
    s_add_u32 s9, s72, 4096
    buffer_load_dwordx4 v[100:103], v0, s[20:23], s9 offen sc1
    v_exp_f32 v16, v16
    v_exp_f32 v17, v17
    s_waitcnt lgkmcnt(6)
    v_mfma_f32_32x32x16_bf16 v[48:63], v[32:35], v[120:123], v[48:63]
    ds_read_b64_tr_b16 v[28:29], v3 offset:36864
    ds_read_b64_tr_b16 v[30:31], v3 offset:37376
    v_exp_f32 v18, v18
    v_exp_f32 v19, v19
    s_waitcnt lgkmcnt(6)
    v_mfma_f32_32x32x16_bf16 v[48:63], v[36:39], v[124:127], v[48:63]
    ds_read_b64_tr_b16 v[32:33], v3 offset:38912
    ds_read_b64_tr_b16 v[34:35], v3 offset:39424
    s_add_u32 s9, s73, 44032
    s_add_u32 m0, s16, 65536
    s_nop 0
    buffer_load_dwordx4 v0, s[20:23], s9 offen sc1 lds
    v_fma_f32 v16, v16, v11, v11
    v_fma_f32 v17, v17, v11, v11
    v_fma_f32 v18, v18, v11, v11
    s_waitcnt lgkmcnt(6)
    v_mfma_f32_32x32x16_bf16 v[48:63], v[40:43], v[128:131], v[48:63]
    ds_read_b64_tr_b16 v[36:37], v3 offset:40960
    ds_read_b64_tr_b16 v[38:39], v3 offset:41472
    v_fma_f32 v19, v19, v11, v11
    v_rcp_f32 v16, v16
    v_rcp_f32 v17, v17
    s_waitcnt lgkmcnt(6)
    v_mfma_f32_32x32x16_bf16 v[48:63], v[44:47], v[132:135], v[48:63]
    ds_read_b64_tr_b16 v[40:41], v3 offset:43008
    ds_read_b64_tr_b16 v[42:43], v3 offset:43520
    s_add_u32 s9, s73, 45056
    s_add_u32 m0, s16, 73728
    s_nop 0
    buffer_load_dwordx4 v0, s[20:23], s9 offen sc1 lds
    v_rcp_f32 v18, v18
    v_rcp_f32 v19, v19
    s_waitcnt lgkmcnt(6)
    v_mfma_f32_32x32x16_bf16 v[48:63], v[28:31], v[136:139], v[48:63]
    ds_read_b64_tr_b16 v[44:45], v3 offset:45056
    ds_read_b64_tr_b16 v[46:47], v3 offset:45568
    v_mul_f32 v64, v64, v16
    v_mul_f32 v65, v65, v17
    v_mul_f32 v66, v66, v18
    v_mul_f32 v67, v67, v19
    s_waitcnt lgkmcnt(6)
    v_mfma_f32_32x32x16_bf16 v[48:63], v[32:35], v[140:143], v[48:63]
    ds_read_b64_tr_b16 v[28:29], v3 offset:47104
    ds_read_b64_tr_b16 v[30:31], v3 offset:47616
    s_add_u32 s9, s72, 8192
    buffer_load_dwordx4 v[104:107], v0, s[20:23], s9 offen sc1
    v_mul_f32 v16, v68, v10
    v_mul_f32 v17, v69, v10
    v_mul_f32 v18, v70, v10
    s_waitcnt lgkmcnt(6)
    v_mfma_f32_32x32x16_bf16 v[48:63], v[36:39], v[144:147], v[48:63]
    s_barrier
    ds_read_b64_tr_b16 v[32:33], v3 offset:49152
    ds_read_b64_tr_b16 v[34:35], v3 offset:49664
    v_mul_f32 v19, v71, v10
    v_exp_f32 v16, v16
    v_exp_f32 v17, v17
    s_waitcnt lgkmcnt(6)
    v_mfma_f32_32x32x16_bf16 v[48:63], v[40:43], v[148:151], v[48:63]
    ds_read_b64_tr_b16 v[36:37], v3 offset:51200
    ds_read_b64_tr_b16 v[38:39], v3 offset:51712
    s_add_u32 s9, s72, 12288
    buffer_load_dwordx4 v[108:111], v0, s[20:23], s9 offen sc1
    v_exp_f32 v18, v18
    v_exp_f32 v19, v19
    s_waitcnt lgkmcnt(6)
    v_mfma_f32_32x32x16_bf16 v[48:63], v[44:47], v[152:155], v[48:63]
    ds_read_b64_tr_b16 v[40:41], v3 offset:53248
    ds_read_b64_tr_b16 v[42:43], v3 offset:53760
    v_fma_f32 v16, v16, v11, v11
    v_fma_f32 v17, v17, v11, v11
    v_fma_f32 v18, v18, v11, v11
    v_fma_f32 v19, v19, v11, v11
    s_waitcnt lgkmcnt(6)
    v_mfma_f32_32x32x16_bf16 v[48:63], v[28:31], v[156:159], v[48:63]
    ds_read_b64_tr_b16 v[44:45], v3 offset:55296
    ds_read_b64_tr_b16 v[46:47], v3 offset:55808
    s_add_u32 s9, s73, 81920
    s_add_u32 m0, s16, 81920
    s_nop 0
    buffer_load_dwordx4 v0, s[20:23], s9 offen sc1 lds
    v_rcp_f32 v16, v16
    v_rcp_f32 v17, v17
    s_waitcnt lgkmcnt(6)
    v_mfma_f32_32x32x16_bf16 v[48:63], v[32:35], v[160:163], v[48:63]
    ds_read_b64_tr_b16 v[28:29], v3 offset:57344
    ds_read_b64_tr_b16 v[30:31], v3 offset:57856
    v_rcp_f32 v18, v18
    v_rcp_f32 v19, v19
    s_waitcnt lgkmcnt(6)
    v_mfma_f32_32x32x16_bf16 v[48:63], v[36:39], v[164:167], v[48:63]
    ds_read_b64_tr_b16 v[32:33], v3 offset:59392
    ds_read_b64_tr_b16 v[34:35], v3 offset:59904
    s_add_u32 s9, s73, 82944
    s_add_u32 m0, s16, 90112
    s_nop 0
    buffer_load_dwordx4 v0, s[20:23], s9 offen sc1 lds
    v_mul_f32 v68, v68, v16
    v_mul_f32 v69, v69, v17
    v_mul_f32 v70, v70, v18
    s_waitcnt lgkmcnt(6)
    v_mfma_f32_32x32x16_bf16 v[48:63], v[40:43], v[168:171], v[48:63]
    ds_read_b64_tr_b16 v[36:37], v3 offset:61440
    ds_read_b64_tr_b16 v[38:39], v3 offset:61952
    v_mul_f32 v71, v71, v19
    v_mul_f32 v16, v72, v10
    v_mul_f32 v17, v73, v10
    v_mul_f32 v18, v74, v10
    s_waitcnt lgkmcnt(6)
    v_mfma_f32_32x32x16_bf16 v[48:63], v[44:47], v[172:175], v[48:63]
    ds_read_b64_tr_b16 v[40:41], v3 offset:63488
    ds_read_b64_tr_b16 v[42:43], v3 offset:64000
    s_add_u32 s9, s72, 16384
    buffer_load_dwordx4 v[112:115], v0, s[20:23], s9 offen sc1
    v_mul_f32 v19, v75, v10
    v_exp_f32 v16, v16
    s_waitcnt lgkmcnt(6)
    v_mfma_f32_32x32x16_bf16 v[48:63], v[28:31], v[176:179], v[48:63]
    s_barrier
    ds_read_b64_tr_b16 v[44:45], v4
    ds_read_b64_tr_b16 v[46:47], v4 offset:512
    s_waitcnt vmcnt(15)
    v_perm_b32 v15, v14, v14, s62
    v_perm_b32 v14, v14, v14, s61
    v_exp_f32 v17, v17
    v_exp_f32 v18, v18
    s_waitcnt lgkmcnt(6)
    v_mfma_f32_32x32x16_bf16 v[48:63], v[32:35], v[180:183], v[48:63]
    ds_read_b64_tr_b16 v[28:29], v4 offset:2048
    ds_read_b64_tr_b16 v[30:31], v4 offset:2560
    s_add_u32 s9, s72, 20480
    buffer_load_dwordx4 v[116:119], v0, s[20:23], s9 offen sc1
    v_exp_f32 v19, v19
    v_fma_f32 v16, v16, v11, v11
    s_waitcnt lgkmcnt(6)
    v_mfma_f32_32x32x16_bf16 v[48:63], v[36:39], v[184:187], v[48:63]
    ds_read_b64_tr_b16 v[32:33], v4 offset:4096
    ds_read_b64_tr_b16 v[34:35], v4 offset:4608
    v_fma_f32 v17, v17, v11, v11
    v_fma_f32 v18, v18, v11, v11
    v_fma_f32 v19, v19, v11, v11
    v_rcp_f32 v16, v16
    s_waitcnt lgkmcnt(6)
    v_mfma_f32_32x32x16_bf16 v[48:63], v[40:43], v[188:191], v[48:63]
    ds_read_b64_tr_b16 v[36:37], v4 offset:6144
    ds_read_b64_tr_b16 v[38:39], v4 offset:6656
    s_add_u32 s9, s73, 83968
    s_add_u32 m0, s16, 98304
    s_nop 0
    buffer_load_dwordx4 v0, s[20:23], s9 offen sc1 lds
    v_rcp_f32 v17, v17
    v_rcp_f32 v18, v18
    s_waitcnt lgkmcnt(6)
    v_mfma_f32_32x32x16_bf16 v[48:63], v[44:47], v[192:195], v[48:63]
    ds_read_b64_tr_b16 v[40:41], v4 offset:8192
    ds_read_b64_tr_b16 v[42:43], v4 offset:8704
    v_rcp_f32 v19, v19
    v_mul_f32 v72, v72, v16
    v_mul_f32 v73, v73, v17
    s_waitcnt lgkmcnt(6)
    v_mfma_f32_32x32x16_bf16 v[48:63], v[28:31], v[196:199], v[48:63]
    ds_read_b64_tr_b16 v[44:45], v4 offset:10240
    ds_read_b64_tr_b16 v[46:47], v4 offset:10752
    s_add_u32 s9, s73, 84992
    s_add_u32 m0, s16, 106496
    s_nop 0
    buffer_load_dwordx4 v0, s[20:23], s9 offen sc1 lds
    v_mul_f32 v74, v74, v18
    v_mul_f32 v75, v75, v19
    v_mul_f32 v16, v76, v10
    s_waitcnt lgkmcnt(6)
    v_mfma_f32_32x32x16_bf16 v[48:63], v[32:35], v[200:203], v[48:63]
    ds_read_b64_tr_b16 v[28:29], v4 offset:12288
    ds_read_b64_tr_b16 v[30:31], v4 offset:12800
    v_mul_f32 v17, v77, v10
    v_mul_f32 v18, v78, v10
    v_mul_f32 v19, v79, v10
    v_exp_f32 v16, v16
    s_waitcnt lgkmcnt(6)
    v_mfma_f32_32x32x16_bf16 v[48:63], v[36:39], v[204:207], v[48:63]
    ds_read_b64_tr_b16 v[32:33], v4 offset:14336
    ds_read_b64_tr_b16 v[34:35], v4 offset:14848
    s_add_u32 s9, s72, 24576
    buffer_load_dwordx4 v[120:123], v0, s[20:23], s9 offen sc1
    v_exp_f32 v17, v17
    v_exp_f32 v18, v18
    s_waitcnt lgkmcnt(6)
    v_mfma_f32_32x32x16_bf16 v[48:63], v[40:43], v[208:211], v[48:63]
    s_barrier
    ds_read_b64_tr_b16 v[36:37], v4 offset:16384
    ds_read_b64_tr_b16 v[38:39], v4 offset:16896
    v_exp_f32 v19, v19
    v_fma_f32 v16, v16, v11, v11
    v_fma_f32 v17, v17, v11, v11
    s_waitcnt lgkmcnt(6)
    v_mfma_f32_32x32x16_bf16 v[48:63], v[44:47], v[212:215], v[48:63]
    ds_read_b64_tr_b16 v[40:41], v4 offset:18432
    ds_read_b64_tr_b16 v[42:43], v4 offset:18944
    s_add_u32 s9, s72, 28672
    buffer_load_dwordx4 v[124:127], v0, s[20:23], s9 offen sc1
    v_fma_f32 v18, v18, v11, v11
    v_fma_f32 v19, v19, v11, v11
    v_rcp_f32 v16, v16
    s_waitcnt lgkmcnt(6)
    v_mfma_f32_32x32x16_bf16 v[48:63], v[28:31], v[216:219], v[48:63]
    ds_read_b64_tr_b16 v[44:45], v4 offset:20480
    ds_read_b64_tr_b16 v[46:47], v4 offset:20992
    v_rcp_f32 v17, v17
    v_rcp_f32 v18, v18
    s_waitcnt lgkmcnt(6)
    v_mfma_f32_32x32x16_bf16 v[48:63], v[32:35], v[220:223], v[48:63]
    ds_read_b64_tr_b16 v[28:29], v4 offset:22528
    ds_read_b64_tr_b16 v[30:31], v4 offset:23040
    s_add_u32 s9, s73, 86016
    s_add_u32 m0, s16, 114688
    s_nop 0
    buffer_load_dwordx4 v0, s[20:23], s9 offen sc1 lds
    v_rcp_f32 v19, v19
    v_mul_f32 v76, v76, v16
    s_waitcnt lgkmcnt(6)
    v_mfma_f32_32x32x16_bf16 v[48:63], v[36:39], v[224:227], v[48:63]
    ds_read_b64_tr_b16 v[32:33], v4 offset:24576
    ds_read_b64_tr_b16 v[34:35], v4 offset:25088
    v_mul_f32 v77, v77, v17
    v_mul_f32 v78, v78, v18
    v_mul_f32 v79, v79, v19
    s_waitcnt lgkmcnt(6)
    v_mfma_f32_32x32x16_bf16 v[48:63], v[40:43], v[228:231], v[48:63]
    ds_read_b64_tr_b16 v[36:37], v4 offset:26624
    ds_read_b64_tr_b16 v[38:39], v4 offset:27136
    s_add_u32 s9, s73, 122880
    s_add_u32 m0, s16, 122880
    s_nop 0
    buffer_load_dwordx4 v0, s[20:23], s9 offen sc1 lds
    s_waitcnt lgkmcnt(6)
    v_mfma_f32_32x32x16_bf16 v[48:63], v[44:47], v[232:235], v[48:63]
    ds_read_b64_tr_b16 v[40:41], v4 offset:28672
    ds_read_b64_tr_b16 v[42:43], v4 offset:29184
    s_waitcnt lgkmcnt(6)
    v_mfma_f32_32x32x16_bf16 v[48:63], v[28:31], v[236:239], v[48:63]
    ds_read_b64_tr_b16 v[44:45], v4 offset:30720
    ds_read_b64_tr_b16 v[46:47], v4 offset:31232
    s_add_u32 s9, s72, 32768
    buffer_load_dwordx4 v[128:131], v0, s[20:23], s9 offen sc1
    s_waitcnt lgkmcnt(6)
    v_mfma_f32_32x32x16_bf16 v[48:63], v[32:35], v[240:243], v[48:63]
    s_mov_b32 s9, 15081472
    s_mov_b32 exec_lo, 511
    s_mov_b32 exec_hi, 0
    buffer_load_dword v3, v24, s[20:23], s9 offen sc1
    s_mov_b64 exec, -1
    s_waitcnt lgkmcnt(4)
    v_mfma_f32_32x32x16_bf16 v[48:63], v[36:39], v[244:247], v[48:63]
    s_waitcnt lgkmcnt(2)
    v_mfma_f32_32x32x16_bf16 v[48:63], v[40:43], v[248:251], v[48:63]
    s_waitcnt lgkmcnt(0)
    v_mfma_f32_32x32x16_bf16 v[48:63], v[44:47], v[252:255], v[48:63]
    s_nop 9
    v_mfma_f32_32x32x8_bf16 v[48:63], v[14:15], v[8:9], v[48:63]
    v_mov_b32 v2, v24
    v_mov_b32 v4, v26
    s_nop 9
    v_mul_f32 v64, v64, v48
    v_mul_f32 v65, v65, v49
    v_mul_f32 v66, v66, v50
    v_mul_f32 v67, v67, v51
    v_mul_f32 v68, v68, v52
    v_mul_f32 v69, v69, v53
    v_mul_f32 v70, v70, v54
    v_mul_f32 v71, v71, v55
    v_cvt_pk_bf16_f32 v20, v64, v65
    v_cvt_pk_bf16_f32 v21, v66, v67
    v_cvt_pk_bf16_f32 v22, v68, v69
    v_cvt_pk_bf16_f32 v23, v70, v71
    buffer_store_dwordx4 v[20:23], v6, s[20:23], s13 offen sc1
    v_mul_f32 v72, v72, v56
    v_mul_f32 v73, v73, v57
    v_mul_f32 v74, v74, v58
    v_mul_f32 v75, v75, v59
    v_mul_f32 v76, v76, v60
    v_mul_f32 v77, v77, v61
    v_mul_f32 v78, v78, v62
    v_mul_f32 v79, v79, v63
    v_cvt_pk_bf16_f32 v20, v72, v73
    v_cvt_pk_bf16_f32 v21, v74, v75
    v_cvt_pk_bf16_f32 v22, v76, v77
    v_cvt_pk_bf16_f32 v23, v78, v79
    buffer_store_dwordx4 v[20:23], v6, s[20:23], s13 offen offset:512 sc1
    s_lshr_b32 s4, s3, 2
    s_lshl_b32 s5, s4, 10
    v_add_u32 v68, s5, v0
    v_add_u32 v69, 65536, v68
    v_add_u32 v70, 131072, v68
    s_waitcnt vmcnt(24)
    s_barrier
    ds_read_b128 v[8:11], v68
    ds_read_b128 v[12:15], v68 offset:8192
    ds_read_b128 v[16:19], v68 offset:16384
    ds_read_b128 v[20:23], v68 offset:24576
    ds_read_b128 v[24:27], v68 offset:32768
    v_add_u32 v6, s16, v0
    v_add_u32 v7, 0x20000, v6
    v_add_u32 v6, 0x10000, v6
    ds_write_b128 v7, v[80:83]
    ds_write_b128 v7, v[84:87] offset:8192
    ds_write_b128 v7, v[88:91] offset:16384
    s_waitcnt vmcnt(22)
    ds_write_b128 v7, v[92:95] offset:24576
    s_waitcnt vmcnt(19) lgkmcnt(8)
    v_mfma_f32_16x16x32_bf16 v[48:51], v[8:11], v[96:99], 0
    ds_read_b128 v[28:31], v68 offset:2048
    s_lshl_b32 s4, s3, 6
    s_add_u32 s4, s4, 0
    v_add_u32 v76, s4, v1
    v_mul_u32_u24 v77, 6554, v76
    v_lshrrev_b32 v77, 16, v77
    s_waitcnt lgkmcnt(8)
    v_mfma_f32_16x16x32_bf16 v[52:55], v[12:15], v[96:99], 0
    ds_read_b128 v[32:35], v68 offset:10240
    v_mul_u32_u24 v78, 10, v77
    v_sub_u32 v76, v76, v78
    v_mul_u32_u24 v73, 336, v77
    v_lshl_add_u32 v73, v76, 5, v73
    v_add_u32 v73, 81920, v73
    s_waitcnt lgkmcnt(8)
    v_mfma_f32_16x16x32_bf16 v[56:59], v[16:19], v[96:99], 0
    ds_read_b128 v[36:39], v68 offset:18432
    v_and_b32 v78, 15, v77
    v_and_b32 v71, 32, v77
    v_lshl_add_u32 v71, v78, 1, v71
    v_bfe_u32 v78, v77, 4, 1
    v_add_u32 v71, v71, v78
    s_waitcnt lgkmcnt(8)
    v_mfma_f32_16x16x32_bf16 v[60:63], v[20:23], v[96:99], 0
    ds_read_b128 v[40:43], v68 offset:26624
    v_mul_u32_u24 v71, 1280, v71
    v_lshl_add_u32 v71, v76, 4, v71
    buffer_load_dwordx4 v[244:247], v71, s[24:27], s74 offen
    s_waitcnt lgkmcnt(8)
    v_mfma_f32_16x16x32_bf16 v[64:67], v[24:27], v[96:99], 0
    ds_read_b128 v[44:47], v68 offset:34816
    s_lshl_b32 s4, s3, 6
    s_add_u32 s4, s4, 512
    v_add_u32 v76, s4, v1
    v_mul_u32_u24 v77, 6554, v76
    v_lshrrev_b32 v77, 16, v77
    s_waitcnt vmcnt(3)
    v_cmp_ne_u32 vcc, s60, v3
    s_nop 1
    s_and_b32 vcc_lo, vcc_lo, 511
    s_cbranch_scc0 L_ck13_ok
L_ck13_sp:
    s_sleep 2
    s_mov_b32 s9, 15081472
    s_mov_b32 exec_lo, 511
    s_mov_b32 exec_hi, 0
    buffer_load_dword v3, v2, s[20:23], s9 offen sc1
    s_mov_b64 exec, -1
    s_waitcnt vmcnt(0)
    s_add_u32 s75, s75, 1
    s_cmp_gt_u32 s75, 30000
    s_cbranch_scc1 L_ck13_ok
    v_cmp_ne_u32 vcc, s60, v3
    s_nop 3
    s_and_b32 vcc_lo, vcc_lo, 511
    s_nop 3
    s_cbranch_scc1 L_ck13_sp
L_ck13_ok:
    s_waitcnt lgkmcnt(4)
    v_mfma_f32_16x16x32_bf16 v[48:51], v[28:31], v[100:103], v[48:51]
    ds_read_b128 v[8:11], v68 offset:4096
    s_add_u32 s9, s72, 36864
    buffer_load_dwordx4 v[132:135], v0, s[20:23], s9 offen sc1
    s_waitcnt lgkmcnt(4)
    v_mfma_f32_16x16x32_bf16 v[52:55], v[32:35], v[100:103], v[52:55]
    ds_read_b128 v[12:15], v68 offset:12288
    s_add_u32 s9, s72, 40960
    buffer_load_dwordx4 v[136:139], v0, s[20:23], s9 offen sc1
    s_waitcnt lgkmcnt(4)
    v_mfma_f32_16x16x32_bf16 v[56:59], v[36:39], v[100:103], v[56:59]
    ds_read_b128 v[16:19], v68 offset:20480
    s_add_u32 s9, s72, 45056
    buffer_load_dwordx4 v[140:143], v0, s[20:23], s9 offen sc1
    s_waitcnt lgkmcnt(4)
    v_mfma_f32_16x16x32_bf16 v[60:63], v[40:43], v[100:103], v[60:63]
    ds_read_b128 v[20:23], v68 offset:28672
    s_waitcnt lgkmcnt(4)
    v_mfma_f32_16x16x32_bf16 v[64:67], v[44:47], v[100:103], v[64:67]
    ds_read_b128 v[24:27], v68 offset:36864
    s_waitcnt lgkmcnt(4)
    v_mfma_f32_16x16x32_bf16 v[48:51], v[8:11], v[104:107], v[48:51]
    ds_read_b128 v[28:31], v68 offset:6144
    s_add_u32 s9, s72, 49152
    buffer_load_dwordx4 v[144:147], v0, s[20:23], s9 offen sc1
    s_waitcnt lgkmcnt(4)
    v_mfma_f32_16x16x32_bf16 v[52:55], v[12:15], v[104:107], v[52:55]
    ds_read_b128 v[32:35], v68 offset:14336
    s_add_u32 s9, s72, 53248
    buffer_load_dwordx4 v[148:151], v0, s[20:23], s9 offen sc1
    s_waitcnt lgkmcnt(4)
    v_mfma_f32_16x16x32_bf16 v[56:59], v[16:19], v[104:107], v[56:59]
    ds_read_b128 v[36:39], v68 offset:22528
    s_waitcnt lgkmcnt(4)
    v_mfma_f32_16x16x32_bf16 v[60:63], v[20:23], v[104:107], v[60:63]
    ds_read_b128 v[40:43], v68 offset:30720
    s_waitcnt lgkmcnt(4)
    v_mfma_f32_16x16x32_bf16 v[64:67], v[24:27], v[104:107], v[64:67]
    ds_read_b128 v[44:47], v68 offset:38912
    s_waitcnt lgkmcnt(0)
    s_barrier
    v_mfma_f32_16x16x32_bf16 v[48:51], v[28:31], v[108:111], v[48:51]
    ds_read_b128 v[8:11], v68 offset:40960
    s_add_u32 s9, s72, 57344
    buffer_load_dwordx4 v[152:155], v0, s[20:23], s9 offen sc1
    v_mfma_f32_16x16x32_bf16 v[52:55], v[32:35], v[108:111], v[52:55]
    ds_read_b128 v[12:15], v68 offset:49152
    s_add_u32 s9, s73, 163840
    s_add_u32 m0, s16, 0
    s_nop 0
    buffer_load_dwordx4 v0, s[20:23], s9 offen sc1 lds
    v_mfma_f32_16x16x32_bf16 v[56:59], v[36:39], v[108:111], v[56:59]
    ds_read_b128 v[16:19], v68 offset:57344
    v_mfma_f32_16x16x32_bf16 v[60:63], v[40:43], v[108:111], v[60:63]
    ds_read_b128 v[20:23], v69
    v_mfma_f32_16x16x32_bf16 v[64:67], v[44:47], v[108:111], v[64:67]
    ds_read_b128 v[24:27], v69 offset:8192
    s_waitcnt vmcnt(8)
    s_barrier
    s_cmp_eq_u32 s3, 0
    s_cbranch_scc0 L_c34
    s_add_u32 s9, s17, 0
    v_mov_b32 v5, s60
    buffer_store_dword v5, v4, s[20:23], s9 offen sc1
L_c34:
    s_waitcnt lgkmcnt(4)
    v_mfma_f32_16x16x32_bf16 v[48:51], v[8:11], v[112:115], v[48:51]
    ds_read_b128 v[28:31], v68 offset:43008
    s_add_u32 s9, s73, 164864
    s_add_u32 m0, s16, 8192
    s_nop 0
    buffer_load_dwordx4 v0, s[20:23], s9 offen sc1 lds
    s_waitcnt lgkmcnt(4)
    v_mfma_f32_16x16x32_bf16 v[52:55], v[12:15], v[112:115], v[52:55]
    ds_read_b128 v[32:35], v68 offset:51200
    s_add_u32 s9, s73, 165888
    s_add_u32 m0, s16, 16384
    s_nop 0
    buffer_load_dwordx4 v0, s[20:23], s9 offen sc1 lds
    s_waitcnt lgkmcnt(4)
    v_mfma_f32_16x16x32_bf16 v[56:59], v[16:19], v[112:115], v[56:59]
    ds_read_b128 v[36:39], v68 offset:59392
    s_waitcnt lgkmcnt(4)
    v_mfma_f32_16x16x32_bf16 v[60:63], v[20:23], v[112:115], v[60:63]
    ds_read_b128 v[40:43], v69 offset:2048
    s_waitcnt lgkmcnt(4)
    v_mfma_f32_16x16x32_bf16 v[64:67], v[24:27], v[112:115], v[64:67]
    ds_read_b128 v[44:47], v69 offset:10240
    s_waitcnt lgkmcnt(4)
    v_mfma_f32_16x16x32_bf16 v[48:51], v[28:31], v[116:119], v[48:51]
    ds_read_b128 v[8:11], v68 offset:45056
    s_add_u32 s9, s73, 166912
    s_add_u32 m0, s16, 24576
    s_nop 0
    buffer_load_dwordx4 v0, s[20:23], s9 offen sc1 lds
    s_waitcnt lgkmcnt(4)
    v_mfma_f32_16x16x32_bf16 v[52:55], v[32:35], v[116:119], v[52:55]
    ds_read_b128 v[12:15], v68 offset:53248
    s_add_u32 s9, s73, 167936
    s_add_u32 m0, s16, 32768
    s_nop 0
    buffer_load_dwordx4 v0, s[20:23], s9 offen sc1 lds
    s_waitcnt lgkmcnt(4)
    v_mfma_f32_16x16x32_bf16 v[56:59], v[36:39], v[116:119], v[56:59]
    ds_read_b128 v[16:19], v68 offset:61440
    s_waitcnt lgkmcnt(4)
    v_mfma_f32_16x16x32_bf16 v[60:63], v[40:43], v[116:119], v[60:63]
    ds_read_b128 v[20:23], v69 offset:4096
    s_waitcnt lgkmcnt(4)
    v_mfma_f32_16x16x32_bf16 v[64:67], v[44:47], v[116:119], v[64:67]
    ds_read_b128 v[24:27], v69 offset:12288
    s_waitcnt lgkmcnt(4)
    v_mfma_f32_16x16x32_bf16 v[48:51], v[8:11], v[120:123], v[48:51]
    ds_read_b128 v[28:31], v68 offset:47104
    s_add_u32 s9, s72, 61440
    buffer_load_dwordx4 v[156:159], v0, s[20:23], s9 offen sc1
    s_waitcnt lgkmcnt(4)
    v_mfma_f32_16x16x32_bf16 v[52:55], v[12:15], v[120:123], v[52:55]
    ds_read_b128 v[32:35], v68 offset:55296
    s_add_u32 s9, s72, 65536
    buffer_load_dwordx4 v[160:163], v0, s[20:23], s9 offen sc1
    s_waitcnt lgkmcnt(4)
    v_mfma_f32_16x16x32_bf16 v[56:59], v[16:19], v[120:123], v[56:59]
    ds_read_b128 v[36:39], v68 offset:63488
    s_waitcnt lgkmcnt(4)
    v_mfma_f32_16x16x32_bf16 v[60:63], v[20:23], v[120:123], v[60:63]
    ds_read_b128 v[40:43], v69 offset:6144
    s_waitcnt lgkmcnt(4)
    v_mfma_f32_16x16x32_bf16 v[64:67], v[24:27], v[120:123], v[64:67]
    ds_read_b128 v[44:47], v69 offset:14336
    s_waitcnt lgkmcnt(0)
    s_barrier
    v_mfma_f32_16x16x32_bf16 v[48:51], v[28:31], v[124:127], v[48:51]
    ds_read_b128 v[8:11], v69 offset:16384
    s_add_u32 s9, s72, 69632
    buffer_load_dwordx4 v[164:167], v0, s[20:23], s9 offen sc1
    v_mfma_f32_16x16x32_bf16 v[52:55], v[32:35], v[124:127], v[52:55]
    ds_read_b128 v[12:15], v69 offset:24576
    s_add_u32 s9, s73, 204800
    s_add_u32 m0, s16, 40960
    s_nop 0
    buffer_load_dwordx4 v0, s[20:23], s9 offen sc1 lds
    v_mfma_f32_16x16x32_bf16 v[56:59], v[36:39], v[124:127], v[56:59]
    ds_read_b128 v[16:19], v69 offset:32768
    v_mfma_f32_16x16x32_bf16 v[60:63], v[40:43], v[124:127], v[60:63]
    ds_read_b128 v[20:23], v69 offset:40960
    v_mfma_f32_16x16x32_bf16 v[64:67], v[44:47], v[124:127], v[64:67]
    ds_read_b128 v[24:27], v69 offset:49152
    s_waitcnt lgkmcnt(4)
    v_mfma_f32_16x16x32_bf16 v[48:51], v[8:11], v[128:131], v[48:51]
    ds_read_b128 v[28:31], v69 offset:18432
    s_add_u32 s9, s73, 205824
    s_add_u32 m0, s16, 49152
    s_nop 0
    buffer_load_dwordx4 v0, s[20:23], s9 offen sc1 lds
    s_waitcnt lgkmcnt(4)
    v_mfma_f32_16x16x32_bf16 v[52:55], v[12:15], v[128:131], v[52:55]
    ds_read_b128 v[32:35], v69 offset:26624
    s_add_u32 s9, s73, 206848
    s_add_u32 m0, s16, 57344
    s_nop 0
    buffer_load_dwordx4 v0, s[20:23], s9 offen sc1 lds
    s_waitcnt lgkmcnt(4)
    v_mfma_f32_16x16x32_bf16 v[56:59], v[16:19], v[128:131], v[56:59]
    ds_read_b128 v[36:39], v69 offset:34816
    s_waitcnt lgkmcnt(4)
    v_mfma_f32_16x16x32_bf16 v[60:63], v[20:23], v[128:131], v[60:63]
    ds_read_b128 v[40:43], v69 offset:43008
    s_waitcnt lgkmcnt(4)
    v_mfma_f32_16x16x32_bf16 v[64:67], v[24:27], v[128:131], v[64:67]
    ds_read_b128 v[44:47], v69 offset:51200
    s_waitcnt vmcnt(16) lgkmcnt(4)
    v_mfma_f32_16x16x32_bf16 v[48:51], v[28:31], v[132:135], v[48:51]
    ds_read_b128 v[8:11], v69 offset:20480
    s_add_u32 s9, s73, 207872
    s_add_u32 m0, s16, 65536
    s_nop 0
    buffer_load_dwordx4 v0, s[20:23], s9 offen sc1 lds
    s_waitcnt lgkmcnt(4)
    v_mfma_f32_16x16x32_bf16 v[52:55], v[32:35], v[132:135], v[52:55]
    ds_read_b128 v[12:15], v69 offset:28672
    s_add_u32 s9, s73, 208896
    s_add_u32 m0, s16, 73728
    s_nop 0
    buffer_load_dwordx4 v0, s[20:23], s9 offen sc1 lds
    s_waitcnt lgkmcnt(4)
    v_mfma_f32_16x16x32_bf16 v[56:59], v[36:39], v[132:135], v[56:59]
    ds_read_b128 v[16:19], v69 offset:36864
    v_mul_u32_u24 v78, 10, v77
    v_sub_u32 v76, v76, v78
    v_mul_u32_u24 v74, 336, v77
    v_lshl_add_u32 v74, v76, 5, v74
    v_add_u32 v74, 81920, v74
    s_waitcnt lgkmcnt(4)
    v_mfma_f32_16x16x32_bf16 v[60:63], v[40:43], v[132:135], v[60:63]
    ds_read_b128 v[20:23], v69 offset:45056
    v_and_b32 v78, 15, v77
    v_and_b32 v72, 32, v77
    v_lshl_add_u32 v72, v78, 1, v72
    v_bfe_u32 v78, v77, 4, 1
    v_add_u32 v72, v72, v78
    s_waitcnt lgkmcnt(4)
    v_mfma_f32_16x16x32_bf16 v[64:67], v[44:47], v[132:135], v[64:67]
    ds_read_b128 v[24:27], v69 offset:53248
    v_mul_u32_u24 v72, 1280, v72
    v_lshl_add_u32 v72, v76, 4, v72
    s_cmp_lt_u32 s3, 2
    s_cbranch_scc0 L_c35
    buffer_load_dwordx4 v[248:251], v72, s[24:27], s74 offen
L_c35:
    s_waitcnt vmcnt(17) lgkmcnt(4)
    v_mfma_f32_16x16x32_bf16 v[48:51], v[8:11], v[136:139], v[48:51]
    ds_read_b128 v[28:31], v69 offset:22528
    s_lshr_b32 s4, s3, 2
    s_mul_i32 s4, s4, 21504
    s_and_b32 s5, s3, 3
    s_mul_i32 s5, s5, 5376
    s_add_u32 s4, s4, s5
    s_add_u32 s4, s4, 81920
    v_and_b32 v76, 15, v1
    v_mul_u32_u24 v76, 336, v76
    v_and_b32 v77, 48, v1
    v_add3_u32 v75, v76, v77, s4
    s_waitcnt lgkmcnt(4)
    v_mfma_f32_16x16x32_bf16 v[52:55], v[12:15], v[136:139], v[52:55]
    ds_read_b128 v[32:35], v69 offset:30720
    s_or_b32 s4, s2, s3
    s_cmp_eq_u32 s4, 0
    s_cbranch_scc0 L_c36
    v_lshlrev_b32 v86, 3, v0
    v_add_u32 v87, 8192, v86
    v_add_u32 v88, 16384, v86
    v_add_u32 v89, 24576, v86
    buffer_load_dword v90, v86, s[36:39], 0 offen offset:4 sc1
    buffer_load_dword v91, v87, s[36:39], 0 offen offset:4 sc1
    buffer_load_dword v92, v88, s[36:39], 0 offen offset:4 sc1
    buffer_load_dword v93, v89, s[36:39], 0 offen offset:4 sc1
L_c36:
    s_waitcnt lgkmcnt(4)
    v_mfma_f32_16x16x32_bf16 v[56:59], v[16:19], v[136:139], v[56:59]
    ds_read_b128 v[36:39], v69 offset:38912
    s_waitcnt lgkmcnt(4)
    v_mfma_f32_16x16x32_bf16 v[60:63], v[20:23], v[136:139], v[60:63]
    ds_read_b128 v[40:43], v69 offset:47104
    s_waitcnt lgkmcnt(4)
    v_mfma_f32_16x16x32_bf16 v[64:67], v[24:27], v[136:139], v[64:67]
    ds_read_b128 v[44:47], v69 offset:55296
    s_waitcnt lgkmcnt(0)
    s_barrier
    s_mov_b32 s9, 15073280
    s_mov_b32 exec_lo, 511
    s_mov_b32 exec_hi, 0
    buffer_load_dword v3, v2, s[20:23], s9 offen sc1
    s_mov_b64 exec, -1
    s_waitcnt vmcnt(17)
    v_mfma_f32_16x16x32_bf16 v[48:51], v[28:31], v[140:143], v[48:51]
    ds_read_b128 v[8:11], v69 offset:57344
    s_add_u32 s9, s73, 245760
    s_add_u32 m0, s16, 81920
    s_nop 0
    buffer_load_dwordx4 v0, s[20:23], s9 offen sc1 lds
    v_mfma_f32_16x16x32_bf16 v[52:55], v[32:35], v[140:143], v[52:55]
    ds_read_b128 v[12:15], v70
    s_add_u32 s9, s73, 246784
    s_add_u32 m0, s16, 90112
    s_nop 0
    buffer_load_dwordx4 v0, s[20:23], s9 offen sc1 lds
    v_mfma_f32_16x16x32_bf16 v[56:59], v[36:39], v[140:143], v[56:59]
    ds_read_b128 v[16:19], v70 offset:8192
    s_add_u32 s9, s73, 247808
    s_add_u32 m0, s16, 98304
    s_nop 0
    buffer_load_dwordx4 v0, s[20:23], s9 offen sc1 lds
    v_mfma_f32_16x16x32_bf16 v[60:63], v[40:43], v[140:143], v[60:63]
    ds_read_b128 v[20:23], v70 offset:16384
    v_mfma_f32_16x16x32_bf16 v[64:67], v[44:47], v[140:143], v[64:67]
    ds_read_b128 v[24:27], v70 offset:24576
    s_waitcnt vmcnt(19) lgkmcnt(4)
    v_mfma_f32_16x16x32_bf16 v[48:51], v[8:11], v[144:147], v[48:51]
    ds_read_b128 v[28:31], v69 offset:59392
    s_add_u32 s9, s73, 248832
    s_add_u32 m0, s16, 106496
    s_nop 0
    buffer_load_dwordx4 v0, s[20:23], s9 offen sc1 lds
    s_waitcnt lgkmcnt(4)
    v_mfma_f32_16x16x32_bf16 v[52:55], v[12:15], v[144:147], v[52:55]
    ds_read_b128 v[32:35], v70 offset:2048
    s_add_u32 s9, s73, 249856
    s_add_u32 m0, s16, 114688
    s_nop 0
    buffer_load_dwordx4 v0, s[20:23], s9 offen sc1 lds
    s_waitcnt lgkmcnt(4)
    v_mfma_f32_16x16x32_bf16 v[56:59], v[16:19], v[144:147], v[56:59]
    ds_read_b128 v[36:39], v70 offset:10240
    s_waitcnt lgkmcnt(4)
    v_mfma_f32_16x16x32_bf16 v[60:63], v[20:23], v[144:147], v[60:63]
    ds_read_b128 v[40:43], v70 offset:18432
    s_waitcnt lgkmcnt(4)
    v_mfma_f32_16x16x32_bf16 v[64:67], v[24:27], v[144:147], v[64:67]
    ds_read_b128 v[44:47], v70 offset:26624
    s_waitcnt vmcnt(20) lgkmcnt(4)
    v_mfma_f32_16x16x32_bf16 v[48:51], v[28:31], v[148:151], v[48:51]
    ds_read_b128 v[8:11], v69 offset:61440
    s_waitcnt lgkmcnt(4)
    v_mfma_f32_16x16x32_bf16 v[52:55], v[32:35], v[148:151], v[52:55]
    ds_read_b128 v[12:15], v70 offset:4096
    s_waitcnt lgkmcnt(4)
    v_mfma_f32_16x16x32_bf16 v[56:59], v[36:39], v[148:151], v[56:59]
    ds_read_b128 v[16:19], v70 offset:12288
    s_waitcnt lgkmcnt(4)
    v_mfma_f32_16x16x32_bf16 v[60:63], v[40:43], v[148:151], v[60:63]
    ds_read_b128 v[20:23], v70 offset:20480
    s_waitcnt lgkmcnt(4)
    v_mfma_f32_16x16x32_bf16 v[64:67], v[44:47], v[148:151], v[64:67]
    ds_read_b128 v[24:27], v70 offset:28672
    s_waitcnt vmcnt(5)
    v_cmp_ne_u32 vcc, s60, v3
    s_nop 1
    s_and_b32 vcc_lo, vcc_lo, 511
    s_cbranch_scc0 L_ck14_ok
L_ck14_sp:
    s_sleep 1
    s_mov_b32 s9, 15073280
    s_mov_b32 exec_lo, 511
    s_mov_b32 exec_hi, 0
    buffer_load_dword v3, v2, s[20:23], s9 offen sc1
    s_mov_b64 exec, -1
    s_waitcnt vmcnt(0)
    s_add_u32 s75, s75, 1
    s_cmp_gt_u32 s75, 30000
    s_cbranch_scc1 L_ck14_ok
    v_cmp_ne_u32 vcc, s60, v3
    s_nop 3
    s_and_b32 vcc_lo, vcc_lo, 511
    s_nop 3
    s_cbranch_scc1 L_ck14_sp
L_ck14_ok:
    s_add_u32 s9, s72, 73728
    buffer_load_dwordx4 v[168:171], v0, s[20:23], s9 offen sc1
    s_add_u32 s9, s72, 77824
    buffer_load_dwordx4 v[172:175], v0, s[20:23], s9 offen sc1
    s_add_u32 s9, s72, 81920
    buffer_load_dwordx4 v[176:179], v0, s[20:23], s9 offen sc1
    s_waitcnt lgkmcnt(4)
    v_mfma_f32_16x16x32_bf16 v[48:51], v[8:11], v[152:155], v[48:51]
    ds_read_b128 v[28:31], v69 offset:63488
    s_add_u32 s9, s72, 86016
    buffer_load_dwordx4 v[180:183], v0, s[20:23], s9 offen sc1
    s_waitcnt lgkmcnt(4)
    v_mfma_f32_16x16x32_bf16 v[52:55], v[12:15], v[152:155], v[52:55]
    ds_read_b128 v[32:35], v70 offset:6144
    s_add_u32 s9, s72, 90112
    buffer_load_dwordx4 v[184:187], v0, s[20:23], s9 offen sc1
    s_waitcnt lgkmcnt(4)
    v_mfma_f32_16x16x32_bf16 v[56:59], v[16:19], v[152:155], v[56:59]
    ds_read_b128 v[36:39], v70 offset:14336
    s_add_u32 s9, s72, 94208
    buffer_load_dwordx4 v[188:191], v0, s[20:23], s9 offen sc1
    s_waitcnt lgkmcnt(4)
    v_mfma_f32_16x16x32_bf16 v[60:63], v[20:23], v[152:155], v[60:63]
    ds_read_b128 v[40:43], v70 offset:22528
    s_waitcnt lgkmcnt(4)
    v_mfma_f32_16x16x32_bf16 v[64:67], v[24:27], v[152:155], v[64:67]
    ds_read_b128 v[44:47], v70 offset:30720
    s_waitcnt lgkmcnt(0)
    s_barrier
    v_mfma_f32_16x16x32_bf16 v[48:51], v[28:31], v[156:159], v[48:51]
    ds_read_b128 v[8:11], v68
    s_add_u32 s9, s72, 98304
    buffer_load_dwordx4 v[192:195], v0, s[20:23], s9 offen sc1
    v_mfma_f32_16x16x32_bf16 v[52:55], v[32:35], v[156:159], v[52:55]
    ds_read_b128 v[12:15], v68 offset:8192
    s_add_u32 s9, s72, 102400
    buffer_load_dwordx4 v[196:199], v0, s[20:23], s9 offen sc1
    v_mfma_f32_16x16x32_bf16 v[56:59], v[36:39], v[156:159], v[56:59]
    ds_read_b128 v[16:19], v68 offset:16384
    v_mfma_f32_16x16x32_bf16 v[60:63], v[40:43], v[156:159], v[60:63]
    ds_read_b128 v[20:23], v68 offset:24576
    v_mfma_f32_16x16x32_bf16 v[64:67], v[44:47], v[156:159], v[64:67]
    ds_read_b128 v[24:27], v68 offset:32768
    s_waitcnt lgkmcnt(4)
    v_mfma_f32_16x16x32_bf16 v[48:51], v[8:11], v[160:163], v[48:51]
    ds_read_b128 v[28:31], v68 offset:2048
    s_add_u32 s9, s72, 106496
    buffer_load_dwordx4 v[200:203], v0, s[20:23], s9 offen sc1
    s_waitcnt lgkmcnt(4)
    v_mfma_f32_16x16x32_bf16 v[52:55], v[12:15], v[160:163], v[52:55]
    ds_read_b128 v[32:35], v68 offset:10240
    s_waitcnt lgkmcnt(4)
    v_mfma_f32_16x16x32_bf16 v[56:59], v[16:19], v[160:163], v[56:59]
    ds_read_b128 v[36:39], v68 offset:18432
    s_waitcnt lgkmcnt(4)
    v_mfma_f32_16x16x32_bf16 v[60:63], v[20:23], v[160:163], v[60:63]
    ds_read_b128 v[40:43], v68 offset:26624
    s_waitcnt lgkmcnt(4)
    v_mfma_f32_16x16x32_bf16 v[64:67], v[24:27], v[160:163], v[64:67]
    ds_read_b128 v[44:47], v68 offset:34816
    s_mov_b32 s9, 15073280
    s_mov_b32 exec_lo, 4294901760
    s_mov_b32 exec_hi, 0
    buffer_load_dword v3, v2, s[20:23], s9 offen sc1
    s_mov_b64 exec, -1
    s_waitcnt lgkmcnt(4)
    v_mfma_f32_16x16x32_bf16 v[48:51], v[28:31], v[164:167], v[48:51]
    ds_read_b128 v[8:11], v68 offset:4096
    s_add_u32 s9, s73, 286720
    s_add_u32 m0, s16, 122880
    s_nop 0
    buffer_load_dwordx4 v0, s[20:23], s9 offen sc1 lds
    s_waitcnt lgkmcnt(4)
    v_mfma_f32_16x16x32_bf16 v[52:55], v[32:35], v[164:167], v[52:55]
    ds_read_b128 v[12:15], v68 offset:12288
    s_add_u32 s9, s73, 287744
    s_add_u32 m0, s16, 131072
    s_nop 0
    buffer_load_dwordx4 v0, s[20:23], s9 offen sc1 lds
    s_waitcnt lgkmcnt(4)
    v_mfma_f32_16x16x32_bf16 v[56:59], v[36:39], v[164:167], v[56:59]
    ds_read_b128 v[16:19], v68 offset:20480
    s_waitcnt lgkmcnt(4)
    v_mfma_f32_16x16x32_bf16 v[60:63], v[40:43], v[164:167], v[60:63]
    ds_read_b128 v[20:23], v68 offset:28672
    s_waitcnt lgkmcnt(4)
    v_mfma_f32_16x16x32_bf16 v[64:67], v[44:47], v[164:167], v[64:67]
    ds_read_b128 v[24:27], v68 offset:36864
    s_waitcnt vmcnt(11) lgkmcnt(4)
    v_mfma_f32_16x16x32_bf16 v[48:51], v[8:11], v[168:171], v[48:51]
    ds_read_b128 v[28:31], v68 offset:6144
    s_add_u32 s9, s73, 288768
    s_add_u32 m0, s16, 139264
    s_nop 0
    buffer_load_dwordx4 v0, s[20:23], s9 offen sc1 lds
    s_waitcnt lgkmcnt(4)
    v_mfma_f32_16x16x32_bf16 v[52:55], v[12:15], v[168:171], v[52:55]
    ds_read_b128 v[32:35], v68 offset:14336
    s_waitcnt lgkmcnt(4)
    v_mfma_f32_16x16x32_bf16 v[56:59], v[16:19], v[168:171], v[56:59]
    ds_read_b128 v[36:39], v68 offset:22528
    s_waitcnt lgkmcnt(4)
    v_mfma_f32_16x16x32_bf16 v[60:63], v[20:23], v[168:171], v[60:63]
    ds_read_b128 v[40:43], v68 offset:30720
    s_waitcnt lgkmcnt(4)
    v_mfma_f32_16x16x32_bf16 v[64:67], v[24:27], v[168:171], v[64:67]
    ds_read_b128 v[44:47], v68 offset:38912
    s_waitcnt lgkmcnt(0)
    s_barrier
    s_waitcnt vmcnt(11)
    v_mfma_f32_16x16x32_bf16 v[48:51], v[28:31], v[172:175], v[48:51]
    ds_read_b128 v[8:11], v68 offset:40960
    s_add_u32 s9, s73, 289792
    s_add_u32 m0, s16, 147456
    s_nop 0
    buffer_load_dwordx4 v0, s[20:23], s9 offen sc1 lds
    v_mfma_f32_16x16x32_bf16 v[52:55], v[32:35], v[172:175], v[52:55]
    ds_read_b128 v[12:15], v68 offset:49152
    v_mfma_f32_16x16x32_bf16 v[56:59], v[36:39], v[172:175], v[56:59]
    ds_read_b128 v[16:19], v68 offset:57344
    v_mfma_f32_16x16x32_bf16 v[60:63], v[40:43], v[172:175], v[60:63]
    ds_read_b128 v[20:23], v69
    v_mfma_f32_16x16x32_bf16 v[64:67], v[44:47], v[172:175], v[64:67]
    ds_read_b128 v[24:27], v69 offset:8192
    s_waitcnt vmcnt(4)
    v_cmp_ne_u32 vcc, s60, v3
    s_nop 1
    s_and_b32 vcc_lo, vcc_lo, 4294901760
    s_cbranch_scc0 L_ck15_ok
L_ck15_sp:
    s_sleep 1
    s_mov_b32 s9, 15073280
    s_mov_b32 exec_lo, 4294901760
    s_mov_b32 exec_hi, 0
    buffer_load_dword v3, v2, s[20:23], s9 offen sc1
    s_mov_b64 exec, -1
    s_waitcnt vmcnt(0)
    s_add_u32 s75, s75, 1
    s_cmp_gt_u32 s75, 30000
    s_cbranch_scc1 L_ck15_ok
    v_cmp_ne_u32 vcc, s60, v3
    s_nop 3
    s_and_b32 vcc_lo, vcc_lo, 4294901760
    s_nop 3
    s_cbranch_scc1 L_ck15_sp
L_ck15_ok:
    s_waitcnt lgkmcnt(4)
    v_mfma_f32_16x16x32_bf16 v[48:51], v[8:11], v[176:179], v[48:51]
    ds_read_b128 v[28:31], v68 offset:43008
    s_add_u32 s9, s73, 290816
    s_add_u32 m0, s16, 155648
    s_nop 0
    buffer_load_dwordx4 v0, s[20:23], s9 offen sc1 lds
    s_waitcnt lgkmcnt(4)
    v_mfma_f32_16x16x32_bf16 v[52:55], v[12:15], v[176:179], v[52:55]
    ds_read_b128 v[32:35], v68 offset:51200
    s_add_u32 s9, s72, 110592
    buffer_load_dwordx4 v[204:207], v0, s[20:23], s9 offen sc1
    s_waitcnt lgkmcnt(4)
    v_mfma_f32_16x16x32_bf16 v[56:59], v[16:19], v[176:179], v[56:59]
    ds_read_b128 v[36:39], v68 offset:59392
    s_waitcnt lgkmcnt(4)
    v_mfma_f32_16x16x32_bf16 v[60:63], v[20:23], v[176:179], v[60:63]
    ds_read_b128 v[40:43], v69 offset:2048
    s_waitcnt lgkmcnt(4)
    v_mfma_f32_16x16x32_bf16 v[64:67], v[24:27], v[176:179], v[64:67]
    ds_read_b128 v[44:47], v69 offset:10240
    s_waitcnt lgkmcnt(4)
    v_mfma_f32_16x16x32_bf16 v[48:51], v[28:31], v[180:183], v[48:51]
    ds_read_b128 v[8:11], v68 offset:45056
    s_add_u32 s9, s72, 114688
    buffer_load_dwordx4 v[208:211], v0, s[20:23], s9 offen sc1
    s_waitcnt lgkmcnt(4)
    v_mfma_f32_16x16x32_bf16 v[52:55], v[32:35], v[180:183], v[52:55]
    ds_read_b128 v[12:15], v68 offset:53248
    s_waitcnt lgkmcnt(4)
    v_mfma_f32_16x16x32_bf16 v[56:59], v[36:39], v[180:183], v[56:59]
    ds_read_b128 v[16:19], v68 offset:61440
    s_waitcnt lgkmcnt(4)
    v_mfma_f32_16x16x32_bf16 v[60:63], v[40:43], v[180:183], v[60:63]
    ds_read_b128 v[20:23], v69 offset:4096
    s_waitcnt lgkmcnt(4)
    v_mfma_f32_16x16x32_bf16 v[64:67], v[44:47], v[180:183], v[64:67]
    ds_read_b128 v[24:27], v69 offset:12288
    s_waitcnt lgkmcnt(4)
    v_mfma_f32_16x16x32_bf16 v[48:51], v[8:11], v[184:187], v[48:51]
    ds_read_b128 v[28:31], v68 offset:47104
    s_add_u32 s9, s72, 118784
    buffer_load_dwordx4 v[212:215], v0, s[20:23], s9 offen sc1
    s_waitcnt lgkmcnt(4)
    v_mfma_f32_16x16x32_bf16 v[52:55], v[12:15], v[184:187], v[52:55]
    ds_read_b128 v[32:35], v68 offset:55296
    s_add_u32 s9, s72, 122880
    buffer_load_dwordx4 v[216:219], v0, s[20:23], s9 offen sc1
    s_waitcnt lgkmcnt(4)
    v_mfma_f32_16x16x32_bf16 v[56:59], v[16:19], v[184:187], v[56:59]
    ds_read_b128 v[36:39], v68 offset:63488
    s_waitcnt lgkmcnt(4)
    v_mfma_f32_16x16x32_bf16 v[60:63], v[20:23], v[184:187], v[60:63]
    ds_read_b128 v[40:43], v69 offset:6144
    s_waitcnt lgkmcnt(4)
    v_mfma_f32_16x16x32_bf16 v[64:67], v[24:27], v[184:187], v[64:67]
    ds_read_b128 v[44:47], v69 offset:14336
    s_waitcnt lgkmcnt(0)
    s_barrier
    v_mfma_f32_16x16x32_bf16 v[48:51], v[28:31], v[188:191], v[48:51]
    ds_read_b128 v[8:11], v69 offset:16384
    s_add_u32 s9, s73, 327680
    s_add_u32 m0, s16, 0
    s_nop 0
    buffer_load_dwordx4 v0, s[20:23], s9 offen sc1 lds
    v_mfma_f32_16x16x32_bf16 v[52:55], v[32:35], v[188:191], v[52:55]
    ds_read_b128 v[12:15], v69 offset:24576
    v_mfma_f32_16x16x32_bf16 v[56:59], v[36:39], v[188:191], v[56:59]
    ds_read_b128 v[16:19], v69 offset:32768
    v_mfma_f32_16x16x32_bf16 v[60:63], v[40:43], v[188:191], v[60:63]
    ds_read_b128 v[20:23], v69 offset:40960
    v_mfma_f32_16x16x32_bf16 v[64:67], v[44:47], v[188:191], v[64:67]
    ds_read_b128 v[24:27], v69 offset:49152
    s_waitcnt lgkmcnt(4)
    v_mfma_f32_16x16x32_bf16 v[48:51], v[8:11], v[192:195], v[48:51]
    ds_read_b128 v[28:31], v69 offset:18432
    s_add_u32 s9, s73, 328704
    s_add_u32 m0, s16, 8192
    s_nop 0
    buffer_load_dwordx4 v0, s[20:23], s9 offen sc1 lds
    s_waitcnt lgkmcnt(4)
    v_mfma_f32_16x16x32_bf16 v[52:55], v[12:15], v[192:195], v[52:55]
    ds_read_b128 v[32:35], v69 offset:26624
    s_waitcnt lgkmcnt(4)
    v_mfma_f32_16x16x32_bf16 v[56:59], v[16:19], v[192:195], v[56:59]
    ds_read_b128 v[36:39], v69 offset:34816
    s_waitcnt lgkmcnt(4)
    v_mfma_f32_16x16x32_bf16 v[60:63], v[20:23], v[192:195], v[60:63]
    ds_read_b128 v[40:43], v69 offset:43008
    s_waitcnt lgkmcnt(4)
    v_mfma_f32_16x16x32_bf16 v[64:67], v[24:27], v[192:195], v[64:67]
    ds_read_b128 v[44:47], v69 offset:51200
    s_waitcnt lgkmcnt(4)
    v_mfma_f32_16x16x32_bf16 v[48:51], v[28:31], v[196:199], v[48:51]
    ds_read_b128 v[8:11], v69 offset:20480
    s_add_u32 s9, s73, 329728
    s_add_u32 m0, s16, 16384
    s_nop 0
    buffer_load_dwordx4 v0, s[20:23], s9 offen sc1 lds
    s_waitcnt lgkmcnt(4)
    v_mfma_f32_16x16x32_bf16 v[52:55], v[32:35], v[196:199], v[52:55]
    ds_read_b128 v[12:15], v69 offset:28672
    s_add_u32 s9, s73, 330752
    s_add_u32 m0, s16, 24576
    s_nop 0
    buffer_load_dwordx4 v0, s[20:23], s9 offen sc1 lds
    s_waitcnt lgkmcnt(4)
    v_mfma_f32_16x16x32_bf16 v[56:59], v[36:39], v[196:199], v[56:59]
    ds_read_b128 v[16:19], v69 offset:36864
    s_waitcnt lgkmcnt(4)
    v_mfma_f32_16x16x32_bf16 v[60:63], v[40:43], v[196:199], v[60:63]
    ds_read_b128 v[20:23], v69 offset:45056
    s_waitcnt lgkmcnt(4)
    v_mfma_f32_16x16x32_bf16 v[64:67], v[44:47], v[196:199], v[64:67]
    ds_read_b128 v[24:27], v69 offset:53248
    s_waitcnt lgkmcnt(4)
    v_mfma_f32_16x16x32_bf16 v[48:51], v[8:11], v[200:203], v[48:51]
    ds_read_b128 v[28:31], v69 offset:22528
    s_add_u32 s9, s73, 331776
    s_add_u32 m0, s16, 32768
    s_nop 0
    buffer_load_dwordx4 v0, s[20:23], s9 offen sc1 lds
    s_waitcnt lgkmcnt(4)
    v_mfma_f32_16x16x32_bf16 v[52:55], v[12:15], v[200:203], v[52:55]
    ds_read_b128 v[32:35], v69 offset:30720
    s_add_u32 s9, s72, 126976
    buffer_load_dwordx4 v[220:223], v0, s[20:23], s9 offen sc1
    s_waitcnt lgkmcnt(4)
    v_mfma_f32_16x16x32_bf16 v[56:59], v[16:19], v[200:203], v[56:59]
    ds_read_b128 v[36:39], v69 offset:38912
    s_waitcnt lgkmcnt(4)
    v_mfma_f32_16x16x32_bf16 v[60:63], v[20:23], v[200:203], v[60:63]
    ds_read_b128 v[40:43], v69 offset:47104
    s_waitcnt lgkmcnt(4)
    v_mfma_f32_16x16x32_bf16 v[64:67], v[24:27], v[200:203], v[64:67]
    ds_read_b128 v[44:47], v69 offset:55296
    s_waitcnt vmcnt(10) lgkmcnt(0)
    s_barrier
    s_waitcnt vmcnt(9)
    v_mfma_f32_16x16x32_bf16 v[48:51], v[28:31], v[204:207], v[48:51]
    ds_read_b128 v[8:11], v69 offset:57344
    s_add_u32 s9, s72, 131072
    buffer_load_dwordx4 v[224:227], v0, s[20:23], s9 offen sc1
    v_mfma_f32_16x16x32_bf16 v[52:55], v[32:35], v[204:207], v[52:55]
    ds_read_b128 v[12:15], v70
    v_mfma_f32_16x16x32_bf16 v[56:59], v[36:39], v[204:207], v[56:59]
    ds_read_b128 v[16:19], v70 offset:8192
    v_mfma_f32_16x16x32_bf16 v[60:63], v[40:43], v[204:207], v[60:63]
    ds_read_b128 v[20:23], v70 offset:16384
    v_mfma_f32_16x16x32_bf16 v[64:67], v[44:47], v[204:207], v[64:67]
    ds_read_b128 v[24:27], v70 offset:24576
    s_waitcnt vmcnt(9) lgkmcnt(4)
    v_mfma_f32_16x16x32_bf16 v[48:51], v[8:11], v[208:211], v[48:51]
    ds_read_b128 v[28:31], v69 offset:59392
    s_add_u32 s9, s72, 135168
    buffer_load_dwordx4 v[228:231], v0, s[20:23], s9 offen sc1
    s_waitcnt lgkmcnt(4)
    v_mfma_f32_16x16x32_bf16 v[52:55], v[12:15], v[208:211], v[52:55]
    ds_read_b128 v[32:35], v70 offset:2048
    s_waitcnt lgkmcnt(4)
    v_mfma_f32_16x16x32_bf16 v[56:59], v[16:19], v[208:211], v[56:59]
    ds_read_b128 v[36:39], v70 offset:10240
    s_waitcnt lgkmcnt(4)
    v_mfma_f32_16x16x32_bf16 v[60:63], v[20:23], v[208:211], v[60:63]
    ds_read_b128 v[40:43], v70 offset:18432
    s_waitcnt lgkmcnt(4)
    v_mfma_f32_16x16x32_bf16 v[64:67], v[24:27], v[208:211], v[64:67]
    ds_read_b128 v[44:47], v70 offset:26624
    s_waitcnt vmcnt(9) lgkmcnt(4)
    v_mfma_f32_16x16x32_bf16 v[48:51], v[28:31], v[212:215], v[48:51]
    ds_read_b128 v[8:11], v69 offset:61440
    s_add_u32 s9, s72, 139264
    buffer_load_dwordx4 v[232:235], v0, s[20:23], s9 offen sc1
    s_waitcnt lgkmcnt(4)
    v_mfma_f32_16x16x32_bf16 v[52:55], v[32:35], v[212:215], v[52:55]
    ds_read_b128 v[12:15], v70 offset:4096
    s_waitcnt lgkmcnt(4)
    v_mfma_f32_16x16x32_bf16 v[56:59], v[36:39], v[212:215], v[56:59]
    ds_read_b128 v[16:19], v70 offset:12288
    s_waitcnt lgkmcnt(4)
    v_mfma_f32_16x16x32_bf16 v[60:63], v[40:43], v[212:215], v[60:63]
    ds_read_b128 v[20:23], v70 offset:20480
    s_waitcnt lgkmcnt(4)
    v_mfma_f32_16x16x32_bf16 v[64:67], v[44:47], v[212:215], v[64:67]
    ds_read_b128 v[24:27], v70 offset:28672
    s_waitcnt vmcnt(9) lgkmcnt(4)
    v_mfma_f32_16x16x32_bf16 v[48:51], v[8:11], v[216:219], v[48:51]
    ds_read_b128 v[28:31], v69 offset:63488
    s_cmp_lt_u32 s3, 2
    s_cbranch_scc0 L_c37
    s_add_u32 s9, s73, 368640
    s_add_u32 m0, s16, 40960
    s_nop 0
    buffer_load_dwordx4 v0, s[20:23], s9 offen sc1 lds
    s_add_u32 s9, s73, 369664
    s_add_u32 m0, s16, 49152
    s_nop 0
    buffer_load_dwordx4 v0, s[20:23], s9 offen sc1 lds
    s_add_u32 s9, s73, 370688
    s_add_u32 m0, s16, 57344
    s_nop 0
    buffer_load_dwordx4 v0, s[20:23], s9 offen sc1 lds
    s_add_u32 s9, s73, 371712
    s_add_u32 m0, s16, 65536
    s_nop 0
    buffer_load_dwordx4 v0, s[20:23], s9 offen sc1 lds
    s_add_u32 s9, s73, 372736
    s_add_u32 m0, s16, 73728
    s_nop 0
    buffer_load_dwordx4 v0, s[20:23], s9 offen sc1 lds
L_c37:
    s_waitcnt lgkmcnt(4)
    v_mfma_f32_16x16x32_bf16 v[52:55], v[12:15], v[216:219], v[52:55]
    ds_read_b128 v[32:35], v70 offset:6144
    s_add_u32 s9, s72, 143360
    buffer_load_dwordx4 v[236:239], v0, s[20:23], s9 offen sc1
    s_waitcnt lgkmcnt(4)
    v_mfma_f32_16x16x32_bf16 v[56:59], v[16:19], v[216:219], v[56:59]
    ds_read_b128 v[36:39], v70 offset:14336
    s_waitcnt lgkmcnt(4)
    v_mfma_f32_16x16x32_bf16 v[60:63], v[20:23], v[216:219], v[60:63]
    ds_read_b128 v[40:43], v70 offset:22528
    s_waitcnt lgkmcnt(4)
    v_mfma_f32_16x16x32_bf16 v[64:67], v[24:27], v[216:219], v[64:67]
    ds_read_b128 v[44:47], v70 offset:30720
    s_waitcnt vmcnt(5) lgkmcnt(0)
    s_barrier
    s_waitcnt vmcnt(4)
    v_mfma_f32_16x16x32_bf16 v[48:51], v[28:31], v[220:223], v[48:51]
    ds_read_b128 v[8:11], v68
    s_add_u32 s9, s72, 147456
    buffer_load_dwordx4 v[240:243], v0, s[20:23], s9 offen sc1
    v_mfma_f32_16x16x32_bf16 v[52:55], v[32:35], v[220:223], v[52:55]
    ds_read_b128 v[12:15], v68 offset:8192
    v_mfma_f32_16x16x32_bf16 v[56:59], v[36:39], v[220:223], v[56:59]
    ds_read_b128 v[16:19], v68 offset:16384
    v_mfma_f32_16x16x32_bf16 v[60:63], v[40:43], v[220:223], v[60:63]
    ds_read_b128 v[20:23], v68 offset:24576
    v_mfma_f32_16x16x32_bf16 v[64:67], v[44:47], v[220:223], v[64:67]
    ds_read_b128 v[24:27], v68 offset:32768
    s_waitcnt vmcnt(4) lgkmcnt(4)
    v_mfma_f32_16x16x32_bf16 v[48:51], v[8:11], v[224:227], v[48:51]
    ds_read_b128 v[28:31], v68 offset:2048
    s_waitcnt lgkmcnt(4)
    v_mfma_f32_16x16x32_bf16 v[52:55], v[12:15], v[224:227], v[52:55]
    ds_read_b128 v[32:35], v68 offset:10240
    s_waitcnt lgkmcnt(4)
    v_mfma_f32_16x16x32_bf16 v[56:59], v[16:19], v[224:227], v[56:59]
    ds_read_b128 v[36:39], v68 offset:18432
    s_waitcnt lgkmcnt(4)
    v_mfma_f32_16x16x32_bf16 v[60:63], v[20:23], v[224:227], v[60:63]
    ds_read_b128 v[40:43], v68 offset:26624
    s_waitcnt lgkmcnt(4)
    v_mfma_f32_16x16x32_bf16 v[64:67], v[24:27], v[224:227], v[64:67]
    ds_read_b128 v[44:47], v68 offset:34816
    s_waitcnt vmcnt(3) lgkmcnt(4)
    v_mfma_f32_16x16x32_bf16 v[48:51], v[28:31], v[228:231], v[48:51]
    ds_read_b128 v[8:11], v68 offset:4096
    s_waitcnt lgkmcnt(4)
    v_mfma_f32_16x16x32_bf16 v[52:55], v[32:35], v[228:231], v[52:55]
    ds_read_b128 v[12:15], v68 offset:12288
    s_waitcnt lgkmcnt(4)
    v_mfma_f32_16x16x32_bf16 v[56:59], v[36:39], v[228:231], v[56:59]
    ds_read_b128 v[16:19], v68 offset:20480
    s_waitcnt lgkmcnt(4)
    v_mfma_f32_16x16x32_bf16 v[60:63], v[40:43], v[228:231], v[60:63]
    ds_read_b128 v[20:23], v68 offset:28672
    s_waitcnt lgkmcnt(4)
    v_mfma_f32_16x16x32_bf16 v[64:67], v[44:47], v[228:231], v[64:67]
    ds_read_b128 v[24:27], v68 offset:36864
    s_waitcnt vmcnt(2) lgkmcnt(4)
    v_mfma_f32_16x16x32_bf16 v[48:51], v[8:11], v[232:235], v[48:51]
    ds_read_b128 v[28:31], v68 offset:6144
    s_waitcnt lgkmcnt(4)
    v_mfma_f32_16x16x32_bf16 v[52:55], v[12:15], v[232:235], v[52:55]
    ds_read_b128 v[32:35], v68 offset:14336
    s_waitcnt lgkmcnt(4)
    v_mfma_f32_16x16x32_bf16 v[56:59], v[16:19], v[232:235], v[56:59]
    ds_read_b128 v[36:39], v68 offset:22528
    s_waitcnt lgkmcnt(4)
    v_mfma_f32_16x16x32_bf16 v[60:63], v[20:23], v[232:235], v[60:63]
    ds_read_b128 v[40:43], v68 offset:30720
    s_waitcnt lgkmcnt(4)
    v_mfma_f32_16x16x32_bf16 v[64:67], v[24:27], v[232:235], v[64:67]
    ds_read_b128 v[44:47], v68 offset:38912
    s_waitcnt vmcnt(2) lgkmcnt(0)
    s_barrier
    s_waitcnt vmcnt(1)
    v_mfma_f32_16x16x32_bf16 v[48:51], v[28:31], v[236:239], v[48:51]
    ds_read_b128 v[8:11], v68 offset:40960
    v_mfma_f32_16x16x32_bf16 v[52:55], v[32:35], v[236:239], v[52:55]
    ds_read_b128 v[12:15], v68 offset:49152
    v_mfma_f32_16x16x32_bf16 v[56:59], v[36:39], v[236:239], v[56:59]
    ds_read_b128 v[16:19], v68 offset:57344
    v_mfma_f32_16x16x32_bf16 v[60:63], v[40:43], v[236:239], v[60:63]
    ds_read_b128 v[20:23], v69
    v_mfma_f32_16x16x32_bf16 v[64:67], v[44:47], v[236:239], v[64:67]
    ds_read_b128 v[24:27], v69 offset:8192
    s_waitcnt vmcnt(0) lgkmcnt(4)
    v_mfma_f32_16x16x32_bf16 v[48:51], v[8:11], v[240:243], v[48:51]
    s_waitcnt lgkmcnt(3)
    v_mfma_f32_16x16x32_bf16 v[52:55], v[12:15], v[240:243], v[52:55]
    s_waitcnt lgkmcnt(2)
    v_mfma_f32_16x16x32_bf16 v[56:59], v[16:19], v[240:243], v[56:59]
    s_waitcnt lgkmcnt(1)
    v_mfma_f32_16x16x32_bf16 v[60:63], v[20:23], v[240:243], v[60:63]
    s_waitcnt lgkmcnt(0)
    v_mfma_f32_16x16x32_bf16 v[64:67], v[24:27], v[240:243], v[64:67]
    ds_write_b128 v75, v[48:51]
    s_nop 0
    ds_write_b128 v75, v[52:55] offset:64
    s_nop 0
    ds_write_b128 v75, v[56:59] offset:128
    s_nop 0
    ds_write_b128 v75, v[60:63] offset:192
    s_nop 0
    ds_write_b128 v75, v[64:67] offset:256
    v_lshlrev_b32 v8, 16, v244
    v_and_b32 v9, 0xffff0000, v244
    v_lshlrev_b32 v10, 16, v245
    v_and_b32 v11, 0xffff0000, v245
    v_lshlrev_b32 v12, 16, v246
    v_and_b32 v13, 0xffff0000, v246
    v_lshlrev_b32 v14, 16, v247
    v_and_b32 v15, 0xffff0000, v247
    v_lshlrev_b32 v16, 16, v248
    v_and_b32 v17, 0xffff0000, v248
    v_lshlrev_b32 v18, 16, v249
    v_and_b32 v19, 0xffff0000, v249
    v_lshlrev_b32 v20, 16, v250
    v_and_b32 v21, 0xffff0000, v250
    v_lshlrev_b32 v22, 16, v251
    v_and_b32 v23, 0xffff0000, v251
    s_waitcnt lgkmcnt(0)
    s_barrier
    ds_read_b128 v[96:99], v73
    ds_read_b128 v[100:103], v73 offset:16
    ds_read_b128 v[104:107], v73 offset:21504
    ds_read_b128 v[108:111], v73 offset:21520
    s_cmp_lt_u32 s3, 2
    s_cbranch_scc1 L_f16
    s_waitcnt lgkmcnt(3)
    v_add_f32 v8, v8, v96
    v_add_f32 v9, v9, v97
    v_add_f32 v10, v10, v98
    v_add_f32 v11, v11, v99
    s_waitcnt lgkmcnt(2)
    v_add_f32 v12, v12, v100
    v_add_f32 v13, v13, v101
    v_add_f32 v14, v14, v102
    v_add_f32 v15, v15, v103
    s_waitcnt lgkmcnt(1)
    v_add_f32 v8, v8, v104
    v_add_f32 v9, v9, v105
    v_add_f32 v10, v10, v106
    v_add_f32 v11, v11, v107
    s_waitcnt lgkmcnt(0)
    v_add_f32 v12, v12, v108
    v_add_f32 v13, v13, v109
    v_add_f32 v14, v14, v110
    v_add_f32 v15, v15, v111
    v_cvt_pk_bf16_f32 v244, v8, v9
    v_cvt_pk_bf16_f32 v245, v10, v11
    v_cvt_pk_bf16_f32 v246, v12, v13
    v_cvt_pk_bf16_f32 v247, v14, v15
    buffer_store_dwordx4 v[244:247], v71, s[64:67], s74 offen nt
    s_branch L_f16e
L_f16:
    ds_read_b128 v[112:115], v74
    ds_read_b128 v[116:119], v74 offset:16
    ds_read_b128 v[120:123], v74 offset:21504
    ds_read_b128 v[124:127], v74 offset:21520
    s_waitcnt lgkmcnt(7)
    v_add_f32 v8, v8, v96
    v_add_f32 v9, v9, v97
    v_add_f32 v10, v10, v98
    v_add_f32 v11, v11, v99
    s_waitcnt lgkmcnt(6)
    v_add_f32 v12, v12, v100
    v_add_f32 v13, v13, v101
    v_add_f32 v14, v14, v102
    v_add_f32 v15, v15, v103
    s_waitcnt lgkmcnt(5)
    v_add_f32 v8, v8, v104
    v_add_f32 v9, v9, v105
    v_add_f32 v10, v10, v106
    v_add_f32 v11, v11, v107
    s_waitcnt lgkmcnt(4)
    v_add_f32 v12, v12, v108
    v_add_f32 v13, v13, v109
    v_add_f32 v14, v14, v110
    v_add_f32 v15, v15, v111
    v_cvt_pk_bf16_f32 v244, v8, v9
    v_cvt_pk_bf16_f32 v245, v10, v11
    v_cvt_pk_bf16_f32 v246, v12, v13
    v_cvt_pk_bf16_f32 v247, v14, v15
    buffer_store_dwordx4 v[244:247], v71, s[64:67], s74 offen nt
    s_waitcnt lgkmcnt(3)
    v_add_f32 v16, v16, v112
    v_add_f32 v17, v17, v113
    v_add_f32 v18, v18, v114
    v_add_f32 v19, v19, v115
    s_waitcnt lgkmcnt(2)
    v_add_f32 v20, v20, v116
    v_add_f32 v21, v21, v117
    v_add_f32 v22, v22, v118
    v_add_f32 v23, v23, v119
    s_waitcnt lgkmcnt(1)
    v_add_f32 v16, v16, v120
    v_add_f32 v17, v17, v121
    v_add_f32 v18, v18, v122
    v_add_f32 v19, v19, v123
    s_waitcnt lgkmcnt(0)
    v_add_f32 v20, v20, v124
    v_add_f32 v21, v21, v125
    v_add_f32 v22, v22, v126
    v_add_f32 v23, v23, v127
    v_cvt_pk_bf16_f32 v248, v16, v17
    v_cvt_pk_bf16_f32 v249, v18, v19
    v_cvt_pk_bf16_f32 v250, v20, v21
    v_cvt_pk_bf16_f32 v251, v22, v23
    buffer_store_dwordx4 v[248:251], v72, s[64:67], s74 offen nt
L_f16e:
    s_or_b32 s4, s2, s3
    s_cbranch_scc1 L_ep17
    v_xor_b32 v24, s60, v90
    v_bitop3_b32 v24, v24, v91, s60 bitop3:0xf6
    v_bitop3_b32 v24, v24, v92, s60 bitop3:0xf6
    v_bitop3_b32 v24, v24, v93, s60 bitop3:0xf6
    v_cmp_ne_u32 vcc, 0, v24
    s_nop 1
    s_cmp_lg_u64 vcc, 0
    s_cbranch_scc0 L_ck18_ok
L_ck18_sp:
    s_sleep 2
    buffer_load_dword v90, v86, s[36:39], 0 offen offset:4 sc1
    buffer_load_dword v91, v87, s[36:39], 0 offen offset:4 sc1
    buffer_load_dword v92, v88, s[36:39], 0 offen offset:4 sc1
    buffer_load_dword v93, v89, s[36:39], 0 offen offset:4 sc1
    s_waitcnt vmcnt(0)
    s_add_u32 s75, s75, 1
    s_cmp_gt_u32 s75, 30000
    s_cbranch_scc1 L_ck18_ok
    v_xor_b32 v24, s60, v90
    s_nop 3
    v_bitop3_b32 v24, v24, v91, s60 bitop3:0xf6
    s_nop 3
    v_bitop3_b32 v24, v24, v92, s60 bitop3:0xf6
    s_nop 3
    v_bitop3_b32 v24, v24, v93, s60 bitop3:0xf6
    s_nop 3
    v_cmp_ne_u32 vcc, 0, v24
    s_nop 3
    s_cmp_lg_u64 vcc, 0
    s_nop 3
    s_cbranch_scc1 L_ck18_sp
L_ck18_ok:
    v_mov_b32 v25, s60
    v_lshlrev_b32 v24, 20, v0
    s_mov_b32 s4, 15106048
    buffer_store_dword v25, v24, s[20:23], s4 offen sc1
L_ep17:
    s_endpgm
L_parallel_sum__sliding_local_dilated__glu_gated_swiglu__prompt_kernel_end:
    s_endpgm
.section .rodata,"a"
.p2align 6
.amdhsa_kernel parallel_sum__sliding_local_dilated__glu_gated_swiglu__prompt_kernel
  .amdhsa_next_free_vgpr 256
  .amdhsa_next_free_sgpr 102
  .amdhsa_accum_offset 256
  .amdhsa_group_segment_fixed_size 0
  .amdhsa_kernarg_size 80
  .amdhsa_user_sgpr_count 2
  .amdhsa_user_sgpr_kernarg_segment_ptr 1
  .amdhsa_system_sgpr_workgroup_id_x 1
.end_amdhsa_kernel
```
